```python
import torch

def _softmax(x, axis=-1):
    return torch.softmax(x, dim=axis)
def _gelu(x):
    return torch.nn.functional.gelu(x, approximate="tanh")
def _silu(x):
    return torch.nn.functional.silu(x)
def _sigmoid(x):
    return torch.sigmoid(x)
def _layernorm(x, axis=-1, eps=1e-5):
    m = x.mean(dim=axis, keepdim=True)
    v = x.var(dim=axis, keepdim=True, unbiased=False)
    return (x - m) / torch.sqrt(v + eps)
def _scatter_add(tgt, idx, src, axis=0):
    return tgt.clone().index_add_(axis, idx, src)
def _segment_sum(src, seg, n):
    out = torch.zeros((n,) + src.shape[1:], dtype=src.dtype)
    return out.index_add_(0, seg, src)
def _pad(x, pw):
    flat = tuple(v for pair in reversed(pw) for v in pair)
    return torch.nn.functional.pad(x, flat)

kernel_name = 'interleave_layers__linear_attn_block__mixer_token_mlp__prompt'

def setup_inputs():

    _w = (lambda a: (lambda t: t.to(torch.bfloat16) if t.is_floating_point() else t)(torch.as_tensor(a)))
    def _A_setup():
        B, S, D = 1, 2048, 512
        return {
            "x": _w((lambda *s: torch.randn(*s, dtype=torch.bfloat16) * 0.05)(B, S, D)),
            "wqkv": _w((lambda *s: torch.randn(*s, dtype=torch.bfloat16) * 0.05)(D, 3 * D)),
            "wo": _w((lambda *s: torch.randn(*s, dtype=torch.bfloat16) * 0.05)(D, D)),
        }
    _A_in = _A_setup()

    def _B_setup():
        B, S, D, F = 1, 2048, 512, 1792
        return {
            "x": _w((lambda *s: torch.randn(*s, dtype=torch.bfloat16) * 0.05)(B, S, D)),
            "w1": _w((lambda *s: torch.randn(*s, dtype=torch.bfloat16) * 0.8)(S, F) * (S ** -0.5)),
            "b1": _w((lambda *s: torch.randn(*s, dtype=torch.bfloat16) * 12.8)(F) * 0.02),
            "w2": _w((lambda *s: torch.randn(*s, dtype=torch.bfloat16) * 0.4)(F, S) * (F ** -0.5)),
            "b2": _w((lambda *s: torch.randn(*s, dtype=torch.bfloat16) * 3.2)(S) * 0.02),
        }
    _B_in = _B_setup()

    return {
        "A_x": _A_in["x"],
        "A_wqkv": _A_in["wqkv"],
        "A_wo": _A_in["wo"],
        "B_x": _B_in["x"],
        "B_w1": _B_in["w1"],
        "B_b1": _B_in["b1"],
        "B_w2": _B_in["w2"],
        "B_b2": _B_in["b2"],
    }

def reference(A_x, A_wqkv, A_wo, B_x, B_w1, B_b1, B_w2, B_b2):
    def _A_ref(x, wqkv, wo):
        B, S, D = x.shape
        H = 32; Dh = D // H
        qkv = (lambda x, *d: x.permute(*d))((x @ wqkv).reshape(B, S, 3, H, Dh), 2, 0, 3, 1, 4)
        q, k, v = qkv[0], qkv[1], qkv[2]
        phi = lambda t: torch.where(t > 0, t + 1, torch.exp(t)) + 1e-6
        pq, pk = phi(q), phi(k)
        kv = torch.einsum("bhsd,bhse->bhde", pk, v)
        z = torch.einsum("bhsd->bhd", pk)
        num = torch.einsum("bhqd,bhde->bhqe", pq, kv)
        den = torch.einsum("bhqd,bhd->bhq", pq, z)[..., None] + 1e-6
        o = num / den
        return (lambda x, *d: x.permute(*d))(o, 0, 2, 1, 3).reshape(B, S, D) @ wo

    def _B_ref(x, w1, b1, w2, b2):
        B, S, D = x.shape
        h = _layernorm(x, axis=-1)
        u = torch.einsum("bsd,sf->bdf", h, w1) + b1
        u = _gelu(u)
        y = torch.einsum("bdf,fs->bds", u, w2) + b2
        return (lambda x, *d: x.permute(*d))(y, 0, 2, 1)

    x = A_x
    x = x + _A_ref(_layernorm(x, axis=-1), A_wqkv, A_wo)
    x = x + _B_ref(_layernorm(x, axis=-1), B_w1, B_b1, B_w2, B_b2)
    x = x + _A_ref(_layernorm(x, axis=-1), A_wqkv, A_wo)
    x = x + _B_ref(_layernorm(x, axis=-1), B_w1, B_b1, B_w2, B_b2)
    return x
```

```asm
; @launch grid=(256,1,1) block=(256,1,1) lds=163840
.amdgcn_target "amdgcn-amd-amdhsa--gfx950"
.text
.globl interleave_layers__linear_attn_block__mixer_token_mlp__prompt_kernel
.p2align 8
.type interleave_layers__linear_attn_block__mixer_token_mlp__prompt_kernel,@function
interleave_layers__linear_attn_block__mixer_token_mlp__prompt_kernel:
    s_cmp_ge_u32 s2, 256
    s_cbranch_scc1 L_EXIT
    s_load_dwordx16 s[84:99], s[0:1], 0
    s_load_dwordx4 s[44:47], s[0:1], 64
    s_load_dwordx2 s[100:101], s[0:1], 80
    s_mov_b32 s61, s2
    v_lshrrev_b32 v4, 6, v0
    v_and_b32 v0, 63, v0
    v_readfirstlane_b32 s3, v4
    v_lshlrev_b32 v1, 4, v0
    v_lshrrev_b32 v21, 5, v0
    s_getpc_b64 s[36:37]
L_PC:
    s_and_b32 s37, s37, 0xffff
    s_mov_b32 s38, L_END - L_PC
    s_mov_b32 s39, 0x20000
    s_lshr_b32 s62, s61, 3
    s_lshl_b32 s62, s62, 2
    s_add_u32 s62, s62, s3
    s_lshl_b32 s62, s62, 10
    buffer_load_dwordx4 a[252:255], v1, s[36:39], s62 offen
    s_and_b32 s62, s61, 7
    s_lshr_b32 s63, s61, 3
    s_lshr_b32 s64, s63, 3
    s_and_b32 s49, s63, 7
    s_and_b32 s50, s62, 3
    s_lshl_b32 s50, s50, 2
    s_add_u32 s50, s50, s64
    s_lshr_b32 s51, s62, 2
    s_lshl_b32 s51, s51, 3
    s_add_u32 s51, s51, s49
    s_lshr_b32 s76, s49, 1
    s_add_u32 s76, s76, s64
    s_and_b32 s76, s76, 3
    s_lshl_b32 s76, s76, 1
    s_and_b32 s65, s63, 1
    s_add_u32 s76, s76, s65
    s_and_b32 s73, s76, 6
    s_lshl_b32 s69, s3, 10
    s_lshl_b32 s57, s3, 110
    s_add_u32 s75, s57, 32768
    s_add_u32 s57, s57, 98304
    v_lshrrev_b32 v4, 2, v0
    s_lshl_b32 s62, s3, 4
    v_add_u32_e64 v4, s62, v4
    v_mul_u32_u24 v126, 3072, v4
    v_and_b32_e64 v4, 3, v0
    v_lshl_add_u32 v126, v4, 4, v126
    s_lshl_b32 s62, s51, 6
    v_add_u32 v126, s62, v126
    s_lshl_b32 s62, s50, 17
    s_lshl_b32 s67, s3, 15
    s_add_u32 s62, s62, s67
    v_lshrrev_b32 v4, 3, v0
    v_lshlrev_b32 v4, 10, v4
    v_add_u32 v4, s62, v4
    v_and_b32 v5, 7, v0
    v_lshrrev_b32 v6, 4, v0
    v_xor_b32_e64 v5, v5, v6
    v_lshl_add_u32 v127, v5, 4, v4
    v_xor_b32 v96, 64, v127
    v_add_u32 v96, 7168, v96
    s_waitcnt lgkmcnt(0)
    s_mov_b32 s4, s84
    s_and_b32 s5, s85, 0xffff
    s_mov_b32 s6, 0x200000
    s_mov_b32 s7, 0x20000
    s_mov_b32 s8, s86
    s_and_b32 s9, s87, 0xffff
    s_mov_b32 s10, 0x180000
    s_mov_b32 s11, 0x20000
    s_add_u32 s81, s73, 0
    s_and_b32 s81, s81, 7
    s_lshl_b32 s63, s81, 7
    s_add_u32 m0, s57, 0
    s_mul_i32 s68, s81, 196608
    buffer_load_dwordx4 v127, s[4:7], s63 offen lds
    buffer_load_dwordx4 v96, s[4:7], s63 offen offset:1024 lds
    s_add_u32 m0, s57, 2048
    s_add_u32 s63, s63, 16384
    buffer_load_dwordx4 v127, s[4:7], s63 offen lds
    buffer_load_dwordx4 v96, s[4:7], s63 offen offset:1024 lds
    s_add_u32 m0, s69, 31744
    s_nop 0
    buffer_load_dwordx4 v126, s[8:11], s68 offen offset:1024 lds
    s_add_u32 m0, s69, 63488
    s_nop 0
    buffer_load_dwordx4 v126, s[8:11], s68 offen offset:2048 lds
    s_add_u32 m0, s69, 0
    s_nop 0
    buffer_load_dwordx4 v126, s[8:11], s68 offen offset:0 lds
    s_mov_b32 s24, s100
    s_and_b32 s25, s101, 0xffff
    s_mov_b32 s26, 0x10000000
    s_mov_b32 s27, 0x20000
    buffer_load_dword v92, off, s[24:27], 0 offset:0 sc1
    s_and_b32 s62, s61, 7
    s_lshr_b32 s63, s61, 3
    s_lshr_b32 s64, s63, 3
    s_lshl_b32 s48, s62, 2
    s_add_u32 s48, s48, s64
    s_lshr_b32 s65, s62, 1
    s_mul_i32 s65, s65, 7
    s_and_b32 s66, s62, 1
    s_lshl_b32 s67, s66, 2
    s_add_u32 s53, s65, s67
    s_add_u32 s53, s53, s64
    s_and_b32 s54, s63, 3
    s_add_u32 s67, s67, s54
    s_add_u32 s81, s65, 3
    s_cmp_lt_u32 s63, 24
    s_cselect_b32 s53, s53, s81
    s_cselect_b32 s52, s49, s67
    s_mul_i32 s66, s66, 3
    s_add_u32 s82, s65, s66
    s_lshl_b32 s77, s62, 2
    s_and_b32 s65, s63, 3
    s_lshr_b32 s54, s63, 98
    s_lshl_b32 s83, s63, 2
    s_add_u32 s83, s83, s3
    s_lshl_b32 s79, s62, 2
    s_add_u32 s79, s79, s65
    s_lshl_b32 s79, s79, 97
    s_add_u32 s79, s79, s3
    s_cmp_lt_u32 s3, 2
    s_cselect_b32 s79, s79, 99
    s_cmp_eq_u32 s54, 7
    s_cselect_b32 s79, s79, 99
    s_mul_i32 s78, s62, 7
    s_lshr_b32 s78, s78, 98
    s_lshl_b32 s78, s78, 97
    s_lshr_b32 s55, s3, 1
    s_and_b32 s56, s3, 1
    s_mov_b32 s58, 400000
    s_mov_b32 s59, 0x3f803f80
    s_mov_b32 s60, 0x358637bd
    s_mov_b32 s74, 0x3fb8aa3b
    s_mov_b32 s12, s88
    s_and_b32 s13, s89, 0xffff
    s_mov_b32 s14, 0x80000
    s_mov_b32 s15, 0x20000
    s_mov_b32 s16, s92
    s_and_b32 s17, s93, 0xffff
    s_mov_b32 s18, 0x700000
    s_mov_b32 s19, 0x20000
    s_mov_b32 s36, s94
    s_and_b32 s37, s95, 0xffff
    s_mov_b32 s38, 0xe00
    s_mov_b32 s39, 0x20000
    s_mov_b32 s20, s96
    s_and_b32 s21, s97, 0xffff
    s_mov_b32 s22, 0x700000
    s_mov_b32 s23, 0x20000
    s_mov_b32 s40, s98
    s_and_b32 s41, s99, 0xffff
    s_mov_b32 s42, 0x1000
    s_mov_b32 s43, 0x20000
    s_mov_b32 s28, s44
    s_and_b32 s29, s45, 0xffff
    s_mov_b32 s30, 0x200000
    s_mov_b32 s31, 0x20000
    s_mov_b32 s32, s46
    s_and_b32 s33, s47, 0xffff
    s_mov_b32 s34, 0x100
    s_mov_b32 s35, 0x20000
    s_add_u32 s81, s73, 1
    s_and_b32 s81, s81, 7
    s_lshl_b32 s63, s81, 7
    s_add_u32 m0, s57, 4096
    s_mul_i32 s68, s81, 196608
    buffer_load_dwordx4 v127, s[4:7], s63 offen lds
    buffer_load_dwordx4 v96, s[4:7], s63 offen offset:1024 lds
    s_add_u32 m0, s57, 6144
    s_add_u32 s63, s63, 16384
    buffer_load_dwordx4 v127, s[4:7], s63 offen lds
    buffer_load_dwordx4 v96, s[4:7], s63 offen offset:1024 lds
    s_add_u32 m0, s69, 35840
    s_nop 0
    buffer_load_dwordx4 v126, s[8:11], s68 offen offset:1024 lds
    s_add_u32 m0, s69, 67584
    s_nop 0
    buffer_load_dwordx4 v126, s[8:11], s68 offen offset:2048 lds
    s_add_u32 m0, s69, 4096
    s_nop 0
    buffer_load_dwordx4 v126, s[8:11], s68 offen offset:0 lds
    s_mov_b32 s66, 0
    v_min_u32 v4, 31, v0
    v_lshrrev_b32 v5, 3, v4
    v_mul_u32_u24 v5, 1024, v5
    v_and_b32_e64 v4, 7, v4
    v_lshl_add_u32 v4, v4, 7, v5
    s_mul_i32 s67, s83, 4096
    s_add_u32 s66, s66, s67
    buffer_load_dword a254, v4, s[12:15], s66 offen
    s_mov_b32 s44, s16
    s_and_b32 s45, s17, 0xffff
    s_mov_b32 s46, 0x700000
    s_mov_b32 s47, 0x20000
    s_cmp_eq_u32 s54, 7
    s_cselect_b32 s18, 0, s18
    v_mov_b32 v100, -1
    v_mov_b32 v101, -1
    v_mov_b32 v102, -1
    v_mov_b32 v103, -1
    s_mul_i32 s84, s51, 40960
    s_mul_i32 s67, s50, 2560
    s_add_u32 s84, s84, s67
    s_mul_i32 s67, s3, 640
    s_add_u32 s84, s84, s67
    s_add_u32 s84, s84, 0x8000
    s_lshl_b32 s85, s50, 113
    s_lshl_b32 s67, s3, 15
    s_add_u32 s85, s85, s67
    s_lshl_b32 s67, s51, 11
    s_add_u32 s85, s85, s67
    s_add_u32 s85, s85, 0x400000
    s_lshl_b32 s86, s48, 112
    s_lshl_b32 s67, s55, 15
    s_add_u32 s86, s86, s67
    s_lshl_b32 s67, s56, 14
    s_add_u32 s86, s86, s67
    s_add_u32 s86, s86, 0x400000
    s_mul_i32 s87, s56, 12288
    s_add_u32 s87, s87, 0x2000
    s_lshl_b32 s88, s48, 13
    s_lshl_b32 s67, s49, 10
    s_add_u32 s88, s88, s67
    s_lshl_b32 s67, s56, 9
    s_add_u32 s88, s88, s67
    s_lshl_b32 s67, s55, 8
    s_add_u32 s88, s88, s67
    s_add_u32 s88, s88, 0x166000
    s_lshl_b32 s89, s48, 13
    s_lshl_b32 s67, s55, 8
    s_add_u32 s89, s89, s67
    s_add_u32 s89, s89, 0x166000
    s_lshl_b32 s90, s49, 18
    s_lshl_b32 s67, s48, 13
    s_add_u32 s90, s90, s67
    s_lshl_b32 s67, s55, 12
    s_add_u32 s90, s90, s67
    s_lshl_b32 s67, s56, 8
    s_add_u32 s90, s90, s67
    s_add_u32 s90, s90, 0x800000
    s_lshl_b32 s91, s52, 18
    s_lshl_b32 s67, s3, 16
    s_add_u32 s91, s91, s67
    s_add_u32 s91, s91, 0x800000
    s_mul_i32 s92, s52, 229376
    s_lshl_b32 s67, s53, 13
    s_add_u32 s92, s92, s67
    s_lshl_b32 s67, s55, 12
    s_add_u32 s92, s92, s67
    s_lshl_b32 s67, s56, 107
    s_add_u32 s92, s92, s67
    s_add_u32 s92, s92, 0xc00000
    s_cmp_eq_u32 s54, 7
    s_cselect_b32 s92, 0x10000000, s92
    s_mul_i32 s93, s49, 229376
    s_mul_i32 s67, s3, 57344
    s_add_u32 s93, s93, s67
    s_add_u32 s93, s93, 0xc00000
    s_lshl_b32 s94, s48, 16
    s_lshl_b32 s67, s55, 15
    s_add_u32 s94, s94, s67
    s_lshl_b32 s67, s49, 12
    s_add_u32 s94, s94, s67
    s_lshl_b32 s67, s56, 10
    s_add_u32 s94, s94, s67
    s_add_u32 s94, s94, 0x1000000
    s_lshl_b32 s95, s50, 113
    s_lshl_b32 s67, s3, 15
    s_add_u32 s95, s95, s67
    s_add_u32 s95, s95, 0x1000000
    s_add_u32 s96, s88, 0x80000
    s_lshl_b32 s97, s50, 110
    s_lshl_b32 s67, s55, 13
    s_add_u32 s97, s97, s67
    s_lshl_b32 s67, s56, 8
    s_add_u32 s97, s97, s67
    s_add_u32 s97, s97, 0x1e6000
    s_mul_i32 s98, s51, 98304
    s_add_u32 s98, s98, 0x1200000
    s_mov_b32 s99, 0xbdd2d3e8
    v_bfe_u32 v4, v0, 2, 2
    v_lshl_add_u32 v4, v21, 3, v4
    v_lshlrev_b32_e64 v124, 6, v4
    v_bfe_u32 v5, v0, 4, 1
    v_lshl_add_u32 v124, v5, 5, v124
    v_and_b32_e64 v5, 3, v0
    v_lshl_add_u32 v124, v5, 3, v124
    v_add_u32 v125, 65536, v124
    v_accvgpr_write_b32 a248, s59
    v_accvgpr_write_b32 a249, s59
    v_accvgpr_write_b32 a250, s59
    v_accvgpr_write_b32 a251, s59
    v_mov_b32 v30, 0
    v_mov_b32 v31, 0
    v_mov_b32 v121, 0
    v_mov_b32 v122, 0
    v_mov_b32 v123, 0
    v_mov_b32 v86, 0
    v_mov_b32 v87, 0
    v_mov_b32 v114, 0
    v_mov_b32 v115, 0
    v_mov_b32 v118, 0
    v_mov_b32 v119, 0
    v_add_u32 v97, s69, v124
    v_add_u32 v98, s69, v125
    v_mov_b32 v80, 0
    v_mov_b32 v81, 0
    v_mov_b32 v82, 0
    v_mov_b32 v83, 0
    v_and_b32 v4, 31, v0
    v_bfe_u32 v5, v0, 1, 3
    v_xor_b32 v5, v5, v21
    v_lshlrev_b32 v4, 7, v4
    v_add_u32 v4, s57, v4
    v_xor_b32 v6, 0, v5
    v_lshl_add_u32 v88, v6, 4, v4
    v_xor_b32 v6, 2, v5
    v_lshl_add_u32 v89, v6, 4, v4
    v_xor_b32 v6, 4, v5
    v_lshl_add_u32 v90, v6, 4, v4
    v_xor_b32_e64 v6, 6, v5
    v_lshl_add_u32 v91, v6, 4, v4
    s_lshl_b32 s66, s49, 7
    v_lshrrev_b32 v4, 3, v0
    v_mul_u32_u24 v2, 1024, v4
    v_bfe_u32 v5, v0, 4, 1
    v_lshlrev_b32 v5, 2, v5
    v_and_b32 v4, 7, v0
    v_xor_b32_e64 v4, v4, v5
    v_lshl_add_u32 v2, v4, 4, v2
    v_add_u32_e64 v2, s66, v2
    v_add_u32 v3, 7168, v2
    v_bfe_u32 v4, v0, 2, 2
    v_lshl_add_u32 v4, v21, 2, v4
    v_lshlrev_b32_e64 v26, 7, v4
    v_bfe_u32 v5, v0, 3, 1
    v_lshl_add_u32 v26, v5, 6, v26
    v_bfe_u32 v5, v0, 4, 1
    v_lshl_add_u32 v26, v5, 5, v26
    v_and_b32_e64 v5, 3, v0
    v_lshl_add_u32 v26, v5, 3, v26
    s_lshl_b32 s67, s55, 6
    v_xor_b32 v26, s67, v26
    v_add_u32 v26, s75, v26
    v_xor_b32 v27, 64, v26
    s_lshl_b32 s67, s56, 5
    v_xor_b32 v26, s67, v26
    v_xor_b32 v27, s67, v27
    s_lshl_b32 s66, s53, 7
    s_mul_i32 s67, s3, 1835008
    s_add_u32 s66, s66, s67
    v_lshrrev_b32 v4, 3, v0
    v_mul_u32_u24 v24, 3584, v4
    v_bfe_u32 v5, v0, 4, 1
    v_lshlrev_b32 v5, 2, v5
    v_and_b32 v4, 7, v0
    v_xor_b32_e64 v4, v4, v5
    v_lshl_add_u32 v24, v4, 4, v24
    v_add_u32_e64 v24, s66, v24
    v_add_u32 v25, 27648, v24
    s_add_u32 s67, s77, 0
    s_sub_u32 s80, s67, 32
    s_cselect_b32 s80, s67, s80
    s_mul_i32 s80, s80, 57344
    s_waitcnt vmcnt(12)
    ds_read_b128 v[128:131], v88 offset:0
    ds_read_b128 v[132:135], v89 offset:0
    ds_read_b128 v[136:139], v90 offset:0
    ds_read_b128 v[140:143], v91 offset:0
    s_waitcnt vmcnt(9)
    s_barrier
    ds_read_b64_tr_b16 a[200:201], v97 offset:32768
    ds_read_b64_tr_b16 a[202:203], v97 offset:33024
    ds_read_b64_tr_b16 a[204:205], v98 offset:0
    ds_read_b64_tr_b16 a[206:207], v98 offset:256
    ds_read_b64_tr_b16 a[208:209], v97 offset:0
    ds_read_b64_tr_b16 a[210:211], v97 offset:256
    ds_read_b64_tr_b16 a[216:217], v124 offset:32768
    ds_read_b64_tr_b16 a[218:219], v124 offset:33024
    ds_read_b64_tr_b16 a[220:221], v125 offset:0
    ds_read_b64_tr_b16 a[222:223], v125 offset:256
    ds_read_b64_tr_b16 a[224:225], v124 offset:33792
    ds_read_b64_tr_b16 a[226:227], v124 offset:34048
    ds_read_b64_tr_b16 a[228:229], v125 offset:1024
    ds_read_b64_tr_b16 a[230:231], v125 offset:1280
    ds_read_b64_tr_b16 a[232:233], v124 offset:34816
    ds_read_b64_tr_b16 a[234:235], v124 offset:35072
    ds_read_b64_tr_b16 a[236:237], v125 offset:2048
    ds_read_b64_tr_b16 a[238:239], v125 offset:2304
    s_waitcnt lgkmcnt(12)
    s_nop 0
    v_mfma_f32_32x32x16_bf16 a[152:167], a[248:251], a[200:203], 0
    v_mfma_f32_32x32x16_bf16 a[168:183], a[248:251], a[204:207], 0
    v_mfma_f32_32x32x16_bf16 a[184:199], a[248:251], a[208:211], 0
    v_dot2_f32_bf16 v80, v128, s59, v80
    v_dot2_f32_bf16 v82, v128, v128, v82
    v_dot2_f32_bf16 v81, v129, s59, v81
    v_dot2_f32_bf16 v83, v129, v129, v83
    v_dot2_f32_bf16 v80, v130, s59, v80
    v_dot2_f32_bf16 v82, v130, v130, v82
    v_dot2_f32_bf16 v81, v131, s59, v81
    v_dot2_f32_bf16 v83, v131, v131, v83
    v_dot2_f32_bf16 v80, v132, s59, v80
    v_dot2_f32_bf16 v82, v132, v132, v82
    v_dot2_f32_bf16 v81, v133, s59, v81
    v_dot2_f32_bf16 v83, v133, v133, v83
    v_dot2_f32_bf16 v80, v134, s59, v80
    v_dot2_f32_bf16 v82, v134, v134, v82
    v_dot2_f32_bf16 v81, v135, s59, v81
    v_dot2_f32_bf16 v83, v135, v135, v83
    v_dot2_f32_bf16 v80, v136, s59, v80
    v_dot2_f32_bf16 v82, v136, v136, v82
    v_dot2_f32_bf16 v81, v137, s59, v81
    v_dot2_f32_bf16 v83, v137, v137, v83
    v_dot2_f32_bf16 v80, v138, s59, v80
    v_dot2_f32_bf16 v82, v138, v138, v82
    v_dot2_f32_bf16 v81, v139, s59, v81
    v_dot2_f32_bf16 v83, v139, v139, v83
    v_dot2_f32_bf16 v80, v140, s59, v80
    v_dot2_f32_bf16 v82, v140, v140, v82
    v_dot2_f32_bf16 v81, v141, s59, v81
    v_dot2_f32_bf16 v83, v141, v141, v83
    v_dot2_f32_bf16 v80, v142, s59, v80
    v_dot2_f32_bf16 v82, v142, v142, v82
    v_dot2_f32_bf16 v81, v143, s59, v81
    v_dot2_f32_bf16 v83, v143, v143, v83
    s_waitcnt lgkmcnt(8)
    v_mfma_f32_32x32x16_bf16 v[32:47], v[128:131], a[216:219], 0
    ds_read_b64_tr_b16 a[240:241], v124 offset:35840
    ds_read_b64_tr_b16 a[242:243], v124 offset:36096
    ds_read_b64_tr_b16 a[244:245], v125 offset:3072
    ds_read_b64_tr_b16 a[246:247], v125 offset:3328
    v_mfma_f32_32x32x16_bf16 v[48:63], v[128:131], a[220:223], 0
    s_waitcnt vmcnt(1)
    s_barrier
    s_add_u32 s81, s73, 2
    s_and_b32 s81, s81, 7
    s_lshl_b32 s63, s81, 7
    s_add_u32 m0, s57, 8192
    s_mul_i32 s68, s81, 196608
    buffer_load_dwordx4 v127, s[4:7], s63 offen lds
    buffer_load_dwordx4 v96, s[4:7], s63 offen offset:1024 lds
    s_add_u32 m0, s57, 10240
    s_add_u32 s63, s63, 16384
    buffer_load_dwordx4 v127, s[4:7], s63 offen lds
    buffer_load_dwordx4 v96, s[4:7], s63 offen offset:1024 lds
    s_add_u32 m0, s69, 39936
    s_nop 0
    buffer_load_dwordx4 v126, s[8:11], s68 offen offset:1024 lds
    s_add_u32 m0, s69, 71680
    s_nop 0
    buffer_load_dwordx4 v126, s[8:11], s68 offen offset:2048 lds
    s_add_u32 m0, s69, 8192
    s_nop 0
    buffer_load_dwordx4 v126, s[8:11], s68 offen offset:0 lds
    s_waitcnt lgkmcnt(8)
    v_mfma_f32_32x32x16_bf16 v[32:47], v[132:135], a[224:227], v[32:47]
    ds_read_b64_tr_b16 a[216:217], v124 offset:36864
    ds_read_b64_tr_b16 a[218:219], v124 offset:37120
    ds_read_b64_tr_b16 a[220:221], v125 offset:4096
    ds_read_b64_tr_b16 a[222:223], v125 offset:4352
    ds_read_b64_tr_b16 a[200:201], v97 offset:36864
    ds_read_b64_tr_b16 a[202:203], v97 offset:37120
    ds_read_b64_tr_b16 a[204:205], v98 offset:4096
    ds_read_b64_tr_b16 a[206:207], v98 offset:4352
    ds_read_b64_tr_b16 a[208:209], v97 offset:4096
    ds_read_b64_tr_b16 a[210:211], v97 offset:4352
    v_mfma_f32_32x32x16_bf16 v[48:63], v[132:135], a[228:231], v[48:63]
    s_add_u32 s81, s73, 3
    s_and_b32 s81, s81, 7
    s_lshl_b32 s63, s81, 103
    s_add_u32 m0, s57, 12288
    s_mul_i32 s68, s81, 196608
    buffer_load_dwordx4 v127, s[4:7], s63 offen lds
    buffer_load_dwordx4 v96, s[4:7], s63 offen offset:1024 lds
    s_add_u32 m0, s57, 14336
    s_add_u32 s63, s63, 16384
    buffer_load_dwordx4 v127, s[4:7], s63 offen lds
    buffer_load_dwordx4 v96, s[4:7], s63 offen offset:1024 lds
    s_add_u32 m0, s69, 44032
    s_nop 0
    buffer_load_dwordx4 v126, s[8:11], s68 offen offset:1024 lds
    s_add_u32 m0, s69, 75776
    s_nop 0
    buffer_load_dwordx4 v126, s[8:11], s68 offen offset:2048 lds
    s_add_u32 m0, s69, 12288
    s_nop 0
    buffer_load_dwordx4 v126, s[8:11], s68 offen offset:0 lds
    s_waitcnt lgkmcnt(14)
    v_mfma_f32_32x32x16_bf16 v[32:47], v[136:139], a[232:235], v[32:47]
    ds_read_b64_tr_b16 a[224:225], v124 offset:37888
    ds_read_b64_tr_b16 a[226:227], v124 offset:38144
    ds_read_b64_tr_b16 a[228:229], v125 offset:5120
    ds_read_b64_tr_b16 a[230:231], v125 offset:5376
    ds_read_b128 v[144:147], v88 offset:4096
    ds_read_b128 v[148:151], v89 offset:4096
    ds_read_b128 v[152:155], v90 offset:4096
    ds_read_b128 v[156:159], v91 offset:4096
    v_mfma_f32_32x32x16_bf16 v[48:63], v[136:139], a[236:239], v[48:63]
    s_waitcnt lgkmcnt(15)
    v_mfma_f32_32x32x16_bf16 v[32:47], v[140:143], a[240:243], v[32:47]
    ds_read_b64_tr_b16 a[232:233], v124 offset:38912
    ds_read_b64_tr_b16 a[234:235], v124 offset:39168
    ds_read_b64_tr_b16 a[236:237], v125 offset:6144
    ds_read_b64_tr_b16 a[238:239], v125 offset:6400
    v_mfma_f32_32x32x16_bf16 v[48:63], v[140:143], a[244:247], v[48:63]
    s_waitcnt lgkmcnt(12)
    v_mfma_f32_32x32x16_bf16 a[152:167], a[248:251], a[200:203], a[152:167]
    v_mfma_f32_32x32x16_bf16 a[168:183], a[248:251], a[204:207], a[168:183]
    v_mfma_f32_32x32x16_bf16 a[184:199], a[248:251], a[208:211], a[184:199]
    s_waitcnt lgkmcnt(7)
    v_dot2_f32_bf16 v80, v144, s59, v80
    v_dot2_f32_bf16 v82, v144, v144, v82
    v_dot2_f32_bf16 v81, v145, s59, v81
    v_dot2_f32_bf16 v83, v145, v145, v83
    v_dot2_f32_bf16 v80, v146, s59, v80
    v_dot2_f32_bf16 v82, v146, v146, v82
    v_dot2_f32_bf16 v81, v147, s59, v81
    v_dot2_f32_bf16 v83, v147, v147, v83
    s_waitcnt lgkmcnt(6)
    v_dot2_f32_bf16 v80, v148, s59, v80
    v_dot2_f32_bf16 v82, v148, v148, v82
    v_dot2_f32_bf16 v81, v149, s59, v81
    v_dot2_f32_bf16 v83, v149, v149, v83
    v_dot2_f32_bf16 v80, v150, s59, v80
    v_dot2_f32_bf16 v82, v150, v150, v82
    v_dot2_f32_bf16 v81, v151, s59, v81
    v_dot2_f32_bf16 v83, v151, v151, v83
    s_waitcnt lgkmcnt(5)
    v_dot2_f32_bf16 v80, v152, s59, v80
    v_dot2_f32_bf16 v82, v152, v152, v82
    v_dot2_f32_bf16 v81, v153, s59, v81
    v_dot2_f32_bf16 v83, v153, v153, v83
    v_dot2_f32_bf16 v80, v154, s59, v80
    v_dot2_f32_bf16 v82, v154, v154, v82
    v_dot2_f32_bf16 v81, v155, s59, v81
    v_dot2_f32_bf16 v83, v155, v155, v83
    s_waitcnt lgkmcnt(4)
    v_dot2_f32_bf16 v80, v156, s59, v80
    v_dot2_f32_bf16 v82, v156, v156, v82
    v_dot2_f32_bf16 v81, v157, s59, v81
    v_dot2_f32_bf16 v83, v157, v157, v83
    v_dot2_f32_bf16 v80, v158, s59, v80
    v_dot2_f32_bf16 v82, v158, v158, v82
    v_dot2_f32_bf16 v81, v159, s59, v81
    v_dot2_f32_bf16 v83, v159, v159, v83
    v_mfma_f32_32x32x16_bf16 v[32:47], v[144:147], a[216:219], v[32:47]
    ds_read_b64_tr_b16 a[240:241], v124 offset:39936
    ds_read_b64_tr_b16 a[242:243], v124 offset:40192
    ds_read_b64_tr_b16 a[244:245], v125 offset:7168
    ds_read_b64_tr_b16 a[246:247], v125 offset:7424
    v_mfma_f32_32x32x16_bf16 v[48:63], v[144:147], a[220:223], v[48:63]
    s_waitcnt vmcnt(7)
    s_barrier
    v_add_u32 v92, 1, v92
    v_and_b32 v92, 0x3fffffff, v92
    v_or_b32 v92, 0x40000000, v92
    s_nop 0
    v_readfirstlane_b32 s101, v92
    s_add_u32 s81, s73, 4
    s_and_b32 s81, s81, 7
    s_lshl_b32 s63, s81, 7
    s_add_u32 m0, s57, 0
    s_mul_i32 s68, s81, 196608
    buffer_load_dwordx4 v127, s[4:7], s63 offen lds
    buffer_load_dwordx4 v96, s[4:7], s63 offen offset:1024 lds
    s_add_u32 m0, s57, 2048
    s_add_u32 s63, s63, 16384
    buffer_load_dwordx4 v127, s[4:7], s63 offen lds
    buffer_load_dwordx4 v96, s[4:7], s63 offen offset:1024 lds
    s_add_u32 m0, s69, 48128
    s_nop 0
    s_nop 0
    buffer_load_dwordx4 v126, s[8:11], s68 offen offset:1024 lds
    s_add_u32 m0, s69, 79872
    s_nop 0
    buffer_load_dwordx4 v126, s[8:11], s68 offen offset:2048 lds
    s_add_u32 m0, s69, 16384
    s_nop 0
    buffer_load_dwordx4 v126, s[8:11], s68 offen offset:0 lds
    v_mfma_f32_32x32x16_bf16 v[32:47], v[148:151], a[224:227], v[32:47]
    ds_read_b64_tr_b16 a[216:217], v124 offset:40960
    ds_read_b64_tr_b16 a[218:219], v124 offset:41216
    ds_read_b64_tr_b16 a[220:221], v125 offset:8192
    ds_read_b64_tr_b16 a[222:223], v125 offset:8448
    ds_read_b64_tr_b16 a[200:201], v97 offset:40960
    ds_read_b64_tr_b16 a[202:203], v97 offset:41216
    ds_read_b64_tr_b16 a[204:205], v98 offset:8192
    ds_read_b64_tr_b16 a[206:207], v98 offset:8448
    ds_read_b64_tr_b16 a[208:209], v97 offset:8192
    ds_read_b64_tr_b16 a[210:211], v97 offset:8448
    v_mfma_f32_32x32x16_bf16 v[48:63], v[148:151], a[228:231], v[48:63]
    s_add_u32 s81, s73, 5
    s_and_b32 s81, s81, 7
    s_lshl_b32 s63, s81, 103
    s_add_u32 m0, s57, 4096
    s_mul_i32 s68, s81, 196608
    buffer_load_dwordx4 v127, s[4:7], s63 offen lds
    buffer_load_dwordx4 v96, s[4:7], s63 offen offset:1024 lds
    s_add_u32 m0, s57, 6144
    s_add_u32 s63, s63, 16384
    buffer_load_dwordx4 v127, s[4:7], s63 offen lds
    buffer_load_dwordx4 v96, s[4:7], s63 offen offset:1024 lds
    s_add_u32 m0, s69, 52224
    s_nop 0
    buffer_load_dwordx4 v126, s[8:11], s68 offen offset:1024 lds
    s_add_u32 m0, s69, 83968
    s_nop 0
    buffer_load_dwordx4 v126, s[8:11], s68 offen offset:2048 lds
    s_add_u32 m0, s69, 20480
    s_nop 0
    buffer_load_dwordx4 v126, s[8:11], s68 offen offset:0 lds
    s_waitcnt lgkmcnt(14)
    v_mfma_f32_32x32x16_bf16 v[32:47], v[152:155], a[232:235], v[32:47]
    ds_read_b64_tr_b16 a[224:225], v124 offset:41984
    ds_read_b64_tr_b16 a[226:227], v124 offset:42240
    ds_read_b64_tr_b16 a[228:229], v125 offset:9216
    ds_read_b64_tr_b16 a[230:231], v125 offset:9472
    ds_read_b128 v[160:163], v88 offset:8192
    ds_read_b128 v[164:167], v89 offset:8192
    ds_read_b128 v[168:171], v90 offset:8192
    ds_read_b128 v[172:175], v91 offset:8192
    v_mfma_f32_32x32x16_bf16 v[48:63], v[152:155], a[236:239], v[48:63]
    s_waitcnt lgkmcnt(15)
    s_nop 0
    v_mfma_f32_32x32x16_bf16 v[32:47], v[156:159], a[240:243], v[32:47]
    ds_read_b64_tr_b16 a[232:233], v124 offset:43008
    ds_read_b64_tr_b16 a[234:235], v124 offset:43264
    ds_read_b64_tr_b16 a[236:237], v125 offset:10240
    ds_read_b64_tr_b16 a[238:239], v125 offset:10496
    v_mfma_f32_32x32x16_bf16 v[48:63], v[156:159], a[244:247], v[48:63]
    s_waitcnt lgkmcnt(12)
    v_mfma_f32_32x32x16_bf16 a[152:167], a[248:251], a[200:203], a[152:167]
    v_mfma_f32_32x32x16_bf16 a[168:183], a[248:251], a[204:207], a[168:183]
    v_mfma_f32_32x32x16_bf16 a[184:199], a[248:251], a[208:211], a[184:199]
    s_waitcnt lgkmcnt(7)
    v_dot2_f32_bf16 v80, v160, s59, v80
    v_dot2_f32_bf16 v82, v160, v160, v82
    v_dot2_f32_bf16 v81, v161, s59, v81
    v_dot2_f32_bf16 v83, v161, v161, v83
    v_dot2_f32_bf16 v80, v162, s59, v80
    v_dot2_f32_bf16 v82, v162, v162, v82
    v_dot2_f32_bf16 v81, v163, s59, v81
    v_dot2_f32_bf16 v83, v163, v163, v83
    s_waitcnt lgkmcnt(6)
    v_dot2_f32_bf16 v80, v164, s59, v80
    v_dot2_f32_bf16 v82, v164, v164, v82
    v_dot2_f32_bf16 v81, v165, s59, v81
    v_dot2_f32_bf16 v83, v165, v165, v83
    v_dot2_f32_bf16 v80, v166, s59, v80
    v_dot2_f32_bf16 v82, v166, v166, v82
    v_dot2_f32_bf16 v81, v167, s59, v81
    v_dot2_f32_bf16 v83, v167, v167, v83
    s_waitcnt lgkmcnt(5)
    v_dot2_f32_bf16 v80, v168, s59, v80
    v_dot2_f32_bf16 v82, v168, v168, v82
    v_dot2_f32_bf16 v81, v169, s59, v81
    v_dot2_f32_bf16 v83, v169, v169, v83
    v_dot2_f32_bf16 v80, v170, s59, v80
    v_dot2_f32_bf16 v82, v170, v170, v82
    v_dot2_f32_bf16 v81, v171, s59, v81
    v_dot2_f32_bf16 v83, v171, v171, v83
    s_waitcnt lgkmcnt(4)
    s_nop 0
    v_dot2_f32_bf16 v80, v172, s59, v80
    v_dot2_f32_bf16 v82, v172, v172, v82
    v_dot2_f32_bf16 v81, v173, s59, v81
    v_dot2_f32_bf16 v83, v173, v173, v83
    v_dot2_f32_bf16 v80, v174, s59, v80
    v_dot2_f32_bf16 v82, v174, v174, v82
    v_dot2_f32_bf16 v81, v175, s59, v81
    v_dot2_f32_bf16 v83, v175, v175, v83
    v_mfma_f32_32x32x16_bf16 v[32:47], v[160:163], a[216:219], v[32:47]
    ds_read_b64_tr_b16 a[240:241], v124 offset:44032
    ds_read_b64_tr_b16 a[242:243], v124 offset:44288
    ds_read_b64_tr_b16 a[244:245], v125 offset:11264
    ds_read_b64_tr_b16 a[246:247], v125 offset:11520
    v_mfma_f32_32x32x16_bf16 v[48:63], v[160:163], a[220:223], v[48:63]
    s_waitcnt vmcnt(14)
    s_barrier
    s_add_u32 s81, s73, 6
    s_and_b32 s81, s81, 7
    s_lshl_b32 s63, s81, 103
    s_add_u32 m0, s57, 8192
    s_mul_i32 s68, s81, 196608
    buffer_load_dwordx4 v127, s[4:7], s63 offen lds
    buffer_load_dwordx4 v96, s[4:7], s63 offen offset:1024 lds
    s_add_u32 m0, s57, 10240
    s_add_u32 s63, s63, 16384
    buffer_load_dwordx4 v127, s[4:7], s63 offen lds
    buffer_load_dwordx4 v96, s[4:7], s63 offen offset:1024 lds
    s_add_u32 m0, s69, 56320
    s_nop 0
    buffer_load_dwordx4 v126, s[8:11], s68 offen offset:1024 lds
    s_add_u32 m0, s69, 88064
    s_nop 0
    buffer_load_dwordx4 v126, s[8:11], s68 offen offset:2048 lds
    s_add_u32 m0, s69, 24576
    s_nop 0
    s_nop 0
    buffer_load_dwordx4 v126, s[8:11], s68 offen offset:0 lds
    v_mfma_f32_32x32x16_bf16 v[32:47], v[164:167], a[224:227], v[32:47]
    ds_read_b64_tr_b16 a[216:217], v124 offset:45056
    ds_read_b64_tr_b16 a[218:219], v124 offset:45312
    ds_read_b64_tr_b16 a[220:221], v125 offset:12288
    ds_read_b64_tr_b16 a[222:223], v125 offset:12544
    ds_read_b64_tr_b16 a[200:201], v97 offset:45056
    ds_read_b64_tr_b16 a[202:203], v97 offset:45312
    ds_read_b64_tr_b16 a[204:205], v98 offset:12288
    ds_read_b64_tr_b16 a[206:207], v98 offset:12544
    ds_read_b64_tr_b16 a[208:209], v97 offset:12288
    ds_read_b64_tr_b16 a[210:211], v97 offset:12544
    v_mfma_f32_32x32x16_bf16 v[48:63], v[164:167], a[228:231], v[48:63]
    s_waitcnt lgkmcnt(14)
    s_nop 0
    v_mfma_f32_32x32x16_bf16 v[32:47], v[168:171], a[232:235], v[32:47]
    ds_read_b64_tr_b16 a[224:225], v124 offset:46080
    ds_read_b64_tr_b16 a[226:227], v124 offset:46336
    ds_read_b64_tr_b16 a[228:229], v125 offset:13312
    ds_read_b64_tr_b16 a[230:231], v125 offset:13568
    ds_read_b128 v[176:179], v88 offset:12288
    ds_read_b128 v[180:183], v89 offset:12288
    ds_read_b128 v[184:187], v90 offset:12288
    ds_read_b128 v[188:191], v91 offset:12288
    v_mfma_f32_32x32x16_bf16 v[48:63], v[168:171], a[236:239], v[48:63]
    s_mul_i32 s62, s61, 3072
    s_mul_i32 s67, s3, 768
    s_add_u32 s62, s62, s67
    s_add_u32 s62, s62, 0x166000
    s_mov_b32 exec_lo, 0xffffffff
    s_mov_b32 exec_hi, 0xffff
    buffer_store_dwordx4 v[100:103], v1, s[24:27], s62 offen offset:0 sc1
    s_mov_b64 exec, -1
    s_mov_b32 exec_lo, 0xffffffff
    s_mov_b32 exec_hi, 0xff
    buffer_store_dwordx4 v[100:103], v1, s[24:27], s84 offen offset:0 sc1
    s_mul_i32 s62, s79, 384
    s_add_u32 s62, s62, 0x2000
    s_cmp_ge_u32 s79, 64
    s_cselect_b32 s62, 0x10000000, s62
    s_mov_b32 exec_lo, 0xffffff
    s_mov_b32 exec_hi, 0x0
    buffer_store_dwordx4 v[100:103], v1, s[24:27], s62 offen offset:0 sc1
    s_mov_b64 exec, -1
    v_lshrrev_b32 v4, 3, v0
    s_add_u32 s62, s90, 0xe80
    v_mov_b32_e64 v5, s62
    s_add_u32 s62, s92, 0x380
    v_mov_b32 v6, s62
    v_cmp_eq_u32 vcc, 1, v4
    s_nop 1
    v_cndmask_b32 v5, v5, v6, vcc
    s_add_u32 s62, s92, 0x780
    v_mov_b32 v6, s62
    v_cmp_eq_u32 vcc, 2, v4
    s_nop 1
    v_cndmask_b32 v5, v5, v6, vcc
    s_add_u32 s62, s90, 0x200e80
    v_mov_b32 v6, s62
    v_cmp_eq_u32 vcc, 3, v4
    s_nop 1
    v_cndmask_b32 v5, v5, v6, vcc
    s_add_u32 s62, s92, 0x200380
    v_mov_b32 v6, s62
    v_cmp_eq_u32 vcc, 4, v4
    s_nop 1
    v_cndmask_b32 v5, v5, v6, vcc
    s_add_u32 s62, s92, 0x200780
    v_mov_b32 v6, s62
    v_cmp_eq_u32 vcc, 5, v4
    s_nop 1
    v_cndmask_b32 v5, v5, v6, vcc
    s_add_u32 s62, s85, 0x200780
    v_mov_b32_e64 v6, s62
    v_cmp_eq_u32 vcc, 6, v4
    s_nop 1
    v_cndmask_b32_e64 v5, v5, v6, vcc
    s_add_u32 s62, s94, 0x380
    v_mov_b32_e64 v6, s62
    v_cmp_eq_u32 vcc, 7, v4
    s_nop 1
    v_cndmask_b32_e64 v5, v5, v6, vcc
    v_and_b32 v4, 7, v0
    v_lshl_add_u32 v5, v4, 4, v5
    buffer_store_dwordx4 v[100:103], v5, s[24:27], 0 offen sc1
    s_waitcnt lgkmcnt(15)
    v_mfma_f32_32x32x16_bf16 v[32:47], v[172:175], a[240:243], v[32:47]
    ds_read_b64_tr_b16 a[232:233], v124 offset:47104
    ds_read_b64_tr_b16 a[234:235], v124 offset:47360
    ds_read_b64_tr_b16 a[236:237], v125 offset:14336
    ds_read_b64_tr_b16 a[238:239], v125 offset:14592
    v_mfma_f32_32x32x16_bf16 v[48:63], v[172:175], a[244:247], v[48:63]
    s_waitcnt lgkmcnt(12)
    v_mfma_f32_32x32x16_bf16 a[152:167], a[248:251], a[200:203], a[152:167]
    v_mfma_f32_32x32x16_bf16 a[168:183], a[248:251], a[204:207], a[168:183]
    v_mfma_f32_32x32x16_bf16 a[184:199], a[248:251], a[208:211], a[184:199]
    s_waitcnt lgkmcnt(7)
    v_dot2_f32_bf16 v80, v176, s59, v80
    v_dot2_f32_bf16 v82, v176, v176, v82
    v_dot2_f32_bf16 v81, v177, s59, v81
    v_dot2_f32_bf16 v83, v177, v177, v83
    v_dot2_f32_bf16 v80, v178, s59, v80
    v_dot2_f32_bf16 v82, v178, v178, v82
    v_dot2_f32_bf16 v81, v179, s59, v81
    v_dot2_f32_bf16 v83, v179, v179, v83
    s_waitcnt lgkmcnt(6)
    v_dot2_f32_bf16 v80, v180, s59, v80
    v_dot2_f32_bf16 v82, v180, v180, v82
    v_dot2_f32_bf16 v81, v181, s59, v81
    v_dot2_f32_bf16 v83, v181, v181, v83
    v_dot2_f32_bf16 v80, v182, s59, v80
    v_dot2_f32_bf16 v82, v182, v182, v82
    v_dot2_f32_bf16 v81, v183, s59, v81
    v_dot2_f32_bf16 v83, v183, v183, v83
    s_waitcnt lgkmcnt(5)
    v_dot2_f32_bf16 v80, v184, s59, v80
    v_dot2_f32_bf16 v82, v184, v184, v82
    v_dot2_f32_bf16 v81, v185, s59, v81
    v_dot2_f32_bf16 v83, v185, v185, v83
    v_dot2_f32_bf16 v80, v186, s59, v80
    v_dot2_f32_bf16 v82, v186, v186, v82
    v_dot2_f32_bf16 v81, v187, s59, v81
    v_dot2_f32_bf16 v83, v187, v187, v83
    s_waitcnt lgkmcnt(4)
    s_nop 0
    v_dot2_f32_bf16 v80, v188, s59, v80
    v_dot2_f32_bf16 v82, v188, v188, v82
    v_dot2_f32_bf16 v81, v189, s59, v81
    v_dot2_f32_bf16 v83, v189, v189, v83
    v_dot2_f32_bf16 v80, v190, s59, v80
    v_dot2_f32_bf16 v82, v190, v190, v82
    v_dot2_f32_bf16 v81, v191, s59, v81
    v_dot2_f32_bf16 v83, v191, v191, v83
    v_mfma_f32_32x32x16_bf16 v[32:47], v[176:179], a[216:219], v[32:47]
    ds_read_b64_tr_b16 a[240:241], v124 offset:48128
    ds_read_b64_tr_b16 a[242:243], v124 offset:48384
    ds_read_b64_tr_b16 a[244:245], v125 offset:15360
    ds_read_b64_tr_b16 a[246:247], v125 offset:15616
    v_mfma_f32_32x32x16_bf16 v[48:63], v[176:179], a[220:223], v[48:63]
    s_waitcnt vmcnt(18)
    s_barrier
    s_add_u32 s81, s73, 7
    s_and_b32 s81, s81, 7
    s_lshl_b32 s63, s81, 103
    s_add_u32 m0, s57, 12288
    s_mul_i32 s68, s81, 196608
    buffer_load_dwordx4 v127, s[4:7], s63 offen lds
    buffer_load_dwordx4 v96, s[4:7], s63 offen offset:1024 lds
    s_add_u32 m0, s57, 14336
    s_add_u32 s63, s63, 16384
    buffer_load_dwordx4 v127, s[4:7], s63 offen lds
    buffer_load_dwordx4 v96, s[4:7], s63 offen offset:1024 lds
    s_add_u32 m0, s69, 60416
    s_nop 0
    buffer_load_dwordx4 v126, s[8:11], s68 offen offset:1024 lds
    s_add_u32 m0, s69, 92160
    s_nop 0
    buffer_load_dwordx4 v126, s[8:11], s68 offen offset:2048 lds
    s_add_u32 m0, s69, 28672
    s_nop 0
    s_nop 0
    buffer_load_dwordx4 v126, s[8:11], s68 offen offset:0 lds
    v_mfma_f32_32x32x16_bf16 v[32:47], v[180:183], a[224:227], v[32:47]
    ds_read_b64_tr_b16 a[216:217], v124 offset:49152
    ds_read_b64_tr_b16 a[218:219], v124 offset:49408
    ds_read_b64_tr_b16 a[220:221], v125 offset:16384
    ds_read_b64_tr_b16 a[222:223], v125 offset:16640
    ds_read_b64_tr_b16 a[200:201], v97 offset:49152
    ds_read_b64_tr_b16 a[202:203], v97 offset:49408
    ds_read_b64_tr_b16 a[204:205], v98 offset:16384
    ds_read_b64_tr_b16 a[206:207], v98 offset:16640
    ds_read_b64_tr_b16 a[208:209], v97 offset:16384
    ds_read_b64_tr_b16 a[210:211], v97 offset:16640
    v_mfma_f32_32x32x16_bf16 v[48:63], v[180:183], a[228:231], v[48:63]
    s_waitcnt lgkmcnt(14)
    s_nop 0
    v_mfma_f32_32x32x16_bf16 v[32:47], v[184:187], a[232:235], v[32:47]
    ds_read_b64_tr_b16 a[224:225], v124 offset:50176
    ds_read_b64_tr_b16 a[226:227], v124 offset:50432
    ds_read_b64_tr_b16 a[228:229], v125 offset:17408
    ds_read_b64_tr_b16 a[230:231], v125 offset:17664
    ds_read_b128 v[192:195], v88 offset:0
    ds_read_b128 v[196:199], v89 offset:0
    ds_read_b128 v[200:203], v90 offset:0
    ds_read_b128 v[204:207], v91 offset:0
    v_mfma_f32_32x32x16_bf16 v[48:63], v[184:187], a[236:239], v[48:63]
    buffer_store_dwordx4 v[100:103], v1, s[24:27], s85 offen offset:0 sc1
    buffer_store_dwordx4 v[100:103], v1, s[24:27], s85 offen offset:1024 sc1
    s_waitcnt lgkmcnt(15)
    v_mfma_f32_32x32x16_bf16 v[32:47], v[188:191], a[240:243], v[32:47]
    ds_read_b64_tr_b16 a[232:233], v124 offset:51200
    ds_read_b64_tr_b16 a[234:235], v124 offset:51456
    ds_read_b64_tr_b16 a[236:237], v125 offset:18432
    ds_read_b64_tr_b16 a[238:239], v125 offset:18688
    v_mfma_f32_32x32x16_bf16 v[48:63], v[188:191], a[244:247], v[48:63]
    s_lshl_b32 s62, s48, 6
    s_lshl_b32 s67, s55, 5
    s_add_u32 s62, s62, s67
    v_and_b32 v4, 31, v0
    v_add_u32 v4, s62, v4
    v_lshlrev_b32_e64 v5, 1, v4
    buffer_load_ushort v19, v5, s[40:43], 0 offen
    v_lshlrev_b32_e64 v4, 10, v4
    v_lshl_add_u32 v22, v21, 4, v4
    s_lshl_b32 s62, s49, 7
    s_lshl_b32 s67, s56, 5
    s_add_u32 s62, s62, s67
    v_add_u32 v22, s62, v22
    buffer_load_dwordx4 v[8:11], v22, s[4:7], 0 offen
    buffer_load_dwordx4 v[12:15], v22, s[4:7], 0 offen offset:64
    s_lshl_b32 s66, s82, 7
    v_min_u32 v4, 63, v0
    v_lshrrev_b32_e64 v5, 2, v4
    v_mul_u32_u24 v5, 3584, v5
    v_and_b32 v4, 3, v4
    v_lshl_add_u32 v4, v4, 7, v5
    s_mul_i32 s67, s83, 57344
    s_add_u32 s66, s66, s67
    buffer_load_dword a252, v4, s[44:47], s66 offen
    s_waitcnt lgkmcnt(12)
    v_mfma_f32_32x32x16_bf16 a[152:167], a[248:251], a[200:203], a[152:167]
    v_mfma_f32_32x32x16_bf16 a[168:183], a[248:251], a[204:207], a[168:183]
    v_mfma_f32_32x32x16_bf16 a[184:199], a[248:251], a[208:211], a[184:199]
    s_waitcnt lgkmcnt(7)
    v_dot2_f32_bf16 v80, v192, s59, v80
    v_dot2_f32_bf16 v82, v192, v192, v82
    v_dot2_f32_bf16 v81, v193, s59, v81
    v_dot2_f32_bf16 v83, v193, v193, v83
    v_dot2_f32_bf16 v80, v194, s59, v80
    v_dot2_f32_bf16 v82, v194, v194, v82
    v_dot2_f32_bf16 v81, v195, s59, v81
    v_dot2_f32_bf16 v83, v195, v195, v83
    s_waitcnt lgkmcnt(6)
    v_dot2_f32_bf16 v80, v196, s59, v80
    v_dot2_f32_bf16 v82, v196, v196, v82
    v_dot2_f32_bf16 v81, v197, s59, v81
    v_dot2_f32_bf16 v83, v197, v197, v83
    v_dot2_f32_bf16 v80, v198, s59, v80
    v_dot2_f32_bf16 v82, v198, v198, v82
    v_dot2_f32_bf16 v81, v199, s59, v81
    v_dot2_f32_bf16 v83, v199, v199, v83
    s_waitcnt lgkmcnt(5)
    v_dot2_f32_bf16 v80, v200, s59, v80
    v_dot2_f32_bf16 v82, v200, v200, v82
    v_dot2_f32_bf16 v81, v201, s59, v81
    v_dot2_f32_bf16 v83, v201, v201, v83
    v_dot2_f32_bf16 v80, v202, s59, v80
    v_dot2_f32_bf16 v82, v202, v202, v82
    v_dot2_f32_bf16 v81, v203, s59, v81
    v_dot2_f32_bf16 v83, v203, v203, v83
    s_waitcnt lgkmcnt(4)
    s_nop 0
    v_dot2_f32_bf16 v80, v204, s59, v80
    v_dot2_f32_bf16 v82, v204, v204, v82
    v_dot2_f32_bf16 v81, v205, s59, v81
    v_dot2_f32_bf16 v83, v205, v205, v83
    v_dot2_f32_bf16 v80, v206, s59, v80
    v_dot2_f32_bf16 v82, v206, v206, v82
    v_dot2_f32_bf16 v81, v207, s59, v81
    v_dot2_f32_bf16 v83, v207, v207, v83
    v_mfma_f32_32x32x16_bf16 v[32:47], v[192:195], a[216:219], v[32:47]
    ds_read_b64_tr_b16 a[240:241], v124 offset:52224
    ds_read_b64_tr_b16 a[242:243], v124 offset:52480
    ds_read_b64_tr_b16 a[244:245], v125 offset:19456
    ds_read_b64_tr_b16 a[246:247], v125 offset:19712
    v_mfma_f32_32x32x16_bf16 v[48:63], v[192:195], a[220:223], v[48:63]
    s_waitcnt vmcnt(24)
    s_barrier
    v_mfma_f32_32x32x16_bf16 v[32:47], v[196:199], a[224:227], v[32:47]
    ds_read_b64_tr_b16 a[216:217], v124 offset:53248
    ds_read_b64_tr_b16 a[218:219], v124 offset:53504
    ds_read_b64_tr_b16 a[220:221], v125 offset:20480
    ds_read_b64_tr_b16 a[222:223], v125 offset:20736
    ds_read_b64_tr_b16 a[200:201], v97 offset:53248
    ds_read_b64_tr_b16 a[202:203], v97 offset:53504
    ds_read_b64_tr_b16 a[204:205], v98 offset:20480
    ds_read_b64_tr_b16 a[206:207], v98 offset:20736
    ds_read_b64_tr_b16 a[208:209], v97 offset:20480
    ds_read_b64_tr_b16 a[210:211], v97 offset:20736
    v_mfma_f32_32x32x16_bf16 v[48:63], v[196:199], a[228:231], v[48:63]
    s_waitcnt lgkmcnt(14)
    v_mfma_f32_32x32x16_bf16 v[32:47], v[200:203], a[232:235], v[32:47]
    ds_read_b64_tr_b16 a[224:225], v124 offset:54272
    ds_read_b64_tr_b16 a[226:227], v124 offset:54528
    ds_read_b64_tr_b16 a[228:229], v125 offset:21504
    ds_read_b64_tr_b16 a[230:231], v125 offset:21760
    ds_read_b128 v[208:211], v88 offset:4096
    ds_read_b128 v[212:215], v89 offset:4096
    ds_read_b128 v[216:219], v90 offset:4096
    ds_read_b128 v[220:223], v91 offset:4096
    v_mfma_f32_32x32x16_bf16 v[48:63], v[200:203], a[236:239], v[48:63]
    s_waitcnt lgkmcnt(15)
    v_mfma_f32_32x32x16_bf16 v[32:47], v[204:207], a[240:243], v[32:47]
    ds_read_b64_tr_b16 a[232:233], v124 offset:55296
    ds_read_b64_tr_b16 a[234:235], v124 offset:55552
    ds_read_b64_tr_b16 a[236:237], v125 offset:22528
    ds_read_b64_tr_b16 a[238:239], v125 offset:22784
    v_mfma_f32_32x32x16_bf16 v[48:63], v[204:207], a[244:247], v[48:63]
    s_waitcnt lgkmcnt(12)
    v_mfma_f32_32x32x16_bf16 a[152:167], a[248:251], a[200:203], a[152:167]
    v_mfma_f32_32x32x16_bf16 a[168:183], a[248:251], a[204:207], a[168:183]
    v_mfma_f32_32x32x16_bf16 a[184:199], a[248:251], a[208:211], a[184:199]
    s_waitcnt lgkmcnt(7)
    v_dot2_f32_bf16 v80, v208, s59, v80
    v_dot2_f32_bf16 v82, v208, v208, v82
    v_dot2_f32_bf16 v81, v209, s59, v81
    v_dot2_f32_bf16 v83, v209, v209, v83
    v_dot2_f32_bf16 v80, v210, s59, v80
    v_dot2_f32_bf16 v82, v210, v210, v82
    v_dot2_f32_bf16 v81, v211, s59, v81
    v_dot2_f32_bf16 v83, v211, v211, v83
    s_waitcnt lgkmcnt(6)
    v_dot2_f32_bf16 v80, v212, s59, v80
    v_dot2_f32_bf16 v82, v212, v212, v82
    v_dot2_f32_bf16 v81, v213, s59, v81
    v_dot2_f32_bf16 v83, v213, v213, v83
    v_dot2_f32_bf16 v80, v214, s59, v80
    v_dot2_f32_bf16 v82, v214, v214, v82
    v_dot2_f32_bf16 v81, v215, s59, v81
    v_dot2_f32_bf16 v83, v215, v215, v83
    s_waitcnt lgkmcnt(5)
    v_dot2_f32_bf16 v80, v216, s59, v80
    v_dot2_f32_bf16 v82, v216, v216, v82
    v_dot2_f32_bf16 v81, v217, s59, v81
    v_dot2_f32_bf16 v83, v217, v217, v83
    v_dot2_f32_bf16 v80, v218, s59, v80
    v_dot2_f32_bf16 v82, v218, v218, v82
    v_dot2_f32_bf16 v81, v219, s59, v81
    v_dot2_f32_bf16 v83, v219, v219, v83
    s_waitcnt lgkmcnt(4)
    s_nop 0
    v_dot2_f32_bf16 v80, v220, s59, v80
    v_dot2_f32_bf16 v82, v220, v220, v82
    v_dot2_f32_bf16 v81, v221, s59, v81
    v_dot2_f32_bf16 v83, v221, v221, v83
    v_dot2_f32_bf16 v80, v222, s59, v80
    v_dot2_f32_bf16 v82, v222, v222, v82
    v_dot2_f32_bf16 v81, v223, s59, v81
    v_dot2_f32_bf16 v83, v223, v223, v83
    v_mfma_f32_32x32x16_bf16 v[32:47], v[208:211], a[216:219], v[32:47]
    ds_read_b64_tr_b16 a[240:241], v124 offset:56320
    ds_read_b64_tr_b16 a[242:243], v124 offset:56576
    ds_read_b64_tr_b16 a[244:245], v125 offset:23552
    ds_read_b64_tr_b16 a[246:247], v125 offset:23808
    v_mfma_f32_32x32x16_bf16 v[48:63], v[208:211], a[220:223], v[48:63]
    s_waitcnt vmcnt(17)
    s_barrier
    v_mfma_f32_32x32x16_bf16 v[32:47], v[212:215], a[224:227], v[32:47]
    ds_read_b64_tr_b16 a[216:217], v124 offset:57344
    ds_read_b64_tr_b16 a[218:219], v124 offset:57600
    ds_read_b64_tr_b16 a[220:221], v125 offset:24576
    ds_read_b64_tr_b16 a[222:223], v125 offset:24832
    ds_read_b64_tr_b16 a[200:201], v97 offset:57344
    ds_read_b64_tr_b16 a[202:203], v97 offset:57600
    ds_read_b64_tr_b16 a[204:205], v98 offset:24576
    ds_read_b64_tr_b16 a[206:207], v98 offset:24832
    ds_read_b64_tr_b16 a[208:209], v97 offset:24576
    ds_read_b64_tr_b16 a[210:211], v97 offset:24832
    v_mfma_f32_32x32x16_bf16 v[48:63], v[212:215], a[228:231], v[48:63]
    s_waitcnt lgkmcnt(14)
    v_mfma_f32_32x32x16_bf16 v[32:47], v[216:219], a[232:235], v[32:47]
    ds_read_b64_tr_b16 a[224:225], v124 offset:58368
    ds_read_b64_tr_b16 a[226:227], v124 offset:58624
    ds_read_b64_tr_b16 a[228:229], v125 offset:25600
    ds_read_b64_tr_b16 a[230:231], v125 offset:25856
    ds_read_b128 v[224:227], v88 offset:8192
    ds_read_b128 v[228:231], v89 offset:8192
    ds_read_b128 v[232:235], v90 offset:8192
    ds_read_b128 v[236:239], v91 offset:8192
    v_mfma_f32_32x32x16_bf16 v[48:63], v[216:219], a[236:239], v[48:63]
    s_waitcnt lgkmcnt(15)
    v_mfma_f32_32x32x16_bf16 v[32:47], v[220:223], a[240:243], v[32:47]
    ds_read_b64_tr_b16 a[232:233], v124 offset:59392
    ds_read_b64_tr_b16 a[234:235], v124 offset:59648
    ds_read_b64_tr_b16 a[236:237], v125 offset:26624
    ds_read_b64_tr_b16 a[238:239], v125 offset:26880
    v_mfma_f32_32x32x16_bf16 v[48:63], v[220:223], a[244:247], v[48:63]
    s_waitcnt lgkmcnt(12)
    v_mfma_f32_32x32x16_bf16 a[152:167], a[248:251], a[200:203], a[152:167]
    v_mfma_f32_32x32x16_bf16 a[168:183], a[248:251], a[204:207], a[168:183]
    v_mfma_f32_32x32x16_bf16 a[184:199], a[248:251], a[208:211], a[184:199]
    s_waitcnt lgkmcnt(7)
    v_dot2_f32_bf16 v80, v224, s59, v80
    v_dot2_f32_bf16 v82, v224, v224, v82
    v_dot2_f32_bf16 v81, v225, s59, v81
    v_dot2_f32_bf16 v83, v225, v225, v83
    v_dot2_f32_bf16 v80, v226, s59, v80
    v_dot2_f32_bf16 v82, v226, v226, v82
    v_dot2_f32_bf16 v81, v227, s59, v81
    v_dot2_f32_bf16 v83, v227, v227, v83
    s_waitcnt lgkmcnt(6)
    v_dot2_f32_bf16 v80, v228, s59, v80
    v_dot2_f32_bf16 v82, v228, v228, v82
    v_dot2_f32_bf16 v81, v229, s59, v81
    v_dot2_f32_bf16 v83, v229, v229, v83
    v_dot2_f32_bf16 v80, v230, s59, v80
    v_dot2_f32_bf16 v82, v230, v230, v82
    v_dot2_f32_bf16 v81, v231, s59, v81
    v_dot2_f32_bf16 v83, v231, v231, v83
    s_waitcnt lgkmcnt(5)
    v_dot2_f32_bf16 v80, v232, s59, v80
    v_dot2_f32_bf16 v82, v232, v232, v82
    v_dot2_f32_bf16 v81, v233, s59, v81
    v_dot2_f32_bf16 v83, v233, v233, v83
    v_dot2_f32_bf16 v80, v234, s59, v80
    v_dot2_f32_bf16 v82, v234, v234, v82
    v_dot2_f32_bf16 v81, v235, s59, v81
    v_dot2_f32_bf16 v83, v235, v235, v83
    s_waitcnt lgkmcnt(4)
    s_nop 0
    v_dot2_f32_bf16 v80, v236, s59, v80
    v_dot2_f32_bf16 v82, v236, v236, v82
    v_dot2_f32_bf16 v81, v237, s59, v81
    v_dot2_f32_bf16 v83, v237, v237, v83
    v_dot2_f32_bf16 v80, v238, s59, v80
    v_dot2_f32_bf16 v82, v238, v238, v82
    v_dot2_f32_bf16 v81, v239, s59, v81
    v_dot2_f32_bf16 v83, v239, v239, v83
    v_mfma_f32_32x32x16_bf16 v[32:47], v[224:227], a[216:219], v[32:47]
    ds_read_b64_tr_b16 a[240:241], v124 offset:60416
    ds_read_b64_tr_b16 a[242:243], v124 offset:60672
    ds_read_b64_tr_b16 a[244:245], v125 offset:27648
    ds_read_b64_tr_b16 a[246:247], v125 offset:27904
    v_mfma_f32_32x32x16_bf16 v[48:63], v[224:227], a[220:223], v[48:63]
    s_waitcnt vmcnt(6)
    s_barrier
    v_mfma_f32_32x32x16_bf16 v[32:47], v[228:231], a[224:227], v[32:47]
    ds_read_b64_tr_b16 a[216:217], v124 offset:61440
    ds_read_b64_tr_b16 a[218:219], v124 offset:61696
    ds_read_b64_tr_b16 a[220:221], v125 offset:28672
    ds_read_b64_tr_b16 a[222:223], v125 offset:28928
    ds_read_b64_tr_b16 a[200:201], v97 offset:61440
    ds_read_b64_tr_b16 a[202:203], v97 offset:61696
    ds_read_b64_tr_b16 a[204:205], v98 offset:28672
    ds_read_b64_tr_b16 a[206:207], v98 offset:28928
    ds_read_b64_tr_b16 a[208:209], v97 offset:28672
    ds_read_b64_tr_b16 a[210:211], v97 offset:28928
    v_mfma_f32_32x32x16_bf16 v[48:63], v[228:231], a[228:231], v[48:63]
    s_waitcnt lgkmcnt(14)
    s_nop 0
    v_mfma_f32_32x32x16_bf16 v[32:47], v[232:235], a[232:235], v[32:47]
    ds_read_b64_tr_b16 a[224:225], v124 offset:62464
    ds_read_b64_tr_b16 a[226:227], v124 offset:62720
    ds_read_b64_tr_b16 a[228:229], v125 offset:29696
    ds_read_b64_tr_b16 a[230:231], v125 offset:29952
    ds_read_b128 v[240:243], v88 offset:12288
    ds_read_b128 v[244:247], v89 offset:12288
    ds_read_b128 v[248:251], v90 offset:12288
    ds_read_b128 v[252:255], v91 offset:12288
    v_mfma_f32_32x32x16_bf16 v[48:63], v[232:235], a[236:239], v[48:63]
    v_bfe_u32 v4, v0, 4, 1
    v_lshl_add_u32 v4, v4, 1, v21
    v_mul_u32_u24_e64 v4, 17, v4
    v_and_b32_e64 v5, 15, v0
    v_add_u32_e64 v4, v4, v5
    v_lshlrev_b32_e64 v4, 5, v4
    v_add_u32_e64 v6, s75, v4
    s_mul_i32 s62, s3, 544
    s_add_u32 s62, s62, 45056
    v_add_u32 v127, s62, v1
    s_waitcnt lgkmcnt(15)
    v_mfma_f32_32x32x16_bf16 v[32:47], v[236:239], a[240:243], v[32:47]
    ds_read_b64_tr_b16 a[232:233], v124 offset:63488
    ds_read_b64_tr_b16 a[234:235], v124 offset:63744
    ds_read_b64_tr_b16 a[236:237], v125 offset:30720
    ds_read_b64_tr_b16 a[238:239], v125 offset:30976
    v_mfma_f32_32x32x16_bf16 v[48:63], v[236:239], a[244:247], v[48:63]
    s_waitcnt lgkmcnt(12)
    v_mfma_f32_32x32x16_bf16 a[152:167], a[248:251], a[200:203], a[152:167]
    v_mfma_f32_32x32x16_bf16 a[168:183], a[248:251], a[204:207], a[168:183]
    v_mfma_f32_32x32x16_bf16 a[184:199], a[248:251], a[208:211], a[184:199]
    s_waitcnt lgkmcnt(7)
    v_dot2_f32_bf16 v80, v240, s59, v80
    v_dot2_f32_bf16 v82, v240, v240, v82
    v_dot2_f32_bf16 v81, v241, s59, v81
    v_dot2_f32_bf16 v83, v241, v241, v83
    v_dot2_f32_bf16 v80, v242, s59, v80
    v_dot2_f32_bf16 v82, v242, v242, v82
    v_dot2_f32_bf16 v81, v243, s59, v81
    v_dot2_f32_bf16 v83, v243, v243, v83
    s_waitcnt lgkmcnt(6)
    v_dot2_f32_bf16 v80, v244, s59, v80
    v_dot2_f32_bf16 v82, v244, v244, v82
    v_dot2_f32_bf16 v81, v245, s59, v81
    v_dot2_f32_bf16 v83, v245, v245, v83
    v_dot2_f32_bf16 v80, v246, s59, v80
    v_dot2_f32_bf16 v82, v246, v246, v82
    v_dot2_f32_bf16 v81, v247, s59, v81
    v_dot2_f32_bf16 v83, v247, v247, v83
    s_waitcnt lgkmcnt(5)
    v_dot2_f32_bf16 v80, v248, s59, v80
    v_dot2_f32_bf16 v82, v248, v248, v82
    v_dot2_f32_bf16 v81, v249, s59, v81
    v_dot2_f32_bf16 v83, v249, v249, v83
    v_dot2_f32_bf16 v80, v250, s59, v80
    v_dot2_f32_bf16 v82, v250, v250, v82
    v_dot2_f32_bf16 v81, v251, s59, v81
    v_dot2_f32_bf16 v83, v251, v251, v83
    s_waitcnt lgkmcnt(4)
    s_nop 0
    v_dot2_f32_bf16 v80, v252, s59, v80
    v_dot2_f32_bf16 v82, v252, v252, v82
    v_dot2_f32_bf16 v81, v253, s59, v81
    v_dot2_f32_bf16 v83, v253, v253, v83
    v_dot2_f32_bf16 v80, v254, s59, v80
    v_dot2_f32_bf16 v82, v254, v254, v82
    v_dot2_f32_bf16 v81, v255, s59, v81
    v_dot2_f32_bf16 v83, v255, v255, v83
    s_lshr_b32 s62, s50, 1
    s_sub_u32 s62, s62, s73
    s_and_b32 s62, s62, 7
    s_cmp_eq_u32 s62, 0
    s_cselect_b32 s63, 4096, 0
    s_add_u32 s63, s63, 32768
    v_add_u32 v5, s63, v1
    v_add_u32 v4, s69, v5
    v_accvgpr_read_b32 v96, a152
    v_accvgpr_read_b32 v97, a168
    v_accvgpr_read_b32 v98, a184
    ds_write_b128 v4, v[96:99]
    v_mfma_f32_32x32x16_bf16 v[32:47], v[240:243], a[216:219], v[32:47]
    ds_read_b64_tr_b16 a[240:241], v124 offset:64512
    ds_read_b64_tr_b16 a[242:243], v124 offset:64768
    ds_read_b64_tr_b16 a[244:245], v125 offset:31744
    ds_read_b64_tr_b16 a[246:247], v125 offset:32000
    v_mfma_f32_32x32x16_bf16 v[48:63], v[240:243], a[220:223], v[48:63]
    s_waitcnt lgkmcnt(4)
    s_barrier
    v_mfma_f32_32x32x16_bf16 v[32:47], v[244:247], a[224:227], v[32:47]
    ds_read_b128 v[64:67], v5 offset:0
    ds_read_b128 v[68:71], v5 offset:1024
    ds_read_b128 v[72:75], v5 offset:2048
    ds_read_b128 v[76:79], v5 offset:3072
    s_lshl_b32 s62, s62, 12
    s_and_b32 s63, s50, 1
    s_lshl_b32 s63, s63, 11
    s_add_u32 s62, s62, s63
    s_min_u32 s64, s3, 2
    s_lshl_b32 s64, s64, 15
    s_add_u32 s62, s62, s64
    v_lshlrev_b32 v5, 8, v21
    v_sub_u32 v4, v124, v5
    v_add_u32 v4, s62, v4
    ds_read_b64_tr_b16 v[104:105], v4 offset:0
    ds_read_b64_tr_b16 v[106:107], v4 offset:512
    ds_read_b64_tr_b16 v[108:109], v4 offset:1024
    ds_read_b64_tr_b16 v[110:111], v4 offset:1536
    v_mfma_f32_32x32x16_bf16 v[48:63], v[244:247], a[228:231], v[48:63]
    v_mfma_f32_32x32x16_bf16 v[32:47], v[248:251], a[232:235], v[32:47]
    s_waitcnt lgkmcnt(4)
    v_add_f32 v64, v64, v68
    v_add_f32 v72, v72, v76
    v_add_f32 v65, v65, v69
    v_add_f32 v73, v73, v77
    v_add_f32 v66, v66, v70
    v_add_f32 v74, v74, v78
    v_mfma_f32_32x32x16_bf16 v[48:63], v[248:251], a[236:239], v[48:63]
    v_add_f32 v64, v64, v72
    v_add_f32 v65, v65, v73
    v_add_f32 v66, v66, v74
    s_lshl_b32 s63, s50, 11
    s_add_u32 s65, s98, s64
    s_add_u32 s65, s65, s63
    s_waitcnt lgkmcnt(0)
    buffer_store_dwordx4 v[104:107], v1, s[24:27], s65 offen offset:0 sc1
    buffer_store_dwordx4 v[108:111], v1, s[24:27], s65 offen offset:1024 sc1
    v_mfma_f32_32x32x16_bf16 v[32:47], v[252:255], a[240:243], v[32:47]
    v_cvt_pk_bf16_f32 v4, v64, v64
    v_and_b32 v4, 0xffff0000, v4
    v_sub_f32_e64 v16, v64, v4
    v_cvt_pk_bf16_f32 v16, v4, v16
    v_cvt_pk_bf16_f32 v5, v65, v65
    v_and_b32 v5, 0xffff0000, v5
    v_sub_f32_e64 v17, v65, v5
    v_cvt_pk_bf16_f32 v17, v5, v17
    v_mfma_f32_32x32x16_bf16 v[48:63], v[252:255], a[244:247], v[48:63]
    v_add_f32 v80, v80, v81
    v_add_f32 v82, v82, v83
    v_mov_b32 v81, v80
    v_mov_b32 v83, v82
    v_mov_b32 v84, v16
    v_mov_b32 v85, v16
    v_mov_b32 v112, v17
    v_mov_b32 v113, v17
    v_permlane32_swap_b32 v80, v81
    v_permlane32_swap_b32 v82, v83
    v_add_f32 v80, v80, v81
    v_add_f32 v82, v82, v83
    v_cvt_pk_bf16_f32 v5, v66, v66
    v_and_b32 v5, 0xffff0000, v5
    v_sub_f32_e64 v18, v66, v5
    v_cvt_pk_bf16_f32 v18, v5, v18
    v_mul_f32 v80, 0xbb000000, v80
    v_mul_f32 v82, 0x3b000000, v82
    v_cmp_eq_u32_e64 vcc, 0, v21
    v_fma_f32 v82, -v80, v80, v82
    v_max_f32_e64 v82, 0, v82
    v_add_f32 v82, 0x3727c5ac, v82
    v_rsq_f32 v20, v82
    v_cndmask_b32 v80, 0, v80, vcc
    v_cvt_pk_bf16_f32 v28, v80, v80
    v_cndmask_b32_e64 v82, 0, v20, vcc
    v_and_b32 v4, 0xffff0000, v28
    v_sub_f32_e64 v80, v80, v4
    v_cvt_pk_bf16_f32 v29, v80, v80
    v_cvt_pk_bf16_f32 v4, v82, v82
    v_and_b32 v4, 0xffff0000, v4
    v_sub_f32_e64 v120, v82, v4
    v_cvt_pk_bf16_f32 v120, v4, v120
    v_mfma_f32_32x32x16_bf16 v[32:47], v[28:31], v[84:87], v[32:47]
    s_nop 0
    v_mfma_f32_32x32x16_bf16 v[64:79], v[120:123], a[248:251], 0
    v_mfma_f32_32x32x16_bf16 v[48:63], v[28:31], v[112:115], v[48:63]
    s_nop 10
    v_pk_fma_f32 v[32:33], v[32:33], v[64:65], s[60:61] op_sel_hi:[1,1,0]
    v_pk_fma_f32 v[34:35], v[34:35], v[66:67], s[60:61] op_sel_hi:[1,1,0]
    v_pk_fma_f32 v[36:37], v[36:37], v[68:69], s[60:61] op_sel_hi:[1,1,0]
    v_pk_fma_f32 v[38:39], v[38:39], v[70:71], s[60:61] op_sel_hi:[1,1,0]
    v_pk_fma_f32 v[40:41], v[40:41], v[72:73], s[60:61] op_sel_hi:[1,1,0]
    v_pk_fma_f32 v[42:43], v[42:43], v[74:75], s[60:61] op_sel_hi:[1,1,0]
    v_pk_fma_f32 v[44:45], v[44:45], v[76:77], s[60:61] op_sel_hi:[1,1,0]
    v_pk_fma_f32 v[46:47], v[46:47], v[78:79], s[60:61] op_sel_hi:[1,1,0]
    v_pk_mul_f32 v[96:97], v[32:33], s[74:75] op_sel_hi:[1,0]
    v_pk_mul_f32 v[98:99], v[34:35], s[74:75] op_sel_hi:[1,0]
    v_pk_mul_f32 v[100:101], v[36:37], s[74:75] op_sel_hi:[1,0]
    v_pk_mul_f32 v[102:103], v[38:39], s[74:75] op_sel_hi:[1,0]
    v_pk_mul_f32 v[104:105], v[40:41], s[74:75] op_sel_hi:[1,0]
    v_pk_mul_f32 v[106:107], v[42:43], s[74:75] op_sel_hi:[1,0]
    v_pk_mul_f32 v[108:109], v[44:45], s[74:75] op_sel_hi:[1,0]
    v_pk_mul_f32 v[110:111], v[46:47], s[74:75] op_sel_hi:[1,0]
    v_exp_f32_e64 v96, v96 clamp
    v_max_f32_e64 v32, s60, v32
    v_exp_f32_e64 v97, v97 clamp
    v_max_f32_e64 v33, s60, v33
    v_exp_f32_e64 v98, v98 clamp
    v_max_f32_e64 v34, s60, v34
    v_exp_f32_e64 v99, v99 clamp
    v_max_f32_e64 v35, s60, v35
    v_exp_f32_e64 v100, v100 clamp
    v_max_f32_e64 v36, s60, v36
    v_exp_f32_e64 v101, v101 clamp
    v_max_f32_e64 v37, s60, v37
    v_exp_f32_e64 v102, v102 clamp
    v_max_f32_e64 v38, s60, v38
    v_exp_f32_e64 v103, v103 clamp
    v_max_f32_e64 v39, s60, v39
    v_exp_f32_e64 v104, v104 clamp
    v_max_f32_e64 v40, s60, v40
    v_exp_f32_e64 v105, v105 clamp
    v_max_f32_e64 v41, s60, v41
    v_exp_f32_e64 v106, v106 clamp
    v_max_f32_e64 v42, s60, v42
    v_exp_f32_e64 v107, v107 clamp
    v_max_f32_e64 v43, s60, v43
    v_exp_f32_e64 v108, v108 clamp
    v_max_f32_e64 v44, s60, v44
    v_exp_f32_e64 v109, v109 clamp
    v_max_f32_e64 v45, s60, v45
    v_exp_f32_e64 v110, v110 clamp
    v_max_f32_e64 v46, s60, v46
    v_exp_f32_e64 v111, v111 clamp
    v_max_f32_e64 v47, s60, v47
    v_pk_add_f32 v[32:33], v[32:33], v[96:97]
    v_pk_add_f32 v[34:35], v[34:35], v[98:99]
    v_pk_add_f32 v[36:37], v[36:37], v[100:101]
    v_pk_add_f32 v[38:39], v[38:39], v[102:103]
    v_pk_add_f32 v[40:41], v[40:41], v[104:105]
    v_pk_add_f32 v[42:43], v[42:43], v[106:107]
    v_pk_add_f32 v[44:45], v[44:45], v[108:109]
    v_pk_add_f32 v[46:47], v[46:47], v[110:111]
    v_cvt_pk_bf16_f32 v88, v32, v33
    v_cvt_pk_bf16_f32 v89, v34, v35
    v_cvt_pk_bf16_f32 v90, v36, v37
    v_cvt_pk_bf16_f32 v91, v38, v39
    v_cvt_pk_bf16_f32 v92, v40, v41
    v_cvt_pk_bf16_f32 v93, v42, v43
    v_cvt_pk_bf16_f32 v94, v44, v45
    v_cvt_pk_bf16_f32 v95, v46, v47
    v_pk_mul_f32 v[48:49], v[48:49], v[64:65]
    v_pk_mul_f32 v[50:51], v[50:51], v[66:67]
    v_pk_mul_f32 v[52:53], v[52:53], v[68:69]
    v_pk_mul_f32 v[54:55], v[54:55], v[70:71]
    v_pk_mul_f32 v[56:57], v[56:57], v[72:73]
    v_pk_mul_f32 v[58:59], v[58:59], v[74:75]
    v_pk_mul_f32 v[60:61], v[60:61], v[76:77]
    v_pk_mul_f32 v[62:63], v[62:63], v[78:79]
    v_mfma_f32_32x32x16_bf16 v[96:111], v[88:91], a[248:251], 0
    v_cvt_pk_bf16_f32 v80, v48, v49
    v_cvt_pk_bf16_f32 v81, v50, v51
    v_cvt_pk_bf16_f32 v82, v52, v53
    v_cvt_pk_bf16_f32 v83, v54, v55
    v_mfma_f32_32x32x16_bf16 v[96:111], v[92:95], a[248:251], v[96:111]
    v_cvt_pk_bf16_f32 v84, v56, v57
    v_cvt_pk_bf16_f32 v85, v58, v59
    v_cvt_pk_bf16_f32 v86, v60, v61
    v_cvt_pk_bf16_f32 v87, v62, v63
    v_and_b32 v4, 16, v0
    v_cmp_ne_u32 vcc, 0, v4
    v_mfma_f32_32x32x16_bf16 v[64:79], v[88:91], v[80:83], 0
    v_mfma_f32_32x32x16_bf16 v[64:79], v[92:95], v[84:87], v[64:79]
    s_barrier
    s_nop 2
    v_cndmask_b32 v40, v96, v104, vcc
    v_cndmask_b32 v41, v97, v105, vcc
    v_cndmask_b32 v42, v98, v106, vcc
    v_cndmask_b32 v43, v99, v107, vcc
    v_cndmask_b32 v44, v100, v108, vcc
    v_cndmask_b32 v45, v101, v109, vcc
    v_cndmask_b32 v46, v102, v110, vcc
    v_cndmask_b32 v47, v103, v111, vcc
    s_mov_b32 exec_lo, 0x10001
    s_mov_b32 exec_hi, 0x10001
    ds_write_b128 v6, v[40:43] offset:12800
    ds_write_b128 v6, v[44:47] offset:12816
    s_mov_b64 exec, -1
    v_cndmask_b32 v32, v64, v72, vcc
    v_cndmask_b32 v33, v65, v73, vcc
    v_cndmask_b32 v34, v66, v74, vcc
    v_cndmask_b32_e64 v35, v67, v75, vcc
    ds_write_b128 v6, v[32:35] offset:12288
    v_cndmask_b32 v36, v68, v76, vcc
    v_cndmask_b32 v37, v69, v77, vcc
    v_cndmask_b32_e64 v38, v70, v78, vcc
    v_cndmask_b32 v39, v71, v79, vcc
    ds_write_b128 v6, v[36:39] offset:12304
    s_waitcnt vmcnt(6)
    s_waitcnt lgkmcnt(0)
    s_barrier
    ds_read_b128 v[64:67], v127 offset:0
    ds_read_b128 v[68:71], v127 offset:16384
    ds_read_b128 v[72:75], v127 offset:32768
    ds_read_b128 v[76:79], v127 offset:49152
    ds_read_b64_tr_b16 a[216:217], v124 offset:0
    ds_read_b64_tr_b16 a[218:219], v124 offset:256
    ds_read_b64_tr_b16 a[220:221], v124 offset:1024
    ds_read_b64_tr_b16 a[222:223], v124 offset:1280
    ds_read_b64_tr_b16 a[224:225], v124 offset:2048
    ds_read_b64_tr_b16 a[226:227], v124 offset:2304
    ds_read_b64_tr_b16 a[228:229], v124 offset:3072
    ds_read_b64_tr_b16 a[230:231], v124 offset:3328
    ds_read_b64_tr_b16 a[232:233], v124 offset:4096
    ds_read_b64_tr_b16 a[234:235], v124 offset:4352
    ds_read_b64_tr_b16 a[236:237], v124 offset:5120
    ds_read_b64_tr_b16 a[238:239], v124 offset:5376
    v_mov_b32_e64 v116, v18
    v_mov_b32 v117, v18
    s_nop 1
    v_mfma_f32_32x32x16_bf16 v[32:47], v[116:119], v[28:31], 0
    s_waitcnt lgkmcnt(12)
    v_add_f32 v64, v64, v68
    v_add_f32 v65, v65, v69
    v_add_f32 v66, v66, v70
    v_add_f32 v67, v67, v71
    v_add_f32 v72, v72, v76
    v_add_f32 v73, v73, v77
    v_add_f32 v74, v74, v78
    v_add_f32 v75, v75, v79
    v_add_f32 v64, v64, v72
    v_add_f32_e64 v65, v65, v73
    v_add_f32_e64 v66, v66, v74
    v_add_f32 v67, v67, v75
    s_mov_b32 exec_lo, 0xffffffff
    s_mov_b32 exec_hi, 0xff
    v_writelane_b32 v64, s101, 34
    buffer_store_dwordx4 v[64:67], v1, s[24:27], s84 offen offset:0 sc1
    s_mov_b64 exec, -1
    s_waitcnt lgkmcnt(10)
    v_mfma_f32_32x32x16_bf16 v[32:47], a[216:219], v[128:131], v[32:47]
    ds_read_b64_tr_b16 a[240:241], v124 offset:6144
    ds_read_b64_tr_b16 a[242:243], v124 offset:6400
    s_add_u32 m0, s57, 0
    s_lshl_b32 s68, s3, 17
    buffer_load_dwordx4 v2, s[12:15], s68 offen lds
    buffer_load_dwordx4 v3, s[12:15], s68 offen offset:1024 lds
    s_add_u32 m0, s57, 2048
    s_add_u32 s68, s68, 16384
    buffer_load_dwordx4 v2, s[12:15], s68 offen lds
    buffer_load_dwordx4 v3, s[12:15], s68 offen offset:1024 lds
    s_waitcnt lgkmcnt(10)
    v_mfma_f32_32x32x16_bf16 v[32:47], a[220:223], v[132:135], v[32:47]
    ds_read_b64_tr_b16 a[244:245], v124 offset:7168
    ds_read_b64_tr_b16 a[246:247], v124 offset:7424
    s_waitcnt lgkmcnt(10)
    v_mfma_f32_32x32x16_bf16 v[32:47], a[224:227], v[136:139], v[32:47]
    ds_read_b64_tr_b16 a[216:217], v124 offset:8192
    ds_read_b64_tr_b16 a[218:219], v124 offset:8448
    v_mov_b32 v80, -1
    v_mov_b32 v81, -1
    v_mov_b32_e64 v82, -1
    v_mov_b32 v83, -1
    s_waitcnt lgkmcnt(10)
    v_mfma_f32_32x32x16_bf16 v[32:47], a[228:231], v[140:143], v[32:47]
    ds_read_b64_tr_b16 a[220:221], v124 offset:9216
    ds_read_b64_tr_b16 a[222:223], v124 offset:9472
    v_and_b32_e64 v5, 15, v0
    v_lshlrev_b32_e64 v5, 4, v5
    v_lshl_add_u32 v5, v21, 9, v5
    v_bfe_u32 v4, v0, 4, 1
    v_lshl_add_u32 v5, v4, 10, v5
    buffer_store_dwordx4 v[80:83], v5, s[24:27], s90 offen offset:0 sc1
    buffer_store_dwordx4 v[80:83], v5, s[24:27], s90 offen offset:2048 sc1
    s_waitcnt lgkmcnt(10)
    v_mfma_f32_32x32x16_bf16 v[32:47], a[232:235], v[144:147], v[32:47]
    ds_read_b64_tr_b16 a[224:225], v124 offset:10240
    ds_read_b64_tr_b16 a[226:227], v124 offset:10496
    s_waitcnt lgkmcnt(10)
    v_mfma_f32_32x32x16_bf16 v[32:47], a[236:239], v[148:151], v[32:47]
    ds_read_b64_tr_b16 a[228:229], v124 offset:11264
    ds_read_b64_tr_b16 a[230:231], v124 offset:11520
    s_waitcnt lgkmcnt(10)
    s_nop 0
    v_mfma_f32_32x32x16_bf16 v[32:47], a[240:243], v[152:155], v[32:47]
    ds_read_b64_tr_b16 a[232:233], v124 offset:12288
    ds_read_b64_tr_b16 a[234:235], v124 offset:12544
    buffer_store_dwordx4 v[80:83], v1, s[24:27], s92 offen offset:0 sc1
    buffer_store_dwordx4 v[80:83], v1, s[24:27], s92 offen offset:1024 sc1
    s_waitcnt lgkmcnt(10)
    v_mfma_f32_32x32x16_bf16 v[32:47], a[244:247], v[156:159], v[32:47]
    ds_read_b64_tr_b16 a[236:237], v124 offset:13312
    ds_read_b64_tr_b16 a[238:239], v124 offset:13568
    s_waitcnt lgkmcnt(10)
    v_mfma_f32_32x32x16_bf16 v[32:47], a[216:219], v[160:163], v[32:47]
    ds_read_b64_tr_b16 a[240:241], v124 offset:14336
    ds_read_b64_tr_b16 a[242:243], v124 offset:14592
    s_add_u32 m0, s57, 4096
    s_add_u32 s68, s68, 16384
    buffer_load_dwordx4 v2, s[12:15], s68 offen lds
    buffer_load_dwordx4 v3, s[12:15], s68 offen offset:1024 lds
    s_add_u32 m0, s57, 6144
    s_add_u32 s68, s68, 16384
    buffer_load_dwordx4 v2, s[12:15], s68 offen lds
    buffer_load_dwordx4 v3, s[12:15], s68 offen offset:1024 lds
    s_waitcnt lgkmcnt(10)
    v_mfma_f32_32x32x16_bf16 v[32:47], a[220:223], v[164:167], v[32:47]
    ds_read_b64_tr_b16 a[244:245], v124 offset:15360
    ds_read_b64_tr_b16 a[246:247], v124 offset:15616
    s_waitcnt lgkmcnt(10)
    v_mfma_f32_32x32x16_bf16 v[32:47], a[224:227], v[168:171], v[32:47]
    ds_read_b64_tr_b16 a[216:217], v124 offset:16384
    ds_read_b64_tr_b16 a[218:219], v124 offset:16640
    s_waitcnt lgkmcnt(10)
    v_mfma_f32_32x32x16_bf16 v[32:47], a[228:231], v[172:175], v[32:47]
    ds_read_b64_tr_b16 a[220:221], v124 offset:17408
    ds_read_b64_tr_b16 a[222:223], v124 offset:17664
    s_waitcnt lgkmcnt(10)
    v_mfma_f32_32x32x16_bf16 v[32:47], a[232:235], v[176:179], v[32:47]
    ds_read_b64_tr_b16 a[224:225], v124 offset:18432
    ds_read_b64_tr_b16 a[226:227], v124 offset:18688
    s_waitcnt lgkmcnt(10)
    v_mfma_f32_32x32x16_bf16 v[32:47], a[236:239], v[180:183], v[32:47]
    ds_read_b64_tr_b16 a[228:229], v124 offset:19456
    ds_read_b64_tr_b16 a[230:231], v124 offset:19712
    s_waitcnt lgkmcnt(10)
    v_mfma_f32_32x32x16_bf16 v[32:47], a[240:243], v[184:187], v[32:47]
    ds_read_b64_tr_b16 a[232:233], v124 offset:20480
    ds_read_b64_tr_b16 a[234:235], v124 offset:20736
    s_waitcnt lgkmcnt(10)
    v_mfma_f32_32x32x16_bf16 v[32:47], a[244:247], v[188:191], v[32:47]
    ds_read_b64_tr_b16 a[236:237], v124 offset:21504
    ds_read_b64_tr_b16 a[238:239], v124 offset:21760
    s_waitcnt lgkmcnt(10)
    v_mfma_f32_32x32x16_bf16 v[32:47], a[216:219], v[192:195], v[32:47]
    ds_read_b64_tr_b16 a[240:241], v124 offset:22528
    ds_read_b64_tr_b16 a[242:243], v124 offset:22784
    s_add_u32 m0, s57, 8192
    s_add_u32 s68, s68, 16384
    buffer_load_dwordx4 v2, s[12:15], s68 offen lds
    buffer_load_dwordx4 v3, s[12:15], s68 offen offset:1024 lds
    s_add_u32 m0, s57, 10240
    s_add_u32 s68, s68, 16384
    buffer_load_dwordx4 v2, s[12:15], s68 offen lds
    buffer_load_dwordx4 v3, s[12:15], s68 offen offset:1024 lds
    s_waitcnt lgkmcnt(10)
    v_mfma_f32_32x32x16_bf16 v[32:47], a[220:223], v[196:199], v[32:47]
    ds_read_b64_tr_b16 a[244:245], v124 offset:23552
    ds_read_b64_tr_b16 a[246:247], v124 offset:23808
    s_waitcnt lgkmcnt(10)
    v_mfma_f32_32x32x16_bf16 v[32:47], a[224:227], v[200:203], v[32:47]
    ds_read_b64_tr_b16 a[216:217], v124 offset:24576
    ds_read_b64_tr_b16 a[218:219], v124 offset:24832
    s_waitcnt lgkmcnt(10)
    v_mfma_f32_32x32x16_bf16 v[32:47], a[228:231], v[204:207], v[32:47]
    ds_read_b64_tr_b16 a[220:221], v124 offset:25600
    ds_read_b64_tr_b16 a[222:223], v124 offset:25856
    s_waitcnt lgkmcnt(10)
    v_mfma_f32_32x32x16_bf16 v[32:47], a[232:235], v[208:211], v[32:47]
    ds_read_b64_tr_b16 a[224:225], v124 offset:26624
    ds_read_b64_tr_b16 a[226:227], v124 offset:26880
    s_waitcnt lgkmcnt(10)
    v_mfma_f32_32x32x16_bf16 v[32:47], a[236:239], v[212:215], v[32:47]
    ds_read_b64_tr_b16 a[228:229], v124 offset:27648
    ds_read_b64_tr_b16 a[230:231], v124 offset:27904
    s_waitcnt lgkmcnt(10)
    v_mfma_f32_32x32x16_bf16 v[32:47], a[240:243], v[216:219], v[32:47]
    ds_read_b64_tr_b16 a[232:233], v124 offset:28672
    ds_read_b64_tr_b16 a[234:235], v124 offset:28928
    s_waitcnt lgkmcnt(10)
    v_mfma_f32_32x32x16_bf16 v[32:47], a[244:247], v[220:223], v[32:47]
    ds_read_b64_tr_b16 a[236:237], v124 offset:29696
    ds_read_b64_tr_b16 a[238:239], v124 offset:29952
    s_waitcnt lgkmcnt(10)
    v_mfma_f32_32x32x16_bf16 v[32:47], a[216:219], v[224:227], v[32:47]
    ds_read_b64_tr_b16 a[240:241], v124 offset:30720
    ds_read_b64_tr_b16 a[242:243], v124 offset:30976
    s_add_u32 m0, s57, 12288
    s_add_u32 s68, s68, 16384
    buffer_load_dwordx4 v2, s[12:15], s68 offen lds
    buffer_load_dwordx4 v3, s[12:15], s68 offen offset:1024 lds
    s_add_u32 m0, s57, 14336
    s_add_u32 s68, s68, 16384
    buffer_load_dwordx4 v2, s[12:15], s68 offen lds
    buffer_load_dwordx4 v3, s[12:15], s68 offen offset:1024 lds
    s_waitcnt lgkmcnt(10)
    v_mfma_f32_32x32x16_bf16 v[32:47], a[220:223], v[228:231], v[32:47]
    ds_read_b64_tr_b16 a[244:245], v124 offset:31744
    ds_read_b64_tr_b16 a[246:247], v124 offset:32000
    s_waitcnt lgkmcnt(10)
    v_mfma_f32_32x32x16_bf16 v[32:47], a[224:227], v[232:235], v[32:47]
    s_waitcnt lgkmcnt(8)
    v_mfma_f32_32x32x16_bf16 v[32:47], a[228:231], v[236:239], v[32:47]
    s_waitcnt lgkmcnt(6)
    v_mfma_f32_32x32x16_bf16 v[32:47], a[232:235], v[240:243], v[32:47]
    s_waitcnt lgkmcnt(4)
    v_mfma_f32_32x32x16_bf16 v[32:47], a[236:239], v[244:247], v[32:47]
    s_waitcnt lgkmcnt(2)
    v_mfma_f32_32x32x16_bf16 v[32:47], a[240:243], v[248:251], v[32:47]
    s_waitcnt lgkmcnt(0)
    v_mfma_f32_32x32x16_bf16 v[32:47], a[244:247], v[252:255], v[32:47]
    s_cmp_lt_u32 s79, 64
    s_cbranch_scc1 RED_2
NOA1E_1:
    s_nop 9
    v_pk_fma_f32 v[32:33], v[32:33], v[20:21], s[60:61] op_sel_hi:[1,0,0]
    v_pk_fma_f32 v[34:35], v[34:35], v[20:21], s[60:61] op_sel_hi:[1,0,0]
    v_pk_fma_f32 v[36:37], v[36:37], v[20:21], s[60:61] op_sel_hi:[1,0,0]
    v_pk_fma_f32 v[38:39], v[38:39], v[20:21], s[60:61] op_sel_hi:[1,0,0]
    v_pk_mul_f32 v[96:97], v[32:33], s[74:75] op_sel_hi:[1,0]
    v_pk_mul_f32 v[98:99], v[34:35], s[74:75] op_sel_hi:[1,0]
    v_pk_mul_f32 v[100:101], v[36:37], s[74:75] op_sel_hi:[1,0]
    v_pk_mul_f32 v[102:103], v[38:39], s[74:75] op_sel_hi:[1,0]
    v_exp_f32_e64 v96, v96 clamp
    v_max_f32_e64 v32, s60, v32
    v_exp_f32_e64 v97, v97 clamp
    v_max_f32 v33, s60, v33
    v_exp_f32_e64 v98, v98 clamp
    v_max_f32 v34, s60, v34
    v_exp_f32_e64 v99, v99 clamp
    v_max_f32 v35, s60, v35
    v_exp_f32_e64 v100, v100 clamp
    v_max_f32 v36, s60, v36
    v_exp_f32_e64 v101, v101 clamp
    v_max_f32_e64 v37, s60, v37
    v_exp_f32_e64 v102, v102 clamp
    v_max_f32_e64 v38, s60, v38
    v_exp_f32_e64 v103, v103 clamp
    v_max_f32_e64 v39, s60, v39
    v_pk_add_f32 v[32:33], v[32:33], v[96:97]
    v_pk_add_f32 v[34:35], v[34:35], v[98:99]
    v_pk_add_f32 v[36:37], v[36:37], v[100:101]
    v_pk_add_f32 v[38:39], v[38:39], v[102:103]
    v_cvt_pk_bf16_f32 v88, v32, v33
    v_cvt_pk_bf16_f32 v89, v34, v35
    v_cvt_pk_bf16_f32 v90, v36, v37
    v_cvt_pk_bf16_f32 v91, v38, v39
    buffer_store_dwordx4 v[88:91], v1, s[24:27], s85 offen offset:0 sc1
    v_pk_fma_f32 v[40:41], v[40:41], v[20:21], s[60:61] op_sel_hi:[1,0,0]
    v_pk_fma_f32 v[42:43], v[42:43], v[20:21], s[60:61] op_sel_hi:[1,0,0]
    v_pk_fma_f32 v[44:45], v[44:45], v[20:21], s[60:61] op_sel_hi:[1,0,0]
    v_pk_fma_f32 v[46:47], v[46:47], v[20:21], s[60:61] op_sel_hi:[1,0,0]
    v_pk_mul_f32 v[104:105], v[40:41], s[74:75] op_sel_hi:[1,0]
    v_pk_mul_f32 v[106:107], v[42:43], s[74:75] op_sel_hi:[1,0]
    v_pk_mul_f32 v[108:109], v[44:45], s[74:75] op_sel_hi:[1,0]
    v_pk_mul_f32 v[110:111], v[46:47], s[74:75] op_sel_hi:[1,0]
    v_exp_f32_e64 v104, v104 clamp
    v_max_f32_e64 v40, s60, v40
    v_exp_f32_e64 v105, v105 clamp
    v_max_f32_e64 v41, s60, v41
    v_exp_f32_e64 v106, v106 clamp
    v_max_f32_e64 v42, s60, v42
    v_exp_f32_e64 v107, v107 clamp
    v_max_f32_e64 v43, s60, v43
    v_exp_f32_e64 v108, v108 clamp
    v_max_f32_e64 v44, s60, v44
    v_exp_f32_e64 v109, v109 clamp
    v_max_f32_e64 v45, s60, v45
    v_exp_f32_e64 v110, v110 clamp
    v_max_f32_e64 v46, s60, v46
    v_exp_f32_e64 v111, v111 clamp
    v_max_f32_e64 v47, s60, v47
    v_pk_add_f32 v[40:41], v[40:41], v[104:105]
    v_pk_add_f32 v[42:43], v[42:43], v[106:107]
    v_pk_add_f32 v[44:45], v[44:45], v[108:109]
    v_pk_add_f32 v[46:47], v[46:47], v[110:111]
    v_cvt_pk_bf16_f32 v92, v40, v41
    v_cvt_pk_bf16_f32 v93, v42, v43
    v_cvt_pk_bf16_f32 v94, v44, v45
    v_cvt_pk_bf16_f32 v95, v46, v47
    buffer_store_dwordx4 v[92:95], v1, s[24:27], s85 offen offset:1024 sc1
    v_mov_b32 v96, s101
    v_mov_b32 v97, s101
    v_mov_b32 v98, s101
    v_mov_b32 v99, s101
    s_sub_u32 s62, s85, 0x400000
    s_lshr_b32 s62, s62, 100
    s_add_u32 s62, s62, 0x1540000
    s_mov_b32 exec_lo, 0xff
    s_mov_b32 exec_hi, 0x0
    buffer_store_dwordx4 v[96:99], v1, s[24:27], s62 offen offset:0 sc1
    s_mov_b64 exec, -1
    s_cmp_lt_u32 s79, 64
    s_cbranch_scc1 RED_4
NOA1_3:
    s_add_u32 m0, s75, 0
    s_nop 0
    buffer_load_dwordx4 v24, s[16:19], s80 offen lds
    buffer_load_dwordx4 v25, s[16:19], s80 offen offset:1024 lds
    s_add_u32 m0, s75, 2048
    s_add_u32 s80, s80, 57344
    s_cmp_eq_u32 s80, 1835008
    s_cselect_b32 s80, 0, s80
    buffer_load_dwordx4 v24, s[16:19], s80 offen lds
    buffer_load_dwordx4 v25, s[16:19], s80 offen offset:1024 lds
    s_add_u32 m0, s75, 4096
    s_add_u32 s80, s80, 57344
    s_cmp_eq_u32 s80, 1835008
    s_cselect_b32 s80, 0, s80
    buffer_load_dwordx4 v24, s[16:19], s80 offen lds
    buffer_load_dwordx4 v25, s[16:19], s80 offen offset:1024 lds
    s_add_u32 m0, s75, 6144
    s_add_u32 s80, s80, 57344
    s_cmp_eq_u32 s80, 1835008
    s_cselect_b32 s80, 0, s80
    buffer_load_dwordx4 v24, s[16:19], s80 offen lds
    buffer_load_dwordx4 v25, s[16:19], s80 offen offset:1024 lds
    s_add_u32 m0, s75, 8192
    s_add_u32 s80, s80, 57344
    s_cmp_eq_u32 s80, 1835008
    s_cselect_b32 s80, 0, s80
    buffer_load_dwordx4 v24, s[16:19], s80 offen lds
    buffer_load_dwordx4 v25, s[16:19], s80 offen offset:1024 lds
    s_add_u32 m0, s75, 10240
    s_add_u32 s80, s80, 57344
    s_cmp_eq_u32 s80, 1835008
    s_cselect_b32 s80, 0, s80
    buffer_load_dwordx4 v24, s[16:19], s80 offen lds
    buffer_load_dwordx4 v25, s[16:19], s80 offen offset:1024 lds
    v_bfe_u32 v4, v0, 2, 2
    v_lshl_add_u32 v4, v21, 2, v4
    v_lshlrev_b32 v2, 7, v4
    v_bfe_u32 v5, v0, 3, 1
    v_lshl_add_u32 v2, v5, 6, v2
    v_bfe_u32 v5, v0, 4, 1
    v_lshl_add_u32 v2, v5, 5, v2
    v_and_b32_e64 v5, 3, v0
    v_lshl_add_u32 v2, v5, 3, v2
    s_lshl_b32 s67, s56, 5
    v_xor_b32 v2, s67, v2
    v_add_u32 v2, 98304, v2
    v_xor_b32 v3, 64, v2
    s_lshl_b32 s64, s56, 15
    v_add_u32 v2, s64, v2
    v_add_u32 v3, s64, v3
    v_and_b32_e64 v4, 31, v0
    v_mul_u32_u24 v29, 384, v4
    v_min_u32 v4, 16, v4
    v_lshlrev_b32 v4, 4, v4
    v_mul_u32_u24 v5, 384, v21
    v_add_u32 v28, v4, v5
    v_and_b32 v6, 7, v0
    v_lshlrev_b32_e64 v6, 7, v6
    s_sub_u32 s62, s86, 0x400000
    s_lshr_b32 s62, s62, 4
    s_add_u32 s62, s62, 0x1540000
    s_waitcnt vmcnt(10)
    ds_read_b64_tr_b16 a[0:1], v26 offset:0
    ds_read_b64_tr_b16 a[2:3], v26 offset:1024
    ds_read_b64_tr_b16 a[4:5], v27 offset:0
    ds_read_b64_tr_b16 a[6:7], v27 offset:1024
    s_waitcnt vmcnt(8)
    ds_read_b64_tr_b16 a[8:9], v26 offset:2048
    ds_read_b64_tr_b16 a[10:11], v26 offset:3072
    ds_read_b64_tr_b16 a[12:13], v27 offset:2048
    ds_read_b64_tr_b16 a[14:15], v27 offset:3072
    s_waitcnt lgkmcnt(4)
    s_add_u32 m0, s75, 0
    s_add_u32 s80, s80, 57344
    s_cmp_eq_u32 s80, 1835008
    s_cselect_b32 s80, 0, s80
    buffer_load_dwordx4 v24, s[16:19], s80 offen lds
    buffer_load_dwordx4 v25, s[16:19], s80 offen offset:1024 lds
    s_waitcnt vmcnt(8)
    ds_read_b64_tr_b16 a[16:17], v26 offset:4096
    ds_read_b64_tr_b16 a[18:19], v26 offset:5120
    ds_read_b64_tr_b16 a[20:21], v27 offset:4096
    ds_read_b64_tr_b16 a[22:23], v27 offset:5120
    s_waitcnt lgkmcnt(4)
    s_add_u32 m0, s75, 2048
    s_add_u32 s80, s80, 57344
    s_cmp_eq_u32 s80, 1835008
    s_cselect_b32 s80, 0, s80
    buffer_load_dwordx4 v24, s[16:19], s80 offen lds
    buffer_load_dwordx4 v25, s[16:19], s80 offen offset:1024 lds
    s_waitcnt vmcnt(8)
    ds_read_b64_tr_b16 a[24:25], v26 offset:6144
    ds_read_b64_tr_b16 a[26:27], v26 offset:7168
    ds_read_b64_tr_b16 a[28:29], v27 offset:6144
    ds_read_b64_tr_b16 a[30:31], v27 offset:7168
    s_waitcnt lgkmcnt(4)
    s_add_u32 m0, s75, 4096
    s_add_u32 s80, s80, 57344
    s_cmp_eq_u32 s80, 1835008
    s_cselect_b32 s80, 0, s80
    buffer_load_dwordx4 v24, s[16:19], s80 offen lds
    buffer_load_dwordx4 v25, s[16:19], s80 offen offset:1024 lds
    s_waitcnt vmcnt(8)
    ds_read_b64_tr_b16 a[32:33], v26 offset:8192
    ds_read_b64_tr_b16 a[34:35], v26 offset:9216
    ds_read_b64_tr_b16 a[36:37], v27 offset:8192
    ds_read_b64_tr_b16 a[38:39], v27 offset:9216
    s_waitcnt lgkmcnt(4)
    s_add_u32 m0, s75, 6144
    s_add_u32 s80, s80, 57344
    s_cmp_eq_u32 s80, 1835008
    s_cselect_b32 s80, 0, s80
    buffer_load_dwordx4 v24, s[16:19], s80 offen lds
    buffer_load_dwordx4 v25, s[16:19], s80 offen offset:1024 lds
    s_waitcnt vmcnt(8)
    ds_read_b64_tr_b16 a[40:41], v26 offset:10240
    ds_read_b64_tr_b16 a[42:43], v26 offset:11264
    ds_read_b64_tr_b16 a[44:45], v27 offset:10240
    ds_read_b64_tr_b16 a[46:47], v27 offset:11264
    s_waitcnt lgkmcnt(4)
    s_add_u32 m0, s75, 8192
    s_add_u32 s80, s80, 57344
    s_cmp_eq_u32 s80, 1835008
    s_cselect_b32 s80, 0, s80
    buffer_load_dwordx4 v24, s[16:19], s80 offen lds
    buffer_load_dwordx4 v25, s[16:19], s80 offen offset:1024 lds
    s_waitcnt vmcnt(8)
    ds_read_b64_tr_b16 a[48:49], v26 offset:0
    ds_read_b64_tr_b16 a[50:51], v26 offset:1024
    ds_read_b64_tr_b16 a[52:53], v27 offset:0
    ds_read_b64_tr_b16 a[54:55], v27 offset:1024
    s_waitcnt lgkmcnt(4)
    s_add_u32 m0, s75, 10240
    s_add_u32 s80, s80, 57344
    s_cmp_eq_u32 s80, 1835008
    s_cselect_b32 s80, 0, s80
    buffer_load_dwordx4 v24, s[16:19], s80 offen lds
    buffer_load_dwordx4 v25, s[16:19], s80 offen offset:1024 lds
    s_waitcnt vmcnt(8)
    ds_read_b64_tr_b16 a[56:57], v26 offset:2048
    ds_read_b64_tr_b16 a[58:59], v26 offset:3072
    ds_read_b64_tr_b16 a[60:61], v27 offset:2048
    ds_read_b64_tr_b16 a[62:63], v27 offset:3072
    s_waitcnt lgkmcnt(4)
    s_add_u32 m0, s75, 0
    s_add_u32 s80, s80, 57344
    s_cmp_eq_u32 s80, 1835008
    s_cselect_b32 s80, 0, s80
    buffer_load_dwordx4 v24, s[16:19], s80 offen lds
    buffer_load_dwordx4 v25, s[16:19], s80 offen offset:1024 lds
    s_waitcnt vmcnt(8)
    ds_read_b64_tr_b16 a[64:65], v26 offset:4096
    ds_read_b64_tr_b16 a[66:67], v26 offset:5120
    ds_read_b64_tr_b16 a[68:69], v27 offset:4096
    ds_read_b64_tr_b16 a[70:71], v27 offset:5120
    s_waitcnt lgkmcnt(4)
    s_add_u32 m0, s75, 2048
    s_add_u32 s80, s80, 57344
    s_cmp_eq_u32 s80, 1835008
    s_cselect_b32 s80, 0, s80
    buffer_load_dwordx4 v24, s[16:19], s80 offen lds
    buffer_load_dwordx4 v25, s[16:19], s80 offen offset:1024 lds
    s_waitcnt vmcnt(8)
    ds_read_b64_tr_b16 a[72:73], v26 offset:6144
    ds_read_b64_tr_b16 a[74:75], v26 offset:7168
    ds_read_b64_tr_b16 a[76:77], v27 offset:6144
    ds_read_b64_tr_b16 a[78:79], v27 offset:7168
    s_waitcnt lgkmcnt(4)
    s_add_u32 m0, s75, 4096
    s_add_u32 s80, s80, 57344
    s_cmp_eq_u32 s80, 1835008
    s_cselect_b32 s80, 0, s80
    buffer_load_dwordx4 v24, s[16:19], s80 offen lds
    buffer_load_dwordx4 v25, s[16:19], s80 offen offset:1024 lds
    s_waitcnt vmcnt(8)
    ds_read_b64_tr_b16 a[80:81], v26 offset:8192
    ds_read_b64_tr_b16 a[82:83], v26 offset:9216
    ds_read_b64_tr_b16 a[84:85], v27 offset:8192
    ds_read_b64_tr_b16 a[86:87], v27 offset:9216
    s_waitcnt lgkmcnt(4)
    s_nop 0
    s_add_u32 m0, s75, 6144
    s_add_u32 s80, s80, 57344
    s_cmp_eq_u32 s80, 1835008
    s_cselect_b32 s80, 0, s80
    buffer_load_dwordx4 v24, s[16:19], s80 offen lds
    buffer_load_dwordx4 v25, s[16:19], s80 offen offset:1024 lds
    s_waitcnt vmcnt(8)
    ds_read_b64_tr_b16 a[88:89], v26 offset:10240
    ds_read_b64_tr_b16 a[90:91], v26 offset:11264
    ds_read_b64_tr_b16 a[92:93], v27 offset:10240
    ds_read_b64_tr_b16 a[94:95], v27 offset:11264
    s_waitcnt lgkmcnt(4)
    s_add_u32 m0, s75, 8192
    s_add_u32 s80, s80, 57344
    s_cmp_eq_u32 s80, 1835008
    s_cselect_b32 s80, 0, s80
    buffer_load_dwordx4 v24, s[16:19], s80 offen lds
    buffer_load_dwordx4 v25, s[16:19], s80 offen offset:1024 lds
    s_waitcnt vmcnt(8)
    ds_read_b64_tr_b16 a[96:97], v26 offset:0
    ds_read_b64_tr_b16 a[98:99], v26 offset:1024
    ds_read_b64_tr_b16 a[100:101], v27 offset:0
    ds_read_b64_tr_b16 a[102:103], v27 offset:1024
    s_waitcnt lgkmcnt(4)
    s_add_u32 m0, s75, 10240
    s_add_u32 s80, s80, 57344
    s_cmp_eq_u32 s80, 1835008
    s_cselect_b32 s80, 0, s80
    buffer_load_dwordx4 v24, s[16:19], s80 offen lds
    buffer_load_dwordx4 v25, s[16:19], s80 offen offset:1024 lds
    s_waitcnt vmcnt(8)
    ds_read_b64_tr_b16 a[104:105], v26 offset:2048
    ds_read_b64_tr_b16 a[106:107], v26 offset:3072
    ds_read_b64_tr_b16 a[108:109], v27 offset:2048
    ds_read_b64_tr_b16 a[110:111], v27 offset:3072
    s_waitcnt lgkmcnt(4)
    s_add_u32 m0, s75, 0
    s_add_u32 s80, s80, 57344
    s_cmp_eq_u32 s80, 1835008
    s_cselect_b32 s80, 0, s80
    buffer_load_dwordx4 v24, s[16:19], s80 offen lds
    buffer_load_dwordx4 v25, s[16:19], s80 offen offset:1024 lds
    s_waitcnt vmcnt(8)
    ds_read_b64_tr_b16 a[112:113], v26 offset:4096
    ds_read_b64_tr_b16 a[114:115], v26 offset:5120
    ds_read_b64_tr_b16 a[116:117], v27 offset:4096
    ds_read_b64_tr_b16 a[118:119], v27 offset:5120
    s_waitcnt lgkmcnt(4)
    s_add_u32 m0, s75, 2048
    s_add_u32 s80, s80, 57344
    s_cmp_eq_u32 s80, 1835008
    s_cselect_b32 s80, 0, s80
    buffer_load_dwordx4 v24, s[16:19], s80 offen lds
    buffer_load_dwordx4 v25, s[16:19], s80 offen offset:1024 lds
    s_waitcnt vmcnt(8)
    ds_read_b64_tr_b16 a[120:121], v26 offset:6144
    ds_read_b64_tr_b16 a[122:123], v26 offset:7168
    ds_read_b64_tr_b16 a[124:125], v27 offset:6144
    ds_read_b64_tr_b16 a[126:127], v27 offset:7168
    s_waitcnt lgkmcnt(4)
    s_add_u32 m0, s75, 4096
    s_add_u32 s80, s80, 57344
    s_cmp_eq_u32 s80, 1835008
    s_cselect_b32 s80, 0, s80
    buffer_load_dwordx4 v24, s[16:19], s80 offen lds
    buffer_load_dwordx4 v25, s[16:19], s80 offen offset:1024 lds
    s_waitcnt vmcnt(8)
    ds_read_b64_tr_b16 a[216:217], v26 offset:8192
    ds_read_b64_tr_b16 a[218:219], v26 offset:9216
    ds_read_b64_tr_b16 a[220:221], v27 offset:8192
    ds_read_b64_tr_b16 a[222:223], v27 offset:9216
    s_waitcnt lgkmcnt(4)
    s_add_u32 m0, s75, 6144
    s_add_u32 s80, s80, 57344
    s_cmp_eq_u32 s80, 1835008
    s_cselect_b32 s80, 0, s80
    buffer_load_dwordx4 v24, s[16:19], s80 offen lds
    buffer_load_dwordx4 v25, s[16:19], s80 offen offset:1024 lds
    s_waitcnt vmcnt(8)
    ds_read_b64_tr_b16 a[224:225], v26 offset:10240
    ds_read_b64_tr_b16 a[226:227], v26 offset:11264
    ds_read_b64_tr_b16 a[228:229], v27 offset:10240
    ds_read_b64_tr_b16 a[230:231], v27 offset:11264
    s_waitcnt lgkmcnt(4)
    s_add_u32 m0, s75, 8192
    s_add_u32 s80, s80, 57344
    s_cmp_eq_u32 s80, 1835008
    s_cselect_b32 s80, 0, s80
    buffer_load_dwordx4 v24, s[16:19], s80 offen lds
    buffer_load_dwordx4 v25, s[16:19], s80 offen offset:1024 lds
    s_waitcnt vmcnt(8)
    ds_read_b64_tr_b16 a[232:233], v26 offset:0
    ds_read_b64_tr_b16 a[234:235], v26 offset:1024
    ds_read_b64_tr_b16 a[236:237], v27 offset:0
    ds_read_b64_tr_b16 a[238:239], v27 offset:1024
    s_waitcnt lgkmcnt(4)
    s_add_u32 m0, s75, 10240
    s_add_u32 s80, s80, 57344
    s_cmp_eq_u32 s80, 1835008
    s_cselect_b32 s80, 0, s80
    buffer_load_dwordx4 v24, s[16:19], s80 offen lds
    buffer_load_dwordx4 v25, s[16:19], s80 offen offset:1024 lds
    s_waitcnt vmcnt(8)
    ds_read_b64_tr_b16 a[240:241], v26 offset:2048
    ds_read_b64_tr_b16 a[242:243], v26 offset:3072
    ds_read_b64_tr_b16 a[244:245], v27 offset:2048
    ds_read_b64_tr_b16 a[246:247], v27 offset:3072
    s_waitcnt lgkmcnt(4)
    s_add_u32 m0, s75, 0
    s_add_u32 s80, s80, 57344
    s_cmp_eq_u32 s80, 1835008
    s_cselect_b32 s80, 0, s80
    buffer_load_dwordx4 v24, s[16:19], s80 offen lds
    buffer_load_dwordx4 v25, s[16:19], s80 offen offset:1024 lds
    s_waitcnt vmcnt(8)
    ds_read_b64_tr_b16 a[248:249], v26 offset:4096
    ds_read_b64_tr_b16 a[250:251], v26 offset:5120
    ds_read_b64_tr_b16 a[252:253], v27 offset:4096
    ds_read_b64_tr_b16 a[254:255], v27 offset:5120
    s_waitcnt lgkmcnt(4)
    s_add_u32 m0, s75, 2048
    s_add_u32 s80, s80, 57344
    s_cmp_eq_u32 s80, 1835008
    s_cselect_b32 s80, 0, s80
    buffer_load_dwordx4 v24, s[16:19], s80 offen lds
    buffer_load_dwordx4 v25, s[16:19], s80 offen offset:1024 lds
    s_waitcnt lgkmcnt(0)
    s_add_u32 m0, s75, 4096
    s_add_u32 s80, s80, 57344
    s_cmp_eq_u32 s80, 1835008
    s_cselect_b32 s80, 0, s80
    buffer_load_dwordx4 v24, s[16:19], s80 offen lds
    buffer_load_dwordx4 v25, s[16:19], s80 offen offset:1024 lds
    buffer_load_dword v7, v6, s[24:27], s62 offen sc1
    s_mov_b32 s66, s86
    buffer_load_dwordx4 v[192:195], v1, s[24:27], s66 offen offset:0 sc1
    buffer_load_dwordx4 v[196:199], v1, s[24:27], s66 offen offset:1024 sc1
    buffer_load_dwordx4 v[200:203], v1, s[24:27], s66 offen offset:2048 sc1
    buffer_load_dwordx4 v[204:207], v1, s[24:27], s66 offen offset:3072 sc1
    s_add_u32 s66, s66, 4096
    buffer_load_dwordx4 v[208:211], v1, s[24:27], s66 offen offset:0 sc1
    buffer_load_dwordx4 v[212:215], v1, s[24:27], s66 offen offset:1024 sc1
    buffer_load_dwordx4 v[216:219], v1, s[24:27], s66 offen offset:2048 sc1
    buffer_load_dwordx4 v[220:223], v1, s[24:27], s66 offen offset:3072 sc1
    s_add_u32 s66, s66, 4096
    buffer_load_dwordx4 v[224:227], v1, s[24:27], s66 offen offset:0 sc1
    buffer_load_dwordx4 v[228:231], v1, s[24:27], s66 offen offset:1024 sc1
    buffer_load_dwordx4 v[232:235], v1, s[24:27], s66 offen offset:2048 sc1
    buffer_load_dwordx4 v[236:239], v1, s[24:27], s66 offen offset:3072 sc1
    s_add_u32 s66, s66, 4096
    buffer_load_dwordx4 v[240:243], v1, s[24:27], s66 offen offset:0 sc1
    buffer_load_dwordx4 v[244:247], v1, s[24:27], s66 offen offset:1024 sc1
    buffer_load_dwordx4 v[248:251], v1, s[24:27], s66 offen offset:2048 sc1
    buffer_load_dwordx4 v[252:255], v1, s[24:27], s66 offen offset:3072 sc1
    s_waitcnt vmcnt(16)
    v_cmp_ne_u32 vcc, s101, v7
    s_cbranch_vccnz FB_11
FBB_12:
GO_10:
    v_permlane32_swap_b32 v8, v10
    v_permlane32_swap_b32 v9, v11
    v_permlane32_swap_b32 v12, v14
    v_permlane32_swap_b32 v13, v15
    v_lshlrev_b32 v19, 16, v19
    s_xor_b32 s62, s3, 1
    s_lshl_b32 s62, s62, 12
    v_add_u32_e64 v20, s62, v1
    s_barrier
    buffer_load_dword v7, v29, s[24:27], s87 offen offset:272 sc1
    s_mov_b32 s68, s87
    buffer_load_dwordx4 v[128:131], v28, s[24:27], s68 offen offset:0 sc1
    buffer_load_dwordx4 v[132:135], v28, s[24:27], s68 offen offset:768 sc1
    buffer_load_dwordx4 v[136:139], v28, s[24:27], s68 offen offset:1536 sc1
    buffer_load_dwordx4 v[140:143], v28, s[24:27], s68 offen offset:2304 sc1
    s_add_u32 s68, s68, 3072
    buffer_load_dwordx4 v[144:147], v28, s[24:27], s68 offen offset:0 sc1
    buffer_load_dwordx4 v[148:151], v28, s[24:27], s68 offen offset:768 sc1
    buffer_load_dwordx4 v[152:155], v28, s[24:27], s68 offen offset:1536 sc1
    buffer_load_dwordx4 v[156:159], v28, s[24:27], s68 offen offset:2304 sc1
    s_add_u32 s68, s68, 3072
    buffer_load_dwordx4 v[160:163], v28, s[24:27], s68 offen offset:0 sc1
    buffer_load_dwordx4 v[164:167], v28, s[24:27], s68 offen offset:768 sc1
    s_waitcnt vmcnt(10)
    v_cmp_ne_u32_e64 vcc, s101, v7
    s_cbranch_vccnz FB_20
FBB_21:
GO_19:
    ds_read_b64_tr_b16 v[104:105], v2 offset:0
    ds_read_b64_tr_b16 v[106:107], v2 offset:1024
    ds_read_b64_tr_b16 v[108:109], v3 offset:0
    ds_read_b64_tr_b16 v[110:111], v3 offset:1024
    ds_read_b64_tr_b16 v[112:113], v2 offset:2048
    ds_read_b64_tr_b16 v[114:115], v2 offset:3072
    ds_read_b64_tr_b16 v[116:117], v3 offset:2048
    ds_read_b64_tr_b16 v[118:119], v3 offset:3072
    v_mov_b32 v30, 0
    s_waitcnt vmcnt(9)
    v_mfma_f32_32x32x16_bf16 v[64:79], v[128:131], v[192:195], 0
    v_max3_u32 v30, v30, v128, v192
    buffer_load_dwordx4 v[168:171], v28, s[24:27], s68 offen offset:1536 sc1
    s_waitcnt vmcnt(9)
    v_mfma_f32_32x32x16_bf16 v[80:95], v[132:135], v[196:199], 0
    v_max3_u32 v30, v30, v132, v196
    buffer_load_dwordx4 v[172:175], v28, s[24:27], s68 offen offset:2304 sc1
    s_nop 5
    v_add_f32 v72, s60, v72
    v_rcp_f32 v72, v72
    s_nop 0
    v_mul_f32 v64, v64, v72
    v_mul_f32 v65, v65, v72
    v_mul_f32 v66, v66, v72
    v_mul_f32_e64 v67, v67, v72
    v_cvt_pk_bf16_f32 v96, v64, v65
    v_cvt_pk_bf16_f32 v97, v66, v67
    v_mul_f32 v68, v68, v72
    v_mul_f32 v69, v69, v72
    v_mul_f32_e64 v70, v70, v72
    v_mul_f32 v71, v71, v72
    v_cvt_pk_bf16_f32 v98, v68, v69
    v_cvt_pk_bf16_f32 v99, v70, v71
    s_waitcnt vmcnt(9)
    v_mfma_f32_32x32x16_bf16 v[64:79], v[136:139], v[200:203], 0
    v_max3_u32 v30, v30, v136, v200
    s_add_u32 s68, s68, 3072
    buffer_load_dwordx4 v[176:179], v28, s[24:27], s68 offen offset:0 sc1
    v_add_f32_e64 v88, s60, v88
    v_rcp_f32 v88, v88
    s_waitcnt lgkmcnt(4)
    v_mfma_f32_32x32x16_bf16 v[48:63], v[108:111], v[96:99], 0
    v_mul_f32 v80, v80, v88
    v_mul_f32 v81, v81, v88
    v_mul_f32 v82, v82, v88
    v_mul_f32 v83, v83, v88
    v_cvt_pk_bf16_f32 v100, v80, v81
    v_cvt_pk_bf16_f32 v101, v82, v83
    v_mfma_f32_32x32x16_bf16 v[32:47], v[104:107], v[96:99], 0
    v_mul_f32 v84, v84, v88
    v_mul_f32 v85, v85, v88
    v_mul_f32_e64 v86, v86, v88
    v_mul_f32 v87, v87, v88
    v_cvt_pk_bf16_f32 v102, v84, v85
    v_cvt_pk_bf16_f32 v103, v86, v87
    s_waitcnt vmcnt(9)
    v_mfma_f32_32x32x16_bf16 v[80:95], v[140:143], v[204:207], 0
    v_max3_u32 v30, v30, v140, v204
    buffer_load_dwordx4 v[180:183], v28, s[24:27], s68 offen offset:768 sc1
    ds_read_b64_tr_b16 v[120:121], v2 offset:4096
    ds_read_b64_tr_b16 v[122:123], v2 offset:5120
    ds_read_b64_tr_b16 v[124:125], v3 offset:4096
    ds_read_b64_tr_b16 v[126:127], v3 offset:5120
    v_add_f32_e64 v72, s60, v72
    v_rcp_f32 v72, v72
    s_waitcnt lgkmcnt(4)
    v_mfma_f32_32x32x16_bf16 v[48:63], v[116:119], v[100:103], v[48:63]
    v_mul_f32 v64, v64, v72
    v_mul_f32 v65, v65, v72
    v_mul_f32 v66, v66, v72
    v_mul_f32 v67, v67, v72
    v_cvt_pk_bf16_f32 v96, v64, v65
    v_cvt_pk_bf16_f32 v97, v66, v67
    v_mfma_f32_32x32x16_bf16 v[32:47], v[112:115], v[100:103], v[32:47]
    v_mul_f32 v68, v68, v72
    v_mul_f32 v69, v69, v72
    v_mul_f32_e64 v70, v70, v72
    v_mul_f32 v71, v71, v72
    v_cvt_pk_bf16_f32 v98, v68, v69
    v_cvt_pk_bf16_f32 v99, v70, v71
    s_waitcnt vmcnt(9)
    v_mfma_f32_32x32x16_bf16 v[64:79], v[144:147], v[208:211], 0
    v_max3_u32 v30, v30, v144, v208
    buffer_load_dwordx4 v[184:187], v28, s[24:27], s68 offen offset:1536 sc1
    ds_read_b64_tr_b16 v[104:105], v2 offset:6144
    ds_read_b64_tr_b16 v[106:107], v2 offset:7168
    ds_read_b64_tr_b16 v[108:109], v3 offset:6144
    ds_read_b64_tr_b16 v[110:111], v3 offset:7168
    v_add_f32_e64 v88, s60, v88
    v_rcp_f32 v88, v88
    s_waitcnt lgkmcnt(4)
    v_mfma_f32_32x32x16_bf16 v[48:63], v[124:127], v[96:99], v[48:63]
    v_mul_f32 v80, v80, v88
    v_mul_f32 v81, v81, v88
    v_mul_f32 v82, v82, v88
    v_mul_f32 v83, v83, v88
    v_cvt_pk_bf16_f32 v100, v80, v81
    v_cvt_pk_bf16_f32 v101, v82, v83
    v_mfma_f32_32x32x16_bf16 v[32:47], v[120:123], v[96:99], v[32:47]
    v_mul_f32 v84, v84, v88
    v_mul_f32 v85, v85, v88
    v_mul_f32_e64 v86, v86, v88
    v_mul_f32 v87, v87, v88
    v_cvt_pk_bf16_f32 v102, v84, v85
    v_cvt_pk_bf16_f32 v103, v86, v87
    s_waitcnt vmcnt(9)
    v_mfma_f32_32x32x16_bf16 v[80:95], v[148:151], v[212:215], 0
    v_max3_u32 v30, v30, v148, v212
    buffer_load_dwordx4 v[188:191], v28, s[24:27], s68 offen offset:2304 sc1
    ds_read_b64_tr_b16 v[112:113], v2 offset:8192
    ds_read_b64_tr_b16 v[114:115], v2 offset:9216
    ds_read_b64_tr_b16 v[116:117], v3 offset:8192
    ds_read_b64_tr_b16 v[118:119], v3 offset:9216
    v_add_f32_e64 v72, s60, v72
    v_rcp_f32 v72, v72
    s_waitcnt lgkmcnt(4)
    v_mfma_f32_32x32x16_bf16 v[48:63], v[108:111], v[100:103], v[48:63]
    v_mul_f32 v64, v64, v72
    v_mul_f32 v65, v65, v72
    v_mul_f32 v66, v66, v72
    v_mul_f32 v67, v67, v72
    v_cvt_pk_bf16_f32 v96, v64, v65
    v_cvt_pk_bf16_f32 v97, v66, v67
    v_mfma_f32_32x32x16_bf16 v[32:47], v[104:107], v[100:103], v[32:47]
    v_mul_f32 v68, v68, v72
    v_mul_f32 v69, v69, v72
    v_mul_f32_e64 v70, v70, v72
    v_mul_f32 v71, v71, v72
    v_cvt_pk_bf16_f32 v98, v68, v69
    v_cvt_pk_bf16_f32 v99, v70, v71
    s_waitcnt vmcnt(9)
    v_mfma_f32_32x32x16_bf16 v[64:79], v[152:155], v[216:219], 0
    v_max3_u32 v30, v30, v152, v216
    s_lshr_b32 s66, s83, 3
    s_add_u32 s66, s66, s78
    s_sub_u32 s67, s66, 28
    s_cselect_b32 s66, s66, s67
    s_and_b32 s67, s83, 3
    s_mul_i32 s67, s67, 28
    s_add_u32 s66, s66, s67
    s_lshl_b32 s66, s66, 1
    s_bfe_u32 s67, s83, 0x10002
    s_add_u32 s66, s66, s67
    s_lshl_b32 s66, s66, 15
    s_and_b32 s67, s61, 7
    s_lshl_b32 s67, s67, 9
    s_add_u32 s66, s66, s67
    s_cmp_eq_u32 s54, 7
    s_cselect_b32 s66, 0x10000000, s66
    v_min_u32 v4, 31, v0
    v_lshrrev_b32 v5, 2, v4
    v_and_b32 v4, 3, v4
    v_lshlrev_b32 v4, 7, v4
    v_lshl_add_u32 v4, v5, 12, v4
    buffer_load_dword v31, v4, s[20:23], s66 offen
    ds_read_b64_tr_b16 v[120:121], v2 offset:10240
    ds_read_b64_tr_b16 v[122:123], v2 offset:11264
    ds_read_b64_tr_b16 v[124:125], v3 offset:10240
    ds_read_b64_tr_b16 v[126:127], v3 offset:11264
    v_add_f32_e64 v88, s60, v88
    v_rcp_f32 v88, v88
    s_waitcnt lgkmcnt(4)
    v_mfma_f32_32x32x16_bf16 v[48:63], v[116:119], v[96:99], v[48:63]
    v_mul_f32 v80, v80, v88
    v_mul_f32 v81, v81, v88
    v_mul_f32 v82, v82, v88
    v_mul_f32 v83, v83, v88
    v_cvt_pk_bf16_f32 v100, v80, v81
    v_cvt_pk_bf16_f32 v101, v82, v83
    v_mfma_f32_32x32x16_bf16 v[32:47], v[112:115], v[96:99], v[32:47]
    v_mul_f32 v84, v84, v88
    v_mul_f32 v85, v85, v88
    v_mul_f32_e64 v86, v86, v88
    v_mul_f32 v87, v87, v88
    v_cvt_pk_bf16_f32 v102, v84, v85
    v_cvt_pk_bf16_f32 v103, v86, v87
    s_waitcnt vmcnt(9)
    v_mfma_f32_32x32x16_bf16 v[80:95], v[156:159], v[220:223], 0
    v_max3_u32 v30, v30, v156, v220
    ds_read_b64_tr_b16 v[104:105], v2 offset:12288
    ds_read_b64_tr_b16 v[106:107], v2 offset:13312
    ds_read_b64_tr_b16 v[108:109], v3 offset:12288
    ds_read_b64_tr_b16 v[110:111], v3 offset:13312
    v_add_f32_e64 v72, s60, v72
    v_rcp_f32 v72, v72
    s_waitcnt lgkmcnt(4)
    v_mfma_f32_32x32x16_bf16 v[48:63], v[124:127], v[100:103], v[48:63]
    v_mul_f32 v64, v64, v72
    v_mul_f32 v65, v65, v72
    v_mul_f32 v66, v66, v72
    v_mul_f32 v67, v67, v72
    v_cvt_pk_bf16_f32 v96, v64, v65
    v_cvt_pk_bf16_f32 v97, v66, v67
    v_mfma_f32_32x32x16_bf16 v[32:47], v[120:123], v[100:103], v[32:47]
    v_mul_f32 v68, v68, v72
    v_mul_f32 v69, v69, v72
    v_mul_f32_e64 v70, v70, v72
    v_mul_f32 v71, v71, v72
    v_cvt_pk_bf16_f32 v98, v68, v69
    v_cvt_pk_bf16_f32 v99, v70, v71
    s_waitcnt vmcnt(8)
    v_mfma_f32_32x32x16_bf16 v[64:79], v[160:163], v[224:227], 0
    v_max3_u32 v30, v30, v160, v224
    ds_read_b64_tr_b16 v[112:113], v2 offset:14336
    ds_read_b64_tr_b16 v[114:115], v2 offset:15360
    ds_read_b64_tr_b16 v[116:117], v3 offset:14336
    ds_read_b64_tr_b16 v[118:119], v3 offset:15360
    v_add_f32_e64 v88, s60, v88
    v_rcp_f32 v88, v88
    s_waitcnt lgkmcnt(4)
    v_mfma_f32_32x32x16_bf16 v[48:63], v[108:111], v[96:99], v[48:63]
    v_mul_f32 v80, v80, v88
    v_mul_f32 v81, v81, v88
    v_mul_f32 v82, v82, v88
    v_mul_f32 v83, v83, v88
    v_cvt_pk_bf16_f32 v100, v80, v81
    v_cvt_pk_bf16_f32 v101, v82, v83
    v_mfma_f32_32x32x16_bf16 v[32:47], v[104:107], v[96:99], v[32:47]
    v_mul_f32_e64 v84, v84, v88
    v_mul_f32_e64 v85, v85, v88
    v_mul_f32_e64 v86, v86, v88
    v_mul_f32 v87, v87, v88
    v_cvt_pk_bf16_f32 v102, v84, v85
    v_cvt_pk_bf16_f32 v103, v86, v87
    s_waitcnt vmcnt(7)
    v_mfma_f32_32x32x16_bf16 v[80:95], v[164:167], v[228:231], 0
    v_max3_u32 v30, v30, v164, v228
    ds_read_b64_tr_b16 v[120:121], v2 offset:16384
    ds_read_b64_tr_b16 v[122:123], v2 offset:17408
    ds_read_b64_tr_b16 v[124:125], v3 offset:16384
    ds_read_b64_tr_b16 v[126:127], v3 offset:17408
    v_add_f32_e64 v72, s60, v72
    v_rcp_f32 v72, v72
    s_waitcnt lgkmcnt(4)
    v_mfma_f32_32x32x16_bf16 v[48:63], v[116:119], v[100:103], v[48:63]
    v_mul_f32 v64, v64, v72
    v_mul_f32 v65, v65, v72
    v_mul_f32 v66, v66, v72
    v_mul_f32 v67, v67, v72
    v_cvt_pk_bf16_f32 v96, v64, v65
    v_cvt_pk_bf16_f32 v97, v66, v67
    v_mfma_f32_32x32x16_bf16 v[32:47], v[112:115], v[100:103], v[32:47]
    v_mul_f32_e64 v68, v68, v72
    v_mul_f32_e64 v69, v69, v72
    v_mul_f32_e64 v70, v70, v72
    v_mul_f32 v71, v71, v72
    v_cvt_pk_bf16_f32 v98, v68, v69
    v_cvt_pk_bf16_f32 v99, v70, v71
    s_waitcnt vmcnt(6)
    v_mfma_f32_32x32x16_bf16 v[64:79], v[168:171], v[232:235], 0
    v_max3_u32 v30, v30, v168, v232
    ds_read_b64_tr_b16 v[104:105], v2 offset:18432
    ds_read_b64_tr_b16 v[106:107], v2 offset:19456
    ds_read_b64_tr_b16 v[108:109], v3 offset:18432
    ds_read_b64_tr_b16 v[110:111], v3 offset:19456
    v_add_f32_e64 v88, s60, v88
    v_rcp_f32 v88, v88
    s_waitcnt lgkmcnt(4)
    v_mfma_f32_32x32x16_bf16 v[48:63], v[124:127], v[96:99], v[48:63]
    v_mul_f32 v80, v80, v88
    v_mul_f32 v81, v81, v88
    v_mul_f32 v82, v82, v88
    v_mul_f32 v83, v83, v88
    v_cvt_pk_bf16_f32 v100, v80, v81
    v_cvt_pk_bf16_f32 v101, v82, v83
    v_mfma_f32_32x32x16_bf16 v[32:47], v[120:123], v[96:99], v[32:47]
    v_mul_f32_e64 v84, v84, v88
    v_mul_f32_e64 v85, v85, v88
    v_mul_f32_e64 v86, v86, v88
    v_mul_f32 v87, v87, v88
    v_cvt_pk_bf16_f32 v102, v84, v85
    v_cvt_pk_bf16_f32 v103, v86, v87
    s_waitcnt vmcnt(5)
    v_mfma_f32_32x32x16_bf16 v[80:95], v[172:175], v[236:239], 0
    v_max3_u32 v30, v30, v172, v236
    ds_read_b64_tr_b16 v[112:113], v2 offset:20480
    ds_read_b64_tr_b16 v[114:115], v2 offset:21504
    ds_read_b64_tr_b16 v[116:117], v3 offset:20480
    ds_read_b64_tr_b16 v[118:119], v3 offset:21504
    v_add_f32_e64 v72, s60, v72
    v_rcp_f32 v72, v72
    s_waitcnt lgkmcnt(4)
    v_mfma_f32_32x32x16_bf16 v[48:63], v[108:111], v[100:103], v[48:63]
    v_mul_f32 v64, v64, v72
    v_mul_f32 v65, v65, v72
    v_mul_f32 v66, v66, v72
    v_mul_f32 v67, v67, v72
    v_cvt_pk_bf16_f32 v96, v64, v65
    v_cvt_pk_bf16_f32 v97, v66, v67
    v_mfma_f32_32x32x16_bf16 v[32:47], v[104:107], v[100:103], v[32:47]
    v_mul_f32_e64 v68, v68, v72
    v_mul_f32_e64 v69, v69, v72
    v_mul_f32_e64 v70, v70, v72
    v_mul_f32 v71, v71, v72
    v_cvt_pk_bf16_f32 v98, v68, v69
    v_cvt_pk_bf16_f32 v99, v70, v71
    s_waitcnt vmcnt(4)
    v_mfma_f32_32x32x16_bf16 v[64:79], v[176:179], v[240:243], 0
    v_max3_u32 v30, v30, v176, v240
    ds_read_b64_tr_b16 v[120:121], v2 offset:22528
    ds_read_b64_tr_b16 v[122:123], v2 offset:23552
    ds_read_b64_tr_b16 v[124:125], v3 offset:22528
    ds_read_b64_tr_b16 v[126:127], v3 offset:23552
    v_add_f32_e64 v88, s60, v88
    v_rcp_f32 v88, v88
    s_waitcnt lgkmcnt(4)
    v_mfma_f32_32x32x16_bf16 v[48:63], v[116:119], v[96:99], v[48:63]
    v_mul_f32 v80, v80, v88
    v_mul_f32 v81, v81, v88
    v_mul_f32 v82, v82, v88
    v_mul_f32 v83, v83, v88
    v_cvt_pk_bf16_f32 v100, v80, v81
    v_cvt_pk_bf16_f32 v101, v82, v83
    v_mfma_f32_32x32x16_bf16 v[32:47], v[112:115], v[96:99], v[32:47]
    v_mul_f32_e64 v84, v84, v88
    v_mul_f32_e64 v85, v85, v88
    v_mul_f32_e64 v86, v86, v88
    v_mul_f32 v87, v87, v88
    v_cvt_pk_bf16_f32 v102, v84, v85
    v_cvt_pk_bf16_f32 v103, v86, v87
    s_waitcnt vmcnt(3)
    v_mfma_f32_32x32x16_bf16 v[80:95], v[180:183], v[244:247], 0
    v_max3_u32 v30, v30, v180, v244
    ds_read_b64_tr_b16 v[104:105], v2 offset:24576
    ds_read_b64_tr_b16 v[106:107], v2 offset:25600
    ds_read_b64_tr_b16 v[108:109], v3 offset:24576
    ds_read_b64_tr_b16 v[110:111], v3 offset:25600
    v_add_f32_e64 v72, s60, v72
    v_rcp_f32 v72, v72
    s_waitcnt lgkmcnt(4)
    v_mfma_f32_32x32x16_bf16 v[48:63], v[124:127], v[100:103], v[48:63]
    v_mul_f32 v64, v64, v72
    v_mul_f32 v65, v65, v72
    v_mul_f32 v66, v66, v72
    v_mul_f32 v67, v67, v72
    v_cvt_pk_bf16_f32 v96, v64, v65
    v_cvt_pk_bf16_f32 v97, v66, v67
    v_mfma_f32_32x32x16_bf16 v[32:47], v[120:123], v[100:103], v[32:47]
    v_mul_f32_e64 v68, v68, v72
    v_mul_f32_e64 v69, v69, v72
    v_mul_f32_e64 v70, v70, v72
    v_mul_f32 v71, v71, v72
    v_cvt_pk_bf16_f32 v98, v68, v69
    v_cvt_pk_bf16_f32 v99, v70, v71
    s_waitcnt vmcnt(2)
    v_mfma_f32_32x32x16_bf16 v[64:79], v[184:187], v[248:251], 0
    v_max3_u32 v30, v30, v184, v248
    ds_read_b64_tr_b16 v[112:113], v2 offset:26624
    ds_read_b64_tr_b16 v[114:115], v2 offset:27648
    ds_read_b64_tr_b16 v[116:117], v3 offset:26624
    ds_read_b64_tr_b16 v[118:119], v3 offset:27648
    v_add_f32_e64 v88, s60, v88
    v_rcp_f32 v88, v88
    s_waitcnt lgkmcnt(4)
    v_mfma_f32_32x32x16_bf16 v[48:63], v[108:111], v[96:99], v[48:63]
    v_mul_f32 v80, v80, v88
    v_mul_f32 v81, v81, v88
    v_mul_f32 v82, v82, v88
    v_mul_f32 v83, v83, v88
    v_cvt_pk_bf16_f32 v100, v80, v81
    v_cvt_pk_bf16_f32 v101, v82, v83
    v_mfma_f32_32x32x16_bf16 v[32:47], v[104:107], v[96:99], v[32:47]
    v_mul_f32_e64 v84, v84, v88
    v_mul_f32_e64 v85, v85, v88
    v_mul_f32_e64 v86, v86, v88
    v_mul_f32 v87, v87, v88
    v_cvt_pk_bf16_f32 v102, v84, v85
    v_cvt_pk_bf16_f32 v103, v86, v87
    s_waitcnt vmcnt(1)
    v_mfma_f32_32x32x16_bf16 v[80:95], v[188:191], v[252:255], 0
    v_max3_u32 v30, v30, v188, v252
    ds_read_b64_tr_b16 v[120:121], v2 offset:28672
    ds_read_b64_tr_b16 v[122:123], v2 offset:29696
    ds_read_b64_tr_b16 v[124:125], v3 offset:28672
    ds_read_b64_tr_b16 v[126:127], v3 offset:29696
    v_add_f32_e64 v72, s60, v72
    v_rcp_f32 v72, v72
    s_waitcnt lgkmcnt(4)
    v_mfma_f32_32x32x16_bf16 v[48:63], v[116:119], v[100:103], v[48:63]
    v_mul_f32 v64, v64, v72
    v_mul_f32 v65, v65, v72
    v_mul_f32 v66, v66, v72
    v_mul_f32 v67, v67, v72
    v_cvt_pk_bf16_f32 v96, v64, v65
    v_cvt_pk_bf16_f32 v97, v66, v67
    v_mfma_f32_32x32x16_bf16 v[32:47], v[112:115], v[100:103], v[32:47]
    v_mul_f32 v68, v68, v72
    v_mul_f32 v69, v69, v72
    v_mul_f32 v70, v70, v72
    v_mul_f32 v71, v71, v72
    v_cvt_pk_bf16_f32 v98, v68, v69
    v_cvt_pk_bf16_f32 v99, v70, v71
    ds_read_b64_tr_b16 v[104:105], v2 offset:30720
    ds_read_b64_tr_b16 v[106:107], v2 offset:31744
    ds_read_b64_tr_b16 v[108:109], v3 offset:30720
    ds_read_b64_tr_b16 v[110:111], v3 offset:31744
    v_add_f32_e64 v88, s60, v88
    v_rcp_f32 v88, v88
    s_waitcnt lgkmcnt(4)
    v_mfma_f32_32x32x16_bf16 v[48:63], v[124:127], v[96:99], v[48:63]
    v_mul_f32 v80, v80, v88
    v_mul_f32 v81, v81, v88
    v_mul_f32 v82, v82, v88
    v_mul_f32 v83, v83, v88
    v_cvt_pk_bf16_f32 v100, v80, v81
    v_cvt_pk_bf16_f32 v101, v82, v83
    v_mfma_f32_32x32x16_bf16 v[32:47], v[120:123], v[96:99], v[32:47]
    v_mul_f32 v84, v84, v88
    v_mul_f32 v85, v85, v88
    v_mul_f32 v86, v86, v88
    v_mul_f32 v87, v87, v88
    v_cvt_pk_bf16_f32 v102, v84, v85
    v_cvt_pk_bf16_f32 v103, v86, v87
    s_waitcnt lgkmcnt(0)
    s_nop 0
    v_mfma_f32_32x32x16_bf16 v[48:63], v[108:111], v[100:103], v[48:63]
    v_mfma_f32_32x32x16_bf16 v[32:47], v[104:107], v[100:103], v[32:47]
    v_cmp_eq_u32 vcc, -1, v30
    s_cbranch_vccnz VBAD_27
VOK_26:
    s_lshl_b32 s62, s53, 103
    s_lshl_b32 s67, s55, 6
    s_add_u32 s62, s62, s67
    s_lshl_b32 s67, s56, 5
    s_add_u32 s62, s62, s67
    v_lshlrev_b32 v4, 3, v21
    buffer_load_dwordx2 v[152:153], v4, s[36:39], s62 offen offset:0
    buffer_load_dwordx2 v[154:155], v4, s[36:39], s62 offen offset:16
    s_nop 0
    ds_write_b128 v20, v[56:59] offset:2048
    ds_write_b128 v20, v[60:63] offset:3072
    ds_write_b128 v20, v[40:43] offset:0
    ds_write_b128 v20, v[44:47] offset:1024
    v_lshlrev_b32_e64 v64, 16, v8
    v_and_b32 v65, 0xffff0000, v8
    v_lshlrev_b32_e64 v66, 16, v9
    v_and_b32 v67, 0xffff0000, v9
    v_lshlrev_b32_e64 v68, 16, v10
    v_and_b32 v69, 0xffff0000, v10
    v_lshlrev_b32_e64 v70, 16, v11
    v_and_b32 v71, 0xffff0000, v11
    v_lshlrev_b32_e64 v72, 16, v12
    v_and_b32 v73, 0xffff0000, v12
    v_lshlrev_b32_e64 v74, 16, v13
    v_and_b32 v75, 0xffff0000, v13
    v_lshlrev_b32_e64 v76, 16, v14
    v_and_b32 v77, 0xffff0000, v14
    v_lshlrev_b32_e64 v78, 16, v15
    v_and_b32 v79, 0xffff0000, v15
    v_xor_b32 v5, 4096, v20
    v_pk_add_f32 v[48:49], v[48:49], v[72:73]
    v_pk_add_f32 v[50:51], v[50:51], v[74:75]
    v_pk_add_f32 v[52:53], v[52:53], v[76:77]
    v_pk_add_f32 v[54:55], v[54:55], v[78:79]
    v_pk_add_f32 v[32:33], v[32:33], v[64:65]
    v_pk_add_f32 v[34:35], v[34:35], v[66:67]
    v_pk_add_f32 v[36:37], v[36:37], v[68:69]
    v_pk_add_f32 v[38:39], v[38:39], v[70:71]
    s_waitcnt lgkmcnt(0)
    s_barrier
    ds_read_b128 v[64:67], v5 offset:0
    ds_read_b128 v[68:71], v5 offset:1024
    ds_read_b128 v[72:75], v5 offset:2048
    ds_read_b128 v[76:79], v5 offset:3072
    s_waitcnt lgkmcnt(3)
    v_pk_add_f32 v[32:33], v[32:33], v[64:65]
    v_pk_add_f32 v[34:35], v[34:35], v[66:67]
    v_cvt_pk_bf16_f32 v8, v32, v33
    v_cvt_pk_bf16_f32 v9, v34, v35
    s_waitcnt lgkmcnt(2)
    v_pk_add_f32 v[36:37], v[36:37], v[68:69]
    v_pk_add_f32 v[38:39], v[38:39], v[70:71]
    v_cvt_pk_bf16_f32 v10, v36, v37
    v_cvt_pk_bf16_f32 v11, v38, v39
    s_waitcnt lgkmcnt(1)
    v_pk_add_f32 v[48:49], v[48:49], v[72:73]
    v_pk_add_f32 v[50:51], v[50:51], v[74:75]
    v_cvt_pk_bf16_f32 v12, v48, v49
    v_cvt_pk_bf16_f32 v13, v50, v51
    s_waitcnt lgkmcnt(0)
    v_pk_add_f32 v[52:53], v[52:53], v[76:77]
    v_pk_add_f32 v[54:55], v[54:55], v[78:79]
    v_cvt_pk_bf16_f32 v14, v52, v53
    v_cvt_pk_bf16_f32 v15, v54, v55
    v_dot2_f32_bf16 v96, v8, s59, 0
    v_dot2_f32_bf16 v97, v8, v8, 0
    v_dot2_f32_bf16 v98, v9, s59, 0
    v_dot2_f32_bf16 v99, v9, v9, 0
    v_dot2_f32_bf16 v96, v10, s59, v96
    v_dot2_f32_bf16 v97, v10, v10, v97
    v_dot2_f32_bf16 v98, v11, s59, v98
    v_dot2_f32_bf16 v99, v11, v11, v99
    v_dot2_f32_bf16 v96, v12, s59, v96
    v_dot2_f32_bf16 v97, v12, v12, v97
    v_dot2_f32_bf16 v98, v13, s59, v98
    v_dot2_f32_bf16 v99, v13, v13, v99
    v_dot2_f32_bf16 v96, v14, s59, v96
    v_dot2_f32_bf16 v97, v14, v14, v97
    v_dot2_f32_bf16 v98, v15, s59, v98
    v_dot2_f32_bf16 v99, v15, v15, v99
    v_lshlrev_b32 v4, 3, v0
    s_nop 1
    v_pk_add_f32 v[96:97], v[96:97], v[98:99]
    v_mov_b32_e64 v98, v96
    v_mov_b32 v99, v97
    s_nop 0
    v_permlane32_swap_b32 v96, v98
    v_permlane32_swap_b32 v97, v99
    v_pk_add_f32 v[96:97], v[96:97], v[98:99]
    s_mov_b32 exec_hi, 0
    v_and_b32 v97, 0x7fffffff, v97
    buffer_store_dwordx2 v[96:97], v4, s[24:27], s88 offen sc1
    s_mov_b64 exec, -1
    ds_read_b64_tr_b16 v[160:161], v26 offset:6144
    ds_read_b64_tr_b16 v[162:163], v26 offset:7168
    ds_read_b64_tr_b16 v[164:165], v27 offset:6144
    ds_read_b64_tr_b16 v[166:167], v27 offset:7168
    ds_read_b64_tr_b16 v[168:169], v26 offset:8192
    ds_read_b64_tr_b16 v[170:171], v26 offset:9216
    ds_read_b64_tr_b16 v[172:173], v27 offset:8192
    ds_read_b64_tr_b16 v[174:175], v27 offset:9216
    ds_read_b64_tr_b16 v[176:177], v26 offset:10240
    ds_read_b64_tr_b16 v[178:179], v26 offset:11264
    ds_read_b64_tr_b16 v[180:181], v27 offset:10240
    ds_read_b64_tr_b16 v[182:183], v27 offset:11264
    ds_read_b64_tr_b16 v[184:185], v26 offset:0
    ds_read_b64_tr_b16 v[186:187], v26 offset:1024
    ds_read_b64_tr_b16 v[188:189], v27 offset:0
    ds_read_b64_tr_b16 v[190:191], v27 offset:1024
    ds_read_b64_tr_b16 v[192:193], v26 offset:2048
    ds_read_b64_tr_b16 v[194:195], v26 offset:3072
    ds_read_b64_tr_b16 v[196:197], v27 offset:2048
    ds_read_b64_tr_b16 v[198:199], v27 offset:3072
    ds_read_b64_tr_b16 v[200:201], v26 offset:4096
    ds_read_b64_tr_b16 v[202:203], v26 offset:5120
    ds_read_b64_tr_b16 v[204:205], v27 offset:4096
    ds_read_b64_tr_b16 v[206:207], v27 offset:5120
    s_waitcnt lgkmcnt(15)
    s_add_u32 m0, s75, 6144
    s_add_u32 s80, s80, 57344
    s_cmp_eq_u32 s80, 1835008
    s_cselect_b32 s80, 0, s80
    buffer_load_dwordx4 v24, s[16:19], s80 offen lds
    buffer_load_dwordx4 v25, s[16:19], s80 offen offset:1024 lds
    s_add_u32 m0, s75, 8192
    s_add_u32 s80, s80, 57344
    s_cmp_eq_u32 s80, 1835008
    s_cselect_b32 s80, 0, s80
    buffer_load_dwordx4 v24, s[16:19], s80 offen lds
    buffer_load_dwordx4 v25, s[16:19], s80 offen offset:1024 lds
    s_waitcnt lgkmcnt(12)
    s_nop 0
    s_add_u32 m0, s75, 10240
    s_add_u32 s80, s80, 57344
    s_cmp_eq_u32 s80, 1835008
    s_cselect_b32 s80, 0, s80
    buffer_load_dwordx4 v24, s[16:19], s80 offen lds
    buffer_load_dwordx4 v25, s[16:19], s80 offen offset:1024 lds
    s_waitcnt lgkmcnt(8)
    s_add_u32 m0, s75, 0
    s_add_u32 s80, s80, 57344
    s_cmp_eq_u32 s80, 1835008
    s_cselect_b32 s80, 0, s80
    buffer_load_dwordx4 v24, s[16:19], s80 offen lds
    buffer_load_dwordx4 v25, s[16:19], s80 offen offset:1024 lds
    s_waitcnt lgkmcnt(4)
    s_add_u32 m0, s75, 2048
    s_add_u32 s80, s80, 57344
    s_cmp_eq_u32 s80, 1835008
    s_cselect_b32 s80, 0, s80
    buffer_load_dwordx4 v24, s[16:19], s80 offen lds
    buffer_load_dwordx4 v25, s[16:19], s80 offen offset:1024 lds
    v_lshlrev_b32 v64, 16, v8
    v_and_b32 v65, 0xffff0000, v8
    v_lshlrev_b32_e64 v66, 16, v9
    v_and_b32 v67, 0xffff0000, v9
    v_lshlrev_b32_e64 v68, 16, v10
    v_and_b32 v69, 0xffff0000, v10
    v_lshlrev_b32_e64 v70, 16, v11
    v_and_b32 v71, 0xffff0000, v11
    v_lshlrev_b32_e64 v72, 16, v12
    v_and_b32 v73, 0xffff0000, v12
    v_lshlrev_b32_e64 v74, 16, v13
    v_and_b32 v75, 0xffff0000, v13
    v_lshlrev_b32_e64 v76, 16, v14
    v_and_b32 v77, 0xffff0000, v14
    v_lshlrev_b32_e64 v78, 16, v15
    v_and_b32 v79, 0xffff0000, v15
    v_and_b32 v4, 31, v0
    v_lshlrev_b32 v5, 2, v21
    v_sub_u32_e64 v4, v4, v5
    v_mov_b32 v7, 0x3f80
    v_subrev_u32 v5, 0, v4
    v_cmp_gt_u32 vcc, 2, v5
    v_lshlrev_b32 v5, 4, v5
    v_lshlrev_b32 v6, v5, v7
    v_cndmask_b32 v104, 0, v6, vcc
    v_subrev_u32 v5, 2, v4
    v_cmp_gt_u32 vcc, 2, v5
    v_lshlrev_b32 v5, 4, v5
    v_lshlrev_b32 v6, v5, v7
    v_cndmask_b32 v105, 0, v6, vcc
    v_subrev_u32 v5, 8, v4
    v_cmp_gt_u32 vcc, 2, v5
    v_lshlrev_b32 v5, 4, v5
    v_lshlrev_b32 v6, v5, v7
    v_cndmask_b32 v106, 0, v6, vcc
    v_subrev_u32 v5, 10, v4
    v_cmp_gt_u32 vcc, 2, v5
    v_lshlrev_b32 v5, 4, v5
    v_lshlrev_b32 v6, v5, v7
    v_cndmask_b32 v107, 0, v6, vcc
    v_subrev_u32 v5, 16, v4
    v_cmp_gt_u32 vcc, 2, v5
    v_lshlrev_b32 v5, 4, v5
    v_lshlrev_b32 v6, v5, v7
    v_cndmask_b32 v108, 0, v6, vcc
    v_subrev_u32 v5, 18, v4
    v_cmp_gt_u32 vcc, 2, v5
    v_lshlrev_b32 v5, 4, v5
    v_lshlrev_b32 v6, v5, v7
    v_cndmask_b32 v109, 0, v6, vcc
    v_subrev_u32 v5, 24, v4
    v_cmp_gt_u32 vcc, 2, v5
    v_lshlrev_b32 v5, 4, v5
    v_lshlrev_b32 v6, v5, v7
    v_cndmask_b32 v110, 0, v6, vcc
    v_subrev_u32 v5, 26, v4
    v_cmp_gt_u32 vcc, 2, v5
    v_lshlrev_b32 v5, 4, v5
    v_lshlrev_b32 v6, v5, v7
    v_cndmask_b32 v111, 0, v6, vcc
    v_and_b32 v20, 15, v0
    v_lshlrev_b32 v20, 4, v20
    v_lshl_add_u32 v20, v21, 9, v20
    v_bfe_u32 v4, v0, 4, 1
    v_lshl_add_u32 v20, v4, 10, v20
    v_and_b32_e64 v4, 31, v0
    v_lshlrev_b32_e64 v4, 3, v4
    v_lshl_add_u32 v6, v21, 12, v4
    v_mov_b32 v146, 0x3f800054
    buffer_load_dwordx2 v[128:129], v6, s[24:27], s89 offen offset:0 sc1
    buffer_load_dwordx2 v[130:131], v6, s[24:27], s89 offen offset:512 sc1
    buffer_load_dwordx2 v[132:133], v6, s[24:27], s89 offen offset:1024 sc1
    buffer_load_dwordx2 v[134:135], v6, s[24:27], s89 offen offset:1536 sc1
    buffer_load_dwordx2 v[136:137], v6, s[24:27], s89 offen offset:2048 sc1
    buffer_load_dwordx2 v[138:139], v6, s[24:27], s89 offen offset:2560 sc1
    buffer_load_dwordx2 v[140:141], v6, s[24:27], s89 offen offset:3072 sc1
    buffer_load_dwordx2 v[142:143], v6, s[24:27], s89 offen offset:3584 sc1
    s_waitcnt vmcnt(0)
    v_max3_u32 v7, v129, v131, v133
    v_max3_u32 v7, v7, v135, v137
    v_max3_u32 v7, v7, v139, v141
    v_max_u32 v7, v7, v143
    v_cmp_eq_u32 vcc, -1, v7
    s_cbranch_vccnz PRT_29
PDONE_28:
    ds_read_b64_tr_b16 v[208:209], v26 offset:6144
    ds_read_b64_tr_b16 v[210:211], v26 offset:7168
    ds_read_b64_tr_b16 v[212:213], v27 offset:6144
    ds_read_b64_tr_b16 v[214:215], v27 offset:7168
    ds_read_b64_tr_b16 v[216:217], v26 offset:8192
    ds_read_b64_tr_b16 v[218:219], v26 offset:9216
    ds_read_b64_tr_b16 v[220:221], v27 offset:8192
    ds_read_b64_tr_b16 v[222:223], v27 offset:9216
    ds_read_b64_tr_b16 v[224:225], v26 offset:10240
    ds_read_b64_tr_b16 v[226:227], v26 offset:11264
    ds_read_b64_tr_b16 v[228:229], v27 offset:10240
    ds_read_b64_tr_b16 v[230:231], v27 offset:11264
    ds_read_b64_tr_b16 v[232:233], v26 offset:0
    ds_read_b64_tr_b16 v[234:235], v26 offset:1024
    ds_read_b64_tr_b16 v[236:237], v27 offset:0
    ds_read_b64_tr_b16 v[238:239], v27 offset:1024
    ds_read_b64_tr_b16 v[240:241], v26 offset:2048
    ds_read_b64_tr_b16 v[242:243], v26 offset:3072
    ds_read_b64_tr_b16 v[244:245], v27 offset:2048
    ds_read_b64_tr_b16 v[246:247], v27 offset:3072
    v_pk_add_f32 v[128:129], v[128:129], v[136:137]
    v_pk_add_f32 v[130:131], v[130:131], v[138:139]
    v_pk_add_f32 v[132:133], v[132:133], v[140:141]
    v_pk_add_f32 v[134:135], v[134:135], v[142:143]
    v_pk_add_f32 v[128:129], v[128:129], v[132:133]
    v_pk_add_f32 v[130:131], v[130:131], v[134:135]
    v_pk_add_f32 v[128:129], v[128:129], v[130:131]
    v_mov_b32_e64 v130, v128
    v_mov_b32 v131, v129
    s_nop 0
    v_permlane32_swap_b32 v128, v130
    v_permlane32_swap_b32 v129, v131
    v_pk_add_f32 v[128:129], v[128:129], v[130:131]
    v_mul_f32 v128, 0xbb000000, v128
    v_mul_f32 v129, 0x3b000000, v129
    v_fma_f32 v129, -v128, v128, v129
    v_max_f32_e64 v129, 0, v129
    v_fmaak_f32 v129, v129, v146, 0x2edbe6ff
    v_rsq_f32 v130, v129
    s_nop 0
    v_mul_f32_e64 v128, v128, v130
    v_pk_fma_f32 v[64:65], v[64:65], v[130:131], v[128:129] op_sel_hi:[1,0,0]
    v_pk_fma_f32 v[66:67], v[66:67], v[130:131], v[128:129] op_sel_hi:[1,0,0]
    v_pk_fma_f32 v[68:69], v[68:69], v[130:131], v[128:129] op_sel_hi:[1,0,0]
    v_pk_fma_f32 v[70:71], v[70:71], v[130:131], v[128:129] op_sel_hi:[1,0,0]
    v_pk_fma_f32 v[72:73], v[72:73], v[130:131], v[128:129] op_sel_hi:[1,0,0]
    v_pk_fma_f32 v[74:75], v[74:75], v[130:131], v[128:129] op_sel_hi:[1,0,0]
    v_pk_fma_f32 v[76:77], v[76:77], v[130:131], v[128:129] op_sel_hi:[1,0,0]
    v_pk_fma_f32 v[78:79], v[78:79], v[130:131], v[128:129] op_sel_hi:[1,0,0]
    v_cvt_pk_bf16_f32 v112, v64, v65
    v_cvt_pk_bf16_f32 v113, v66, v67
    v_cvt_pk_bf16_f32 v114, v68, v69
    v_cvt_pk_bf16_f32 v115, v70, v71
    s_nop 1
    s_nop 0
    v_mfma_f32_32x32x16_bf16 v[32:47], v[112:115], v[104:107], 0
    v_cvt_pk_bf16_f32 v116, v72, v73
    v_cvt_pk_bf16_f32 v117, v74, v75
    v_cvt_pk_bf16_f32 v118, v76, v77
    v_cvt_pk_bf16_f32 v119, v78, v79
    s_nop 1
    v_mfma_f32_32x32x16_bf16 v[32:47], v[116:119], v[108:111], v[32:47]
    s_nop 11
    v_cvt_pk_bf16_f32 v48, v32, v33
    v_cvt_pk_bf16_f32 v49, v34, v35
    v_cvt_pk_bf16_f32 v50, v36, v37
    v_cvt_pk_bf16_f32 v51, v38, v39
    buffer_store_dwordx4 v[48:51], v20, s[24:27], s90 offen offset:0 sc1
    v_cvt_pk_bf16_f32 v52, v40, v41
    v_cvt_pk_bf16_f32 v53, v42, v43
    v_cvt_pk_bf16_f32 v54, v44, v45
    v_cvt_pk_bf16_f32 v55, v46, v47
    buffer_store_dwordx4 v[52:55], v20, s[24:27], s90 offen offset:2048 sc1
    s_cmp_lg_u32 s83, 0
    s_cselect_b32 s62, 1, s61
    s_cmp_eq_u32 s62, 0
    s_cbranch_scc1 NONC_33
NONW_32:
    s_waitcnt lgkmcnt(0)
    s_lshl_b32 s67, s56, 5
    v_xor_b32_e64 v26, s67, v26
    v_xor_b32_e64 v27, s67, v27
    s_lshl_b32 s66, s48, 103
    s_mul_i32 s67, s3, 1835008
    s_add_u32 s66, s66, s67
    v_lshrrev_b32 v4, 3, v0
    v_mul_u32_u24 v24, 4096, v4
    v_bfe_u32 v5, v0, 4, 1
    v_lshlrev_b32_e64 v5, 2, v5
    v_and_b32_e64 v4, 7, v0
    v_xor_b32_e64 v4, v4, v5
    v_lshl_add_u32 v24, v4, 4, v24
    v_add_u32_e64 v24, s66, v24
    v_add_u32 v25, 31744, v24
    s_add_u32 s67, s78, 0
    s_sub_u32 s80, s67, 28
    s_cselect_b32 s80, s67, s80
    s_mul_i32 s80, s80, 65536
    s_add_u32 m0, s75, 0
    s_nop 0
    buffer_load_dwordx4 v24, s[20:23], s80 offen lds
    buffer_load_dwordx4 v25, s[20:23], s80 offen offset:1024 lds
    s_waitcnt vmcnt(0)
    ds_read_b64_tr_b16 a[128:129], v26 offset:0
    ds_read_b64_tr_b16 a[130:131], v26 offset:1024
    ds_read_b64_tr_b16 a[132:133], v27 offset:0
    ds_read_b64_tr_b16 a[134:135], v27 offset:1024
    s_add_u32 m0, s75, 2048
    s_add_u32 s80, s80, 65536
    s_cmp_eq_u32 s80, 1835008
    s_cselect_b32 s80, 0, s80
    buffer_load_dwordx4 v24, s[20:23], s80 offen lds
    buffer_load_dwordx4 v25, s[20:23], s80 offen offset:1024 lds
    s_waitcnt vmcnt(0)
    ds_read_b64_tr_b16 a[136:137], v26 offset:2048
    ds_read_b64_tr_b16 a[138:139], v26 offset:3072
    ds_read_b64_tr_b16 a[140:141], v27 offset:2048
    ds_read_b64_tr_b16 a[142:143], v27 offset:3072
    s_add_u32 m0, s75, 4096
    s_add_u32 s80, s80, 65536
    s_cmp_eq_u32 s80, 1835008
    s_cselect_b32 s80, 0, s80
    buffer_load_dwordx4 v24, s[20:23], s80 offen lds
    buffer_load_dwordx4 v25, s[20:23], s80 offen offset:1024 lds
    s_waitcnt vmcnt(0)
    ds_read_b64_tr_b16 a[144:145], v26 offset:4096
    ds_read_b64_tr_b16 a[146:147], v26 offset:5120
    ds_read_b64_tr_b16 a[148:149], v27 offset:4096
    ds_read_b64_tr_b16 a[150:151], v27 offset:5120
    s_add_u32 m0, s75, 6144
    s_add_u32 s80, s80, 65536
    s_cmp_eq_u32 s80, 1835008
    s_cselect_b32 s80, 0, s80
    buffer_load_dwordx4 v24, s[20:23], s80 offen lds
    buffer_load_dwordx4 v25, s[20:23], s80 offen offset:1024 lds
    s_waitcnt vmcnt(0)
    ds_read_b64_tr_b16 a[152:153], v26 offset:6144
    ds_read_b64_tr_b16 a[154:155], v26 offset:7168
    ds_read_b64_tr_b16 a[156:157], v27 offset:6144
    ds_read_b64_tr_b16 a[158:159], v27 offset:7168
    s_add_u32 m0, s75, 8192
    s_add_u32 s80, s80, 65536
    s_cmp_eq_u32 s80, 1835008
    s_cselect_b32 s80, 0, s80
    buffer_load_dwordx4 v24, s[20:23], s80 offen lds
    buffer_load_dwordx4 v25, s[20:23], s80 offen offset:1024 lds
    s_waitcnt vmcnt(0)
    ds_read_b64_tr_b16 a[160:161], v26 offset:8192
    ds_read_b64_tr_b16 a[162:163], v26 offset:9216
    ds_read_b64_tr_b16 a[164:165], v27 offset:8192
    ds_read_b64_tr_b16 a[166:167], v27 offset:9216
    s_barrier
    v_lshlrev_b32 v144, 16, v152
    v_and_b32 v145, 0xffff0000, v152
    v_lshlrev_b32 v146, 16, v153
    v_and_b32 v147, 0xffff0000, v153
    v_lshlrev_b32 v148, 16, v154
    v_and_b32 v149, 0xffff0000, v154
    v_lshlrev_b32_e64 v150, 16, v155
    v_and_b32 v151, 0xffff0000, v155
    v_add_u32 v2, s91, v1
    v_min_u32 v4, 31, v0
    v_lshrrev_b32 v5, 1, v4
    v_and_b32 v4, 1, v4
    v_lshlrev_b32_e64 v4, 8, v4
    v_lshl_add_u32 v29, v5, 12, v4
    s_lshl_b32 s62, s56, 8
    v_xor_b32 v3, s62, v1
    v_add_u32 v3, s93, v3
    v_min_u32 v30, 27, v0
    v_lshlrev_b32 v30, 11, v30
    s_xor_b32 s62, s3, 1
    s_lshl_b32 s62, s62, 13
    v_add_u32 v4, s62, v1
    s_xor_b32 s62, s3, 2
    s_lshl_b32 s62, s62, 13
    v_add_u32 v5, s62, v1
    s_xor_b32 s62, s3, 3
    s_lshl_b32 s62, s62, 13
    v_add_u32 v6, s62, v1
    s_lshl_b32 s62, s3, 13
    v_add_u32 v20, s62, v1
    v_sub_u32 v153, 32768, v1
    v_mov_b32 v152, 0xc0135761
    s_cmp_eq_u32 s54, 7
    s_cbranch_scc1 P3IDLE_34
    s_mov_b32 s64, s99
    buffer_load_dword v7, v29, s[24:27], s91 offen offset:3836 sc1
    s_lshl_b32 s68, s77, 11
    buffer_load_dwordx4 v[96:99], v2, s[24:27], s68 offen offset:0 sc1
    buffer_load_dwordx4 v[100:103], v2, s[24:27], s68 offen offset:2048 sc1
    s_add_u32 s68, s68, 4096
    s_cmp_eq_u32 s68, 65536
    s_cselect_b32 s68, 0, s68
    buffer_load_dwordx4 v[104:107], v2, s[24:27], s68 offen offset:0 sc1
    buffer_load_dwordx4 v[108:111], v2, s[24:27], s68 offen offset:2048 sc1
    s_add_u32 s68, s68, 4096
    s_cmp_eq_u32 s68, 65536
    s_cselect_b32 s68, 0, s68
    buffer_load_dwordx4 v[112:115], v2, s[24:27], s68 offen offset:0 sc1
    buffer_load_dwordx4 v[116:119], v2, s[24:27], s68 offen offset:2048 sc1
    s_add_u32 s68, s68, 4096
    s_cmp_eq_u32 s68, 65536
    s_cselect_b32 s68, 0, s68
    buffer_load_dwordx4 v[120:123], v2, s[24:27], s68 offen offset:0 sc1
    buffer_load_dwordx4 v[124:127], v2, s[24:27], s68 offen offset:2048 sc1
    s_add_u32 s68, s68, 4096
    s_cmp_eq_u32 s68, 65536
    s_cselect_b32 s68, 0, s68
    buffer_load_dwordx4 v[128:131], v2, s[24:27], s68 offen offset:0 sc1
    s_waitcnt vmcnt(9)
    v_cmp_eq_u32_e64 vcc, -1, v7
    s_cbranch_vccnz FB_38
FBB_39:
GO_37:
    v_mov_b32 v28, 0
    s_waitcnt vmcnt(8)
    v_mfma_f32_32x32x16_bf16 v[48:63], a[4:7], v[96:99], 0
    buffer_load_dwordx4 v[132:135], v2, s[24:27], s68 offen offset:2048 sc1
    v_mfma_f32_32x32x16_bf16 v[32:47], a[0:3], v[96:99], 0
    s_waitcnt vmcnt(8)
    v_mfma_f32_32x32x16_bf16 v[48:63], a[12:15], v[100:103], v[48:63]
    s_add_u32 s68, s68, 4096
    s_cmp_eq_u32 s68, 65536
    s_cselect_b32 s68, 0, s68
    buffer_load_dwordx4 v[136:139], v2, s[24:27], s68 offen offset:0 sc1
    v_max3_u32 v28, v28, v96, v100
    v_mfma_f32_32x32x16_bf16 v[32:47], a[8:11], v[100:103], v[32:47]
    s_waitcnt vmcnt(8)
    v_mfma_f32_32x32x16_bf16 v[48:63], a[20:23], v[104:107], v[48:63]
    buffer_load_dwordx4 v[140:143], v2, s[24:27], s68 offen offset:2048 sc1
    v_mfma_f32_32x32x16_bf16 v[32:47], a[16:19], v[104:107], v[32:47]
    s_waitcnt vmcnt(8)
    v_mfma_f32_32x32x16_bf16 v[48:63], a[28:31], v[108:111], v[48:63]
    s_add_u32 s68, s68, 4096
    s_cmp_eq_u32 s68, 65536
    s_cselect_b32 s68, 0, s68
    buffer_load_dwordx4 v[96:99], v2, s[24:27], s68 offen offset:0 sc1
    v_max3_u32 v28, v28, v104, v108
    v_mfma_f32_32x32x16_bf16 v[32:47], a[24:27], v[108:111], v[32:47]
    s_waitcnt vmcnt(8)
    v_mfma_f32_32x32x16_bf16 v[48:63], a[36:39], v[112:115], v[48:63]
    buffer_load_dwordx4 v[100:103], v2, s[24:27], s68 offen offset:2048 sc1
    v_mfma_f32_32x32x16_bf16 v[32:47], a[32:35], v[112:115], v[32:47]
    s_waitcnt vmcnt(8)
    v_mfma_f32_32x32x16_bf16 v[48:63], a[44:47], v[116:119], v[48:63]
    s_add_u32 s68, s68, 4096
    s_cmp_eq_u32 s68, 65536
    s_cselect_b32 s68, 0, s68
    buffer_load_dwordx4 v[104:107], v2, s[24:27], s68 offen offset:0 sc1
    v_max3_u32 v28, v28, v112, v116
    v_mfma_f32_32x32x16_bf16 v[32:47], a[40:43], v[116:119], v[32:47]
    s_waitcnt vmcnt(8)
    v_mfma_f32_32x32x16_bf16 v[48:63], a[52:55], v[120:123], v[48:63]
    buffer_load_dwordx4 v[108:111], v2, s[24:27], s68 offen offset:2048 sc1
    v_mfma_f32_32x32x16_bf16 v[32:47], a[48:51], v[120:123], v[32:47]
    s_waitcnt vmcnt(8)
    v_mfma_f32_32x32x16_bf16 v[48:63], a[60:63], v[124:127], v[48:63]
    s_add_u32 s68, s68, 4096
    s_cmp_eq_u32 s68, 65536
    s_cselect_b32 s68, 0, s68
    buffer_load_dwordx4 v[112:115], v2, s[24:27], s68 offen offset:0 sc1
    v_max3_u32 v28, v28, v120, v124
    v_mfma_f32_32x32x16_bf16 v[32:47], a[56:59], v[124:127], v[32:47]
    s_waitcnt vmcnt(8)
    v_mfma_f32_32x32x16_bf16 v[48:63], a[68:71], v[128:131], v[48:63]
    buffer_load_dwordx4 v[116:119], v2, s[24:27], s68 offen offset:2048 sc1
    v_mfma_f32_32x32x16_bf16 v[32:47], a[64:67], v[128:131], v[32:47]
    s_waitcnt vmcnt(8)
    v_mfma_f32_32x32x16_bf16 v[48:63], a[76:79], v[132:135], v[48:63]
    s_add_u32 s68, s68, 4096
    s_cmp_eq_u32 s68, 65536
    s_cselect_b32 s68, 0, s68
    buffer_load_dwordx4 v[120:123], v2, s[24:27], s68 offen offset:0 sc1
    v_max3_u32 v28, v28, v128, v132
    v_mfma_f32_32x32x16_bf16 v[32:47], a[72:75], v[132:135], v[32:47]
    s_waitcnt vmcnt(8)
    v_mfma_f32_32x32x16_bf16 v[48:63], a[84:87], v[136:139], v[48:63]
    buffer_load_dwordx4 v[124:127], v2, s[24:27], s68 offen offset:2048 sc1
    v_mfma_f32_32x32x16_bf16 v[32:47], a[80:83], v[136:139], v[32:47]
    s_waitcnt vmcnt(8)
    v_mfma_f32_32x32x16_bf16 v[48:63], a[92:95], v[140:143], v[48:63]
    s_add_u32 s68, s68, 4096
    s_cmp_eq_u32 s68, 65536
    s_cselect_b32 s68, 0, s68
    buffer_load_dwordx4 v[128:131], v2, s[24:27], s68 offen offset:0 sc1
    v_max3_u32 v28, v28, v136, v140
    v_mfma_f32_32x32x16_bf16 v[32:47], a[88:91], v[140:143], v[32:47]
    s_waitcnt vmcnt(8)
    v_mfma_f32_32x32x16_bf16 v[48:63], a[100:103], v[96:99], v[48:63]
    buffer_load_dwordx4 v[132:135], v2, s[24:27], s68 offen offset:2048 sc1
    v_mfma_f32_32x32x16_bf16 v[32:47], a[96:99], v[96:99], v[32:47]
    s_waitcnt vmcnt(8)
    v_mfma_f32_32x32x16_bf16 v[48:63], a[108:111], v[100:103], v[48:63]
    s_add_u32 s68, s68, 4096
    s_cmp_eq_u32 s68, 65536
    s_cselect_b32 s68, 0, s68
    buffer_load_dwordx4 v[136:139], v2, s[24:27], s68 offen offset:0 sc1
    v_max3_u32 v28, v28, v96, v100
    v_mfma_f32_32x32x16_bf16 v[32:47], a[104:107], v[100:103], v[32:47]
    s_waitcnt vmcnt(8)
    v_mfma_f32_32x32x16_bf16 v[48:63], a[116:119], v[104:107], v[48:63]
    buffer_load_dwordx4 v[140:143], v2, s[24:27], s68 offen offset:2048 sc1
    v_mfma_f32_32x32x16_bf16 v[32:47], a[112:115], v[104:107], v[32:47]
    s_waitcnt vmcnt(8)
    v_mfma_f32_32x32x16_bf16 v[48:63], a[124:127], v[108:111], v[48:63]
    s_add_u32 s68, s68, 4096
    s_cmp_eq_u32 s68, 65536
    s_cselect_b32 s68, 0, s68
    buffer_load_dwordx4 v[96:99], v2, s[24:27], s68 offen offset:0 sc1
    v_max3_u32 v28, v28, v104, v108
    v_mfma_f32_32x32x16_bf16 v[32:47], a[120:123], v[108:111], v[32:47]
    s_waitcnt vmcnt(8)
    v_mfma_f32_32x32x16_bf16 v[48:63], a[220:223], v[112:115], v[48:63]
    buffer_load_dwordx4 v[100:103], v2, s[24:27], s68 offen offset:2048 sc1
    v_mfma_f32_32x32x16_bf16 v[32:47], a[216:219], v[112:115], v[32:47]
    s_waitcnt vmcnt(8)
    v_mfma_f32_32x32x16_bf16 v[48:63], a[228:231], v[116:119], v[48:63]
    s_add_u32 s68, s68, 4096
    s_cmp_eq_u32 s68, 65536
    s_cselect_b32 s68, 0, s68
    buffer_load_dwordx4 v[104:107], v2, s[24:27], s68 offen offset:0 sc1
    v_max3_u32 v28, v28, v112, v116
    v_mfma_f32_32x32x16_bf16 v[32:47], a[224:227], v[116:119], v[32:47]
    s_waitcnt vmcnt(8)
    v_mfma_f32_32x32x16_bf16 v[48:63], a[236:239], v[120:123], v[48:63]
    buffer_load_dwordx4 v[108:111], v2, s[24:27], s68 offen offset:2048 sc1
    v_mfma_f32_32x32x16_bf16 v[32:47], a[232:235], v[120:123], v[32:47]
    s_waitcnt vmcnt(8)
    v_mfma_f32_32x32x16_bf16 v[48:63], a[244:247], v[124:127], v[48:63]
    s_add_u32 s68, s68, 4096
    s_cmp_eq_u32 s68, 65536
    s_cselect_b32 s68, 0, s68
    buffer_load_dwordx4 v[112:115], v2, s[24:27], s68 offen offset:0 sc1
    v_max3_u32 v28, v28, v120, v124
    v_mfma_f32_32x32x16_bf16 v[32:47], a[240:243], v[124:127], v[32:47]
    s_waitcnt vmcnt(8)
    v_mfma_f32_32x32x16_bf16 v[48:63], a[252:255], v[128:131], v[48:63]
    buffer_load_dwordx4 v[116:119], v2, s[24:27], s68 offen offset:2048 sc1
    v_mfma_f32_32x32x16_bf16 v[32:47], a[248:251], v[128:131], v[32:47]
    s_waitcnt vmcnt(8)
    v_mfma_f32_32x32x16_bf16 v[48:63], v[164:167], v[132:135], v[48:63]
    s_add_u32 s68, s68, 4096
    s_cmp_eq_u32 s68, 65536
    s_cselect_b32 s68, 0, s68
    buffer_load_dwordx4 v[120:123], v2, s[24:27], s68 offen offset:0 sc1
    v_max3_u32 v28, v28, v128, v132
    v_mfma_f32_32x32x16_bf16 v[32:47], v[160:163], v[132:135], v[32:47]
    s_waitcnt vmcnt(8)
    v_mfma_f32_32x32x16_bf16 v[48:63], v[172:175], v[136:139], v[48:63]
    buffer_load_dwordx4 v[124:127], v2, s[24:27], s68 offen offset:2048 sc1
    v_mfma_f32_32x32x16_bf16 v[32:47], v[168:171], v[136:139], v[32:47]
    s_waitcnt vmcnt(8)
    v_mfma_f32_32x32x16_bf16 v[48:63], v[180:183], v[140:143], v[48:63]
    s_lshl_b32 s68, s77, 107
    buffer_load_dwordx4 v[128:131], v2, s[24:27], s68 offen offset:1024 sc1
    v_max3_u32 v28, v28, v136, v140
    v_mfma_f32_32x32x16_bf16 v[32:47], v[176:179], v[140:143], v[32:47]
    s_waitcnt vmcnt(8)
    v_mfma_f32_32x32x16_bf16 v[48:63], v[188:191], v[96:99], v[48:63]
    buffer_load_dwordx4 v[132:135], v2, s[24:27], s68 offen offset:3072 sc1
    v_mfma_f32_32x32x16_bf16 v[32:47], v[184:187], v[96:99], v[32:47]
    s_waitcnt vmcnt(8)
    v_mfma_f32_32x32x16_bf16 v[48:63], v[196:199], v[100:103], v[48:63]
    s_add_u32 s68, s68, 4096
    s_cmp_eq_u32 s68, 65536
    s_cselect_b32 s68, 0, s68
    buffer_load_dwordx4 v[136:139], v2, s[24:27], s68 offen offset:1024 sc1
    v_max3_u32 v28, v28, v96, v100
    v_mfma_f32_32x32x16_bf16 v[32:47], v[192:195], v[100:103], v[32:47]
    s_waitcnt vmcnt(8)
    v_mfma_f32_32x32x16_bf16 v[48:63], v[204:207], v[104:107], v[48:63]
    buffer_load_dwordx4 v[140:143], v2, s[24:27], s68 offen offset:3072 sc1
    v_mfma_f32_32x32x16_bf16 v[32:47], v[200:203], v[104:107], v[32:47]
    s_waitcnt vmcnt(8)
    v_mfma_f32_32x32x16_bf16 v[48:63], v[212:215], v[108:111], v[48:63]
    s_add_u32 s68, s68, 4096
    s_cmp_eq_u32 s68, 65536
    s_cselect_b32 s68, 0, s68
    buffer_load_dwordx4 v[96:99], v2, s[24:27], s68 offen offset:1024 sc1
    v_max3_u32 v28, v28, v104, v108
    v_mfma_f32_32x32x16_bf16 v[32:47], v[208:211], v[108:111], v[32:47]
    s_waitcnt vmcnt(8)
    v_mfma_f32_32x32x16_bf16 v[48:63], v[220:223], v[112:115], v[48:63]
    buffer_load_dwordx4 v[100:103], v2, s[24:27], s68 offen offset:3072 sc1
    v_mfma_f32_32x32x16_bf16 v[32:47], v[216:219], v[112:115], v[32:47]
    s_waitcnt vmcnt(8)
    v_mfma_f32_32x32x16_bf16 v[48:63], v[228:231], v[116:119], v[48:63]
    s_add_u32 s68, s68, 4096
    s_cmp_eq_u32 s68, 65536
    s_cselect_b32 s68, 0, s68
    buffer_load_dwordx4 v[104:107], v2, s[24:27], s68 offen offset:1024 sc1
    v_max3_u32 v28, v28, v112, v116
    v_mfma_f32_32x32x16_bf16 v[32:47], v[224:227], v[116:119], v[32:47]
    s_waitcnt vmcnt(8)
    v_mfma_f32_32x32x16_bf16 v[48:63], v[236:239], v[120:123], v[48:63]
    buffer_load_dwordx4 v[108:111], v2, s[24:27], s68 offen offset:3072 sc1
    v_mfma_f32_32x32x16_bf16 v[32:47], v[232:235], v[120:123], v[32:47]
    s_waitcnt vmcnt(8)
    v_mfma_f32_32x32x16_bf16 v[48:63], v[244:247], v[124:127], v[48:63]
    s_add_u32 s68, s68, 4096
    s_cmp_eq_u32 s68, 65536
    s_cselect_b32 s68, 0, s68
    buffer_load_dwordx4 v[112:115], v2, s[24:27], s68 offen offset:1024 sc1
    v_max3_u32 v28, v28, v120, v124
    v_mfma_f32_32x32x16_bf16 v[32:47], v[240:243], v[124:127], v[32:47]
    v_cmp_eq_u32_e64 vcc, -1, v28
    s_cbranch_vccnz VBAD_47
VOK_46:
BACK_45:
    s_nop 3
    ds_write_b128 v5, v[48:51] offset:2048
    ds_write_b128 v5, v[52:55] offset:3072
    ds_write_b128 v6, v[56:59] offset:4096
    ds_write_b128 v6, v[60:63] offset:5120
    s_nop 1
    ds_write_b128 v4, v[40:43] offset:0
    ds_write_b128 v4, v[44:47] offset:1024
    s_add_u32 m0, s75, 10240
    s_add_u32 s80, s80, 65536
    s_cmp_eq_u32 s80, 1835008
    s_cselect_b32 s80, 0, s80
    buffer_load_dwordx4 v24, s[20:23], s80 offen lds
    buffer_load_dwordx4 v25, s[20:23], s80 offen offset:1024 lds
    s_waitcnt lgkmcnt(15)
    s_add_u32 m0, s75, 0
    s_add_u32 s80, s80, 65536
    s_cmp_eq_u32 s80, 1835008
    s_cselect_b32 s80, 0, s80
    buffer_load_dwordx4 v24, s[20:23], s80 offen lds
    buffer_load_dwordx4 v25, s[20:23], s80 offen offset:1024 lds
    s_add_u32 m0, s75, 2048
    s_add_u32 s80, s80, 65536
    s_cmp_eq_u32 s80, 1835008
    s_cselect_b32 s80, 0, s80
    buffer_load_dwordx4 v24, s[20:23], s80 offen lds
    buffer_load_dwordx4 v25, s[20:23], s80 offen offset:1024 lds
    s_waitcnt lgkmcnt(14)
    s_add_u32 m0, s75, 4096
    s_add_u32 s80, s80, 65536
    s_cmp_eq_u32 s80, 1835008
    s_cselect_b32 s80, 0, s80
    buffer_load_dwordx4 v24, s[20:23], s80 offen lds
    buffer_load_dwordx4 v25, s[20:23], s80 offen offset:1024 lds
    s_waitcnt lgkmcnt(10)
    s_add_u32 m0, s75, 6144
    s_add_u32 s80, s80, 65536
    s_cmp_eq_u32 s80, 1835008
    s_cselect_b32 s80, 0, s80
    buffer_load_dwordx4 v24, s[20:23], s80 offen lds
    buffer_load_dwordx4 v25, s[20:23], s80 offen offset:1024 lds
    s_waitcnt lgkmcnt(6)
    s_add_u32 m0, s75, 8192
    s_add_u32 s80, s80, 65536
    s_cmp_eq_u32 s80, 1835008
    s_cselect_b32 s80, 0, s80
    buffer_load_dwordx4 v24, s[20:23], s80 offen lds
    buffer_load_dwordx4 v25, s[20:23], s80 offen offset:1024 lds
    v_pk_add_f32 v[32:33], v[32:33], v[144:145]
    v_pk_add_f32 v[34:35], v[34:35], v[146:147]
    v_pk_add_f32 v[36:37], v[36:37], v[148:149]
    v_pk_add_f32 v[38:39], v[38:39], v[150:151]
    s_waitcnt lgkmcnt(0)
    s_barrier
    ds_read_b128 v[64:67], v20 offset:0
    ds_read_b128 v[72:75], v20 offset:2048
    ds_read_b128 v[80:83], v20 offset:4096
    ds_read_b128 v[68:71], v20 offset:1024
    ds_read_b128 v[76:79], v20 offset:3072
    ds_read_b128 v[84:87], v20 offset:5120
    s_waitcnt lgkmcnt(4)
    v_pk_add_f32 v[64:65], v[64:65], v[72:73]
    v_pk_add_f32 v[66:67], v[66:67], v[74:75]
    s_waitcnt lgkmcnt(3)
    v_pk_add_f32 v[32:33], v[32:33], v[80:81]
    v_pk_add_f32 v[34:35], v[34:35], v[82:83]
    v_pk_add_f32 v[32:33], v[32:33], v[64:65]
    v_pk_add_f32 v[34:35], v[34:35], v[66:67]
    s_waitcnt lgkmcnt(1)
    v_pk_add_f32 v[68:69], v[68:69], v[76:77]
    v_pk_add_f32 v[70:71], v[70:71], v[78:79]
    s_waitcnt lgkmcnt(0)
    v_pk_add_f32 v[36:37], v[36:37], v[84:85]
    v_pk_add_f32 v[38:39], v[38:39], v[86:87]
    v_pk_add_f32 v[36:37], v[36:37], v[68:69]
    v_pk_add_f32 v[38:39], v[38:39], v[70:71]
    v_pk_mul_f32 v[48:49], v[32:33], v[32:33]
    v_pk_mul_f32 v[50:51], v[34:35], v[34:35]
    v_pk_mul_f32 v[52:53], v[36:37], v[36:37]
    v_pk_mul_f32 v[54:55], v[38:39], v[38:39]
    v_pk_fma_f32 v[48:49], v[48:49], s[64:65], v[152:153] op_sel_hi:[1,0,0]
    v_pk_fma_f32 v[50:51], v[50:51], s[64:65], v[152:153] op_sel_hi:[1,0,0]
    v_pk_fma_f32 v[52:53], v[52:53], s[64:65], v[152:153] op_sel_hi:[1,0,0]
    v_pk_fma_f32 v[54:55], v[54:55], s[64:65], v[152:153] op_sel_hi:[1,0,0]
    v_pk_mul_f32 v[48:49], v[48:49], v[32:33]
    v_pk_mul_f32 v[50:51], v[50:51], v[34:35]
    v_pk_mul_f32 v[52:53], v[52:53], v[36:37]
    v_pk_mul_f32 v[54:55], v[54:55], v[38:39]
    v_exp_f32 v48, v48
    v_exp_f32 v49, v49
    v_exp_f32 v50, v50
    v_exp_f32 v51, v51
    v_exp_f32 v52, v52
    v_exp_f32 v53, v53
    v_exp_f32 v54, v54
    v_exp_f32 v55, v55
    v_pk_add_f32 v[48:49], v[48:49], 1.0 op_sel_hi:[1,0]
    v_pk_add_f32 v[50:51], v[50:51], 1.0 op_sel_hi:[1,0]
    v_pk_add_f32 v[52:53], v[52:53], 1.0 op_sel_hi:[1,0]
    v_pk_add_f32 v[54:55], v[54:55], 1.0 op_sel_hi:[1,0]
    v_rcp_f32 v48, v48
    v_rcp_f32 v49, v49
    v_rcp_f32 v50, v50
    v_rcp_f32 v51, v51
    v_rcp_f32 v52, v52
    v_rcp_f32 v53, v53
    v_rcp_f32 v54, v54
    v_rcp_f32 v55, v55
    v_pk_mul_f32 v[32:33], v[32:33], v[48:49]
    v_pk_mul_f32 v[34:35], v[34:35], v[50:51]
    v_pk_mul_f32 v[36:37], v[36:37], v[52:53]
    v_pk_mul_f32 v[38:39], v[38:39], v[54:55]
    v_cvt_pk_bf16_f32 v56, v32, v33
    v_cvt_pk_bf16_f32 v57, v34, v35
    v_cvt_pk_bf16_f32 v58, v36, v37
    v_cvt_pk_bf16_f32 v59, v38, v39
    buffer_store_dwordx4 v[56:59], v1, s[24:27], s92 offen offset:0 sc1
    v_mov_b32 v28, 0
    s_waitcnt vmcnt(21)
    v_mfma_f32_32x32x16_bf16 v[80:95], a[4:7], v[128:131], 0
    buffer_load_dwordx4 v[116:119], v2, s[24:27], s68 offen offset:3072 sc1
    v_mfma_f32_32x32x16_bf16 v[64:79], a[0:3], v[128:131], 0
    s_waitcnt vmcnt(21)
    v_mfma_f32_32x32x16_bf16 v[80:95], a[12:15], v[132:135], v[80:95]
    s_add_u32 s68, s68, 4096
    s_cmp_eq_u32 s68, 65536
    s_cselect_b32 s68, 0, s68
    buffer_load_dwordx4 v[120:123], v2, s[24:27], s68 offen offset:1024 sc1
    v_max3_u32 v28, v28, v128, v132
    v_mfma_f32_32x32x16_bf16 v[64:79], a[8:11], v[132:135], v[64:79]
    s_waitcnt vmcnt(21)
    v_mfma_f32_32x32x16_bf16 v[80:95], a[20:23], v[136:139], v[80:95]
    buffer_load_dwordx4 v[124:127], v2, s[24:27], s68 offen offset:3072 sc1
    v_mfma_f32_32x32x16_bf16 v[64:79], a[16:19], v[136:139], v[64:79]
    s_waitcnt vmcnt(21)
    v_mfma_f32_32x32x16_bf16 v[80:95], a[28:31], v[140:143], v[80:95]
    s_add_u32 s68, s68, 4096
    s_cmp_eq_u32 s68, 65536
    s_cselect_b32 s68, 0, s68
    buffer_load_dwordx4 v[128:131], v2, s[24:27], s68 offen offset:1024 sc1
    v_max3_u32 v28, v28, v136, v140
    v_mfma_f32_32x32x16_bf16 v[64:79], a[24:27], v[140:143], v[64:79]
    s_waitcnt vmcnt(21)
    v_mfma_f32_32x32x16_bf16 v[80:95], a[36:39], v[96:99], v[80:95]
    buffer_load_dwordx4 v[132:135], v2, s[24:27], s68 offen offset:3072 sc1
    v_mfma_f32_32x32x16_bf16 v[64:79], a[32:35], v[96:99], v[64:79]
    s_waitcnt vmcnt(21)
    v_mfma_f32_32x32x16_bf16 v[80:95], a[44:47], v[100:103], v[80:95]
    s_add_u32 s68, s68, 4096
    s_cmp_eq_u32 s68, 65536
    s_cselect_b32 s68, 0, s68
    buffer_load_dwordx4 v[136:139], v2, s[24:27], s68 offen offset:1024 sc1
    v_max3_u32 v28, v28, v96, v100
    v_mfma_f32_32x32x16_bf16 v[64:79], a[40:43], v[100:103], v[64:79]
    s_waitcnt vmcnt(21)
    v_mfma_f32_32x32x16_bf16 v[80:95], a[52:55], v[104:107], v[80:95]
    buffer_load_dwordx4 v[140:143], v2, s[24:27], s68 offen offset:3072 sc1
    v_mfma_f32_32x32x16_bf16 v[64:79], a[48:51], v[104:107], v[64:79]
    s_waitcnt vmcnt(21)
    v_mfma_f32_32x32x16_bf16 v[80:95], a[60:63], v[108:111], v[80:95]
    s_add_u32 s68, s68, 4096
    s_cmp_eq_u32 s68, 65536
    s_cselect_b32 s68, 0, s68
    buffer_load_dwordx4 v[96:99], v2, s[24:27], s68 offen offset:1024 sc1
    v_max3_u32 v28, v28, v104, v108
    v_mfma_f32_32x32x16_bf16 v[64:79], a[56:59], v[108:111], v[64:79]
    s_waitcnt vmcnt(21)
    v_mfma_f32_32x32x16_bf16 v[80:95], a[68:71], v[112:115], v[80:95]
    buffer_load_dwordx4 v[100:103], v2, s[24:27], s68 offen offset:3072 sc1
    v_mfma_f32_32x32x16_bf16 v[64:79], a[64:67], v[112:115], v[64:79]
    s_waitcnt vmcnt(8)
    v_mfma_f32_32x32x16_bf16 v[80:95], a[76:79], v[116:119], v[80:95]
    s_add_u32 s68, s68, 4096
    s_cmp_eq_u32 s68, 65536
    s_cselect_b32 s68, 0, s68
    buffer_load_dwordx4 v[104:107], v2, s[24:27], s68 offen offset:1024 sc1
    v_max3_u32 v28, v28, v112, v116
    v_mfma_f32_32x32x16_bf16 v[64:79], a[72:75], v[116:119], v[64:79]
    s_waitcnt vmcnt(8)
    v_mfma_f32_32x32x16_bf16 v[80:95], a[84:87], v[120:123], v[80:95]
    buffer_load_dwordx4 v[108:111], v2, s[24:27], s68 offen offset:3072 sc1
    v_mfma_f32_32x32x16_bf16 v[64:79], a[80:83], v[120:123], v[64:79]
    s_waitcnt vmcnt(8)
    v_mfma_f32_32x32x16_bf16 v[80:95], a[92:95], v[124:127], v[80:95]
    s_add_u32 s68, s68, 4096
    s_cmp_eq_u32 s68, 65536
    s_cselect_b32 s68, 0, s68
    buffer_load_dwordx4 v[112:115], v2, s[24:27], s68 offen offset:1024 sc1
    v_max3_u32 v28, v28, v120, v124
    v_mfma_f32_32x32x16_bf16 v[64:79], a[88:91], v[124:127], v[64:79]
    s_waitcnt vmcnt(8)
    v_mfma_f32_32x32x16_bf16 v[80:95], a[100:103], v[128:131], v[80:95]
    buffer_load_dwordx4 v[116:119], v2, s[24:27], s68 offen offset:3072 sc1
    v_mfma_f32_32x32x16_bf16 v[64:79], a[96:99], v[128:131], v[64:79]
    s_waitcnt vmcnt(8)
    v_mfma_f32_32x32x16_bf16 v[80:95], a[108:111], v[132:135], v[80:95]
    s_add_u32 s68, s68, 4096
    s_cmp_eq_u32 s68, 65536
    s_cselect_b32 s68, 0, s68
    buffer_load_dwordx4 v[120:123], v2, s[24:27], s68 offen offset:1024 sc1
    v_max3_u32 v28, v28, v128, v132
    v_mfma_f32_32x32x16_bf16 v[64:79], a[104:107], v[132:135], v[64:79]
    s_waitcnt vmcnt(8)
    v_mfma_f32_32x32x16_bf16 v[80:95], a[116:119], v[136:139], v[80:95]
    buffer_load_dwordx4 v[124:127], v2, s[24:27], s68 offen offset:3072 sc1
    v_mfma_f32_32x32x16_bf16 v[64:79], a[112:115], v[136:139], v[64:79]
    s_waitcnt vmcnt(8)
    v_mfma_f32_32x32x16_bf16 v[80:95], a[124:127], v[140:143], v[80:95]
    s_add_u32 s68, s68, 4096
    s_cmp_eq_u32 s68, 65536
    s_cselect_b32 s68, 0, s68
    buffer_load_dwordx4 v[128:131], v2, s[24:27], s68 offen offset:1024 sc1
    v_max3_u32 v28, v28, v136, v140
    v_mfma_f32_32x32x16_bf16 v[64:79], a[120:123], v[140:143], v[64:79]
    s_waitcnt vmcnt(8)
    v_mfma_f32_32x32x16_bf16 v[80:95], a[220:223], v[96:99], v[80:95]
    buffer_load_dwordx4 v[132:135], v2, s[24:27], s68 offen offset:3072 sc1
    v_mfma_f32_32x32x16_bf16 v[64:79], a[216:219], v[96:99], v[64:79]
    s_waitcnt vmcnt(8)
    v_mfma_f32_32x32x16_bf16 v[80:95], a[228:231], v[100:103], v[80:95]
    s_add_u32 s68, s68, 4096
    s_cmp_eq_u32 s68, 65536
    s_cselect_b32 s68, 0, s68
    buffer_load_dwordx4 v[136:139], v2, s[24:27], s68 offen offset:1024 sc1
    v_max3_u32 v28, v28, v96, v100
    v_mfma_f32_32x32x16_bf16 v[64:79], a[224:227], v[100:103], v[64:79]
    s_waitcnt vmcnt(8)
    v_mfma_f32_32x32x16_bf16 v[80:95], a[236:239], v[104:107], v[80:95]
    buffer_load_dwordx4 v[140:143], v2, s[24:27], s68 offen offset:3072 sc1
    v_mfma_f32_32x32x16_bf16 v[64:79], a[232:235], v[104:107], v[64:79]
    s_waitcnt vmcnt(8)
    v_mfma_f32_32x32x16_bf16 v[80:95], a[244:247], v[108:111], v[80:95]
    s_add_u32 s68, s68, 4096
    s_cmp_eq_u32 s68, 65536
    s_cselect_b32 s68, 0, s68
    buffer_load_dwordx4 v[96:99], v2, s[24:27], s68 offen offset:1024 sc1
    v_max3_u32 v28, v28, v104, v108
    v_mfma_f32_32x32x16_bf16 v[64:79], a[240:243], v[108:111], v[64:79]
    s_waitcnt vmcnt(8)
    v_mfma_f32_32x32x16_bf16 v[80:95], a[252:255], v[112:115], v[80:95]
    buffer_load_dwordx4 v[100:103], v2, s[24:27], s68 offen offset:3072 sc1
    v_mfma_f32_32x32x16_bf16 v[64:79], a[248:251], v[112:115], v[64:79]
    s_waitcnt vmcnt(8)
    v_mfma_f32_32x32x16_bf16 v[80:95], v[164:167], v[116:119], v[80:95]
    s_add_u32 s68, s68, 4096
    s_cmp_eq_u32 s68, 65536
    s_cselect_b32 s68, 0, s68
    buffer_load_dwordx4 v[104:107], v2, s[24:27], s68 offen offset:1024 sc1
    v_max3_u32 v28, v28, v112, v116
    v_mfma_f32_32x32x16_bf16 v[64:79], v[160:163], v[116:119], v[64:79]
    s_waitcnt vmcnt(8)
    v_mfma_f32_32x32x16_bf16 v[80:95], v[172:175], v[120:123], v[80:95]
    buffer_load_dwordx4 v[108:111], v2, s[24:27], s68 offen offset:3072 sc1
    v_mfma_f32_32x32x16_bf16 v[64:79], v[168:171], v[120:123], v[64:79]
    s_waitcnt vmcnt(8)
    v_mfma_f32_32x32x16_bf16 v[80:95], v[180:183], v[124:127], v[80:95]
    buffer_load_dword v7, v30, s[24:27], s93 offen offset:1020 sc1
    s_lshl_b32 s68, s78, 107
    buffer_load_dwordx4 v[112:115], v3, s[24:27], s68 offen offset:0 sc1
    v_max3_u32 v28, v28, v120, v124
    v_mfma_f32_32x32x16_bf16 v[64:79], v[176:179], v[124:127], v[64:79]
    s_waitcnt vmcnt(9)
    v_mfma_f32_32x32x16_bf16 v[80:95], v[188:191], v[128:131], v[80:95]
    buffer_load_dwordx4 v[116:119], v3, s[24:27], s68 offen offset:2048 sc1
    v_mfma_f32_32x32x16_bf16 v[64:79], v[184:187], v[128:131], v[64:79]
    s_waitcnt vmcnt(9)
    v_mfma_f32_32x32x16_bf16 v[80:95], v[196:199], v[132:135], v[80:95]
    s_add_u32 s68, s68, 4096
    s_cmp_eq_u32 s68, 57344
    s_cselect_b32 s68, 0, s68
    buffer_load_dwordx4 v[120:123], v3, s[24:27], s68 offen offset:0 sc1
    v_max3_u32 v28, v28, v128, v132
    v_mfma_f32_32x32x16_bf16 v[64:79], v[192:195], v[132:135], v[64:79]
    s_waitcnt vmcnt(9)
    v_mfma_f32_32x32x16_bf16 v[80:95], v[204:207], v[136:139], v[80:95]
    buffer_load_dwordx4 v[124:127], v3, s[24:27], s68 offen offset:2048 sc1
    v_mfma_f32_32x32x16_bf16 v[64:79], v[200:203], v[136:139], v[64:79]
    s_waitcnt vmcnt(9)
    v_mfma_f32_32x32x16_bf16 v[80:95], v[212:215], v[140:143], v[80:95]
    s_add_u32 s68, s68, 4096
    s_cmp_eq_u32 s68, 57344
    s_cselect_b32 s68, 0, s68
    buffer_load_dwordx4 v[128:131], v3, s[24:27], s68 offen offset:0 sc1
    v_max3_u32 v28, v28, v136, v140
    v_mfma_f32_32x32x16_bf16 v[64:79], v[208:211], v[140:143], v[64:79]
    s_waitcnt vmcnt(9)
    v_mfma_f32_32x32x16_bf16 v[80:95], v[220:223], v[96:99], v[80:95]
    buffer_load_dwordx4 v[132:135], v3, s[24:27], s68 offen offset:2048 sc1
    v_mfma_f32_32x32x16_bf16 v[64:79], v[216:219], v[96:99], v[64:79]
    s_waitcnt vmcnt(9)
    v_mfma_f32_32x32x16_bf16 v[80:95], v[228:231], v[100:103], v[80:95]
    s_add_u32 s68, s68, 4096
    s_cmp_eq_u32 s68, 57344
    s_cselect_b32 s68, 0, s68
    buffer_load_dwordx4 v[136:139], v3, s[24:27], s68 offen offset:0 sc1
    v_max3_u32 v28, v28, v96, v100
    v_mfma_f32_32x32x16_bf16 v[64:79], v[224:227], v[100:103], v[64:79]
    s_waitcnt vmcnt(9)
    v_mfma_f32_32x32x16_bf16 v[80:95], v[236:239], v[104:107], v[80:95]
    buffer_load_dwordx4 v[140:143], v3, s[24:27], s68 offen offset:2048 sc1
    v_mfma_f32_32x32x16_bf16 v[64:79], v[232:235], v[104:107], v[64:79]
    s_waitcnt vmcnt(9)
    v_mfma_f32_32x32x16_bf16 v[80:95], v[244:247], v[108:111], v[80:95]
    s_add_u32 s68, s68, 4096
    s_cmp_eq_u32 s68, 57344
    s_cselect_b32 s68, 0, s68
    buffer_load_dwordx4 v[96:99], v3, s[24:27], s68 offen offset:0 sc1
    v_max3_u32 v28, v28, v104, v108
    v_mfma_f32_32x32x16_bf16 v[64:79], v[240:243], v[108:111], v[64:79]
    v_cmp_eq_u32 vcc, -1, v28
    s_cbranch_vccnz VBAD_51
VOK_50:
BACK_49:
    v_lshl_add_u32 v155, v5, 1, v153
    s_nop 2
    ds_write_b128 v155, v[80:83] offset:14336
    ds_write_b128 v155, v[84:87] offset:15360
    ds_write_b128 v6, v[88:91] offset:6144
    ds_write_b128 v6, v[92:95] offset:7168
    v_lshl_add_u32 v154, v4, 1, v153
    s_nop 0
    ds_write_b128 v154, v[72:75] offset:12288
    ds_write_b128 v154, v[76:79] offset:13312
    ds_read_b64_tr_b16 a[168:169], v26 offset:10240
    ds_read_b64_tr_b16 a[170:171], v26 offset:11264
    ds_read_b64_tr_b16 a[172:173], v27 offset:10240
    ds_read_b64_tr_b16 a[174:175], v27 offset:11264
    ds_read_b64_tr_b16 a[176:177], v26 offset:0
    ds_read_b64_tr_b16 a[178:179], v26 offset:1024
    ds_read_b64_tr_b16 a[180:181], v27 offset:0
    ds_read_b64_tr_b16 a[182:183], v27 offset:1024
    ds_read_b64_tr_b16 a[184:185], v26 offset:2048
    ds_read_b64_tr_b16 a[186:187], v26 offset:3072
    ds_read_b64_tr_b16 a[188:189], v27 offset:2048
    ds_read_b64_tr_b16 a[190:191], v27 offset:3072
    ds_read_b64_tr_b16 a[192:193], v26 offset:4096
    ds_read_b64_tr_b16 a[194:195], v26 offset:5120
    ds_read_b64_tr_b16 a[196:197], v27 offset:4096
    ds_read_b64_tr_b16 a[198:199], v27 offset:5120
    ds_read_b64_tr_b16 a[200:201], v26 offset:6144
    ds_read_b64_tr_b16 a[202:203], v26 offset:7168
    ds_read_b64_tr_b16 a[204:205], v27 offset:6144
    ds_read_b64_tr_b16 a[206:207], v27 offset:7168
    ds_read_b64_tr_b16 a[208:209], v26 offset:8192
    ds_read_b64_tr_b16 a[210:211], v26 offset:9216
    ds_read_b64_tr_b16 a[212:213], v27 offset:8192
    ds_read_b64_tr_b16 a[214:215], v27 offset:9216
    s_waitcnt lgkmcnt(15)
    s_add_u32 m0, s75, 10240
    s_add_u32 s80, s80, 65536
    s_cmp_eq_u32 s80, 1835008
    s_cselect_b32 s80, 0, s80
    buffer_load_dwordx4 v24, s[20:23], s80 offen lds
    buffer_load_dwordx4 v25, s[20:23], s80 offen offset:1024 lds
    s_add_u32 m0, s75, 0
    s_add_u32 s80, s80, 65536
    s_cmp_eq_u32 s80, 1835008
    s_cselect_b32 s80, 0, s80
    buffer_load_dwordx4 v24, s[20:23], s80 offen lds
    buffer_load_dwordx4 v25, s[20:23], s80 offen offset:1024 lds
    s_waitcnt lgkmcnt(12)
    s_add_u32 m0, s75, 2048
    s_add_u32 s80, s80, 65536
    s_cmp_eq_u32 s80, 1835008
    s_cselect_b32 s80, 0, s80
    buffer_load_dwordx4 v24, s[20:23], s80 offen lds
    buffer_load_dwordx4 v25, s[20:23], s80 offen offset:1024 lds
    s_waitcnt lgkmcnt(8)
    s_add_u32 m0, s75, 4096
    s_add_u32 s80, s80, 65536
    s_cmp_eq_u32 s80, 1835008
    s_cselect_b32 s80, 0, s80
    buffer_load_dwordx4 v24, s[20:23], s80 offen lds
    buffer_load_dwordx4 v25, s[20:23], s80 offen offset:1024 lds
    v_pk_add_f32 v[64:65], v[64:65], v[144:145]
    v_pk_add_f32 v[66:67], v[66:67], v[146:147]
    v_pk_add_f32 v[68:69], v[68:69], v[148:149]
    v_pk_add_f32 v[70:71], v[70:71], v[150:151]
    v_lshl_add_u32 v154, v20, 1, v153
    s_waitcnt lgkmcnt(0)
    s_barrier
    ds_read_b128 v[32:35], v154 offset:12288
    ds_read_b128 v[40:43], v154 offset:14336
    ds_read_b128 v[48:51], v20 offset:6144
    ds_read_b128 v[36:39], v154 offset:13312
    ds_read_b128 v[44:47], v154 offset:15360
    ds_read_b128 v[52:55], v20 offset:7168
    s_waitcnt lgkmcnt(4)
    v_pk_add_f32 v[32:33], v[32:33], v[40:41]
    v_pk_add_f32 v[34:35], v[34:35], v[42:43]
    s_waitcnt lgkmcnt(3)
    v_pk_add_f32 v[64:65], v[64:65], v[48:49]
    v_pk_add_f32 v[66:67], v[66:67], v[50:51]
    v_pk_add_f32 v[64:65], v[64:65], v[32:33]
    v_pk_add_f32 v[66:67], v[66:67], v[34:35]
    s_waitcnt lgkmcnt(1)
    v_pk_add_f32 v[36:37], v[36:37], v[44:45]
    v_pk_add_f32 v[38:39], v[38:39], v[46:47]
    s_waitcnt lgkmcnt(0)
    v_pk_add_f32 v[68:69], v[68:69], v[52:53]
    v_pk_add_f32 v[70:71], v[70:71], v[54:55]
    v_pk_add_f32 v[68:69], v[68:69], v[36:37]
    v_pk_add_f32 v[70:71], v[70:71], v[38:39]
    v_pk_mul_f32 v[80:81], v[64:65], v[64:65]
    v_pk_mul_f32 v[82:83], v[66:67], v[66:67]
    v_pk_mul_f32 v[84:85], v[68:69], v[68:69]
    v_pk_mul_f32 v[86:87], v[70:71], v[70:71]
    v_pk_fma_f32 v[80:81], v[80:81], s[64:65], v[152:153] op_sel_hi:[1,0,0]
    v_pk_fma_f32 v[82:83], v[82:83], s[64:65], v[152:153] op_sel_hi:[1,0,0]
    v_pk_fma_f32 v[84:85], v[84:85], s[64:65], v[152:153] op_sel_hi:[1,0,0]
    v_pk_fma_f32 v[86:87], v[86:87], s[64:65], v[152:153] op_sel_hi:[1,0,0]
    v_pk_mul_f32 v[80:81], v[80:81], v[64:65]
    v_pk_mul_f32 v[82:83], v[82:83], v[66:67]
    v_pk_mul_f32 v[84:85], v[84:85], v[68:69]
    v_pk_mul_f32 v[86:87], v[86:87], v[70:71]
    v_exp_f32 v80, v80
    v_exp_f32 v81, v81
    v_exp_f32 v82, v82
    v_exp_f32 v83, v83
    v_exp_f32 v84, v84
    v_exp_f32 v85, v85
    v_exp_f32 v86, v86
    v_exp_f32 v87, v87
    v_pk_add_f32 v[80:81], v[80:81], 1.0 op_sel_hi:[1,0]
    v_pk_add_f32 v[82:83], v[82:83], 1.0 op_sel_hi:[1,0]
    v_pk_add_f32 v[84:85], v[84:85], 1.0 op_sel_hi:[1,0]
    v_pk_add_f32 v[86:87], v[86:87], 1.0 op_sel_hi:[1,0]
    v_rcp_f32 v80, v80
    v_rcp_f32 v81, v81
    v_rcp_f32 v82, v82
    v_rcp_f32 v83, v83
    v_rcp_f32 v84, v84
    v_rcp_f32 v85, v85
    v_rcp_f32 v86, v86
    v_rcp_f32 v87, v87
    v_pk_mul_f32 v[64:65], v[64:65], v[80:81]
    v_pk_mul_f32 v[66:67], v[66:67], v[82:83]
    v_pk_mul_f32 v[68:69], v[68:69], v[84:85]
    v_pk_mul_f32 v[70:71], v[70:71], v[86:87]
    v_cvt_pk_bf16_f32 v88, v64, v65
    v_cvt_pk_bf16_f32 v89, v66, v67
    v_cvt_pk_bf16_f32 v90, v68, v69
    v_cvt_pk_bf16_f32 v91, v70, v71
    buffer_store_dwordx4 v[88:91], v1, s[24:27], s92 offen offset:1024 sc1
    s_waitcnt vmcnt(18)
    v_cmp_eq_u32 vcc, -1, v7
    s_cbranch_vccnz FB_52
FBB_53:
    s_nop 1
P3JOIN_35:
    v_mov_b32 v56, -1
    v_mov_b32 v57, -1
    v_mov_b32_e64 v58, -1
    v_mov_b32_e64 v59, -1
    buffer_store_dwordx4 v[56:59], v1, s[24:27], s94 offen offset:0 sc1
    buffer_store_dwordx4 v[56:59], v1, s[24:27], s94 offen offset:2048 sc1
    s_add_u32 s62, s85, 0x200000
    buffer_store_dwordx4 v[56:59], v1, s[24:27], s62 offen offset:0 sc1
    buffer_store_dwordx4 v[56:59], v1, s[24:27], s62 offen offset:1024 sc1
    s_add_u32 s63, s84, 0xbe000
    s_mov_b32 exec_lo, 0xffffffff
    s_mov_b32 exec_hi, 0xff
    buffer_store_dwordx4 v[56:59], v1, s[24:27], s63 offen offset:0 sc1
    s_mul_i32 s62, s79, 384
    s_add_u32 s62, s62, 0xc0000
    s_cmp_ge_u32 s79, 64
    s_cselect_b32 s62, 0x10000000, s62
    s_mov_b32 exec_lo, 0xffffff
    s_mov_b32 exec_hi, 0x0
    buffer_store_dwordx4 v[56:59], v1, s[24:27], s62 offen offset:0 sc1
    s_mov_b64 exec, -1
    s_waitcnt lgkmcnt(4)
    s_add_u32 m0, s75, 6144
    s_add_u32 s80, s80, 65536
    s_cmp_eq_u32 s80, 1835008
    s_cselect_b32 s80, 0, s80
    buffer_load_dwordx4 v24, s[20:23], s80 offen lds
    buffer_load_dwordx4 v25, s[20:23], s80 offen offset:1024 lds
    s_waitcnt lgkmcnt(0)
    s_add_u32 m0, s75, 8192
    s_add_u32 s80, s80, 65536
    s_cmp_eq_u32 s80, 1835008
    s_cselect_b32 s80, 0, s80
    buffer_load_dwordx4 v24, s[20:23], s80 offen lds
    buffer_load_dwordx4 v25, s[20:23], s80 offen offset:1024 lds
    v_mov_b32_e64 v28, 0
    s_waitcnt vmcnt(26)
    v_mfma_f32_32x32x16_bf16 v[48:63], v[112:115], a[132:135], 0
    buffer_load_dwordx4 v[100:103], v3, s[24:27], s68 offen offset:2048 sc1
    v_mfma_f32_32x32x16_bf16 v[32:47], v[112:115], a[128:131], 0
    s_waitcnt vmcnt(17)
    ds_read_b64_tr_b16 a[216:217], v26 offset:10240
    ds_read_b64_tr_b16 a[218:219], v26 offset:11264
    ds_read_b64_tr_b16 a[220:221], v27 offset:10240
    ds_read_b64_tr_b16 a[222:223], v27 offset:11264
    s_waitcnt vmcnt(15)
    ds_read_b64_tr_b16 a[224:225], v26 offset:0
    ds_read_b64_tr_b16 a[226:227], v26 offset:1024
    ds_read_b64_tr_b16 a[228:229], v27 offset:0
    ds_read_b64_tr_b16 a[230:231], v27 offset:1024
    s_waitcnt lgkmcnt(4)
    s_add_u32 m0, s75, 10240
    s_add_u32 s80, s80, 65536
    s_cmp_eq_u32 s80, 1835008
    s_cselect_b32 s80, 0, s80
    buffer_load_dwordx4 v24, s[20:23], s80 offen lds
    buffer_load_dwordx4 v25, s[20:23], s80 offen offset:1024 lds
    s_waitcnt lgkmcnt(0)
    s_add_u32 m0, s75, 0
    s_add_u32 s80, s80, 65536
    s_cmp_eq_u32 s80, 1835008
    s_cselect_b32 s80, 0, s80
    buffer_load_dwordx4 v24, s[20:23], s80 offen lds
    buffer_load_dwordx4 v25, s[20:23], s80 offen offset:1024 lds
    v_mfma_f32_32x32x16_bf16 v[48:63], v[116:119], a[140:143], v[48:63]
    s_add_u32 s68, s68, 4096
    s_cmp_eq_u32 s68, 57344
    s_cselect_b32 s68, 0, s68
    buffer_load_dwordx4 v[104:107], v3, s[24:27], s68 offen offset:0 sc1
    v_max3_u32 v28, v28, v112, v116
    v_mfma_f32_32x32x16_bf16 v[32:47], v[116:119], a[136:139], v[32:47]
    s_waitcnt vmcnt(18)
    ds_read_b64_tr_b16 a[232:233], v26 offset:2048
    ds_read_b64_tr_b16 a[234:235], v26 offset:3072
    ds_read_b64_tr_b16 a[236:237], v27 offset:2048
    ds_read_b64_tr_b16 a[238:239], v27 offset:3072
    s_waitcnt vmcnt(16)
    ds_read_b64_tr_b16 a[240:241], v26 offset:4096
    ds_read_b64_tr_b16 a[242:243], v26 offset:5120
    ds_read_b64_tr_b16 a[244:245], v27 offset:4096
    ds_read_b64_tr_b16 a[246:247], v27 offset:5120
    s_waitcnt lgkmcnt(4)
    s_add_u32 m0, s75, 2048
    s_add_u32 s80, s80, 65536
    s_cmp_eq_u32 s80, 1835008
    s_cselect_b32 s80, 0, s80
    buffer_load_dwordx4 v24, s[20:23], s80 offen lds
    buffer_load_dwordx4 v25, s[20:23], s80 offen offset:1024 lds
    s_waitcnt lgkmcnt(0)
    s_add_u32 m0, s75, 4096
    s_add_u32 s80, s80, 65536
    s_cmp_eq_u32 s80, 1835008
    s_cselect_b32 s80, 0, s80
    buffer_load_dwordx4 v24, s[20:23], s80 offen lds
    buffer_load_dwordx4 v25, s[20:23], s80 offen offset:1024 lds
    v_mfma_f32_32x32x16_bf16 v[48:63], v[120:123], a[148:151], v[48:63]
    buffer_load_dwordx4 v[108:111], v3, s[24:27], s68 offen offset:2048 sc1
    v_mfma_f32_32x32x16_bf16 v[32:47], v[120:123], a[144:147], v[32:47]
    s_waitcnt vmcnt(13)
    ds_read_b64_tr_b16 a[248:249], v26 offset:6144
    ds_read_b64_tr_b16 a[250:251], v26 offset:7168
    ds_read_b64_tr_b16 a[252:253], v27 offset:6144
    ds_read_b64_tr_b16 a[254:255], v27 offset:7168
    s_waitcnt vmcnt(11)
    ds_read_b64_tr_b16 v[160:161], v26 offset:8192
    ds_read_b64_tr_b16 v[162:163], v26 offset:9216
    ds_read_b64_tr_b16 v[164:165], v27 offset:8192
    ds_read_b64_tr_b16 v[166:167], v27 offset:9216
    s_waitcnt lgkmcnt(4)
    s_add_u32 m0, s75, 6144
    s_add_u32 s80, s80, 65536
    s_cmp_eq_u32 s80, 1835008
    s_cselect_b32 s80, 0, s80
    buffer_load_dwordx4 v24, s[20:23], s80 offen lds
    buffer_load_dwordx4 v25, s[20:23], s80 offen offset:1024 lds
    s_waitcnt lgkmcnt(0)
    s_add_u32 m0, s75, 8192
    s_add_u32 s80, s80, 65536
    s_cmp_eq_u32 s80, 1835008
    s_cselect_b32 s80, 0, s80
    buffer_load_dwordx4 v24, s[20:23], s80 offen lds
    buffer_load_dwordx4 v25, s[20:23], s80 offen offset:1024 lds
    v_mfma_f32_32x32x16_bf16 v[48:63], v[124:127], a[156:159], v[48:63]
    s_add_u32 s68, s68, 4096
    s_cmp_eq_u32 s68, 57344
    s_cselect_b32 s68, 0, s68
    buffer_load_dwordx4 v[112:115], v3, s[24:27], s68 offen offset:0 sc1
    v_max3_u32 v28, v28, v120, v124
    v_mfma_f32_32x32x16_bf16 v[32:47], v[124:127], a[152:155], v[32:47]
    v_mfma_f32_32x32x16_bf16 v[48:63], v[128:131], a[164:167], v[48:63]
    buffer_load_dwordx4 v[116:119], v3, s[24:27], s68 offen offset:2048 sc1
    v_mfma_f32_32x32x16_bf16 v[32:47], v[128:131], a[160:163], v[32:47]
    v_mfma_f32_32x32x16_bf16 v[48:63], v[132:135], a[172:175], v[48:63]
    s_add_u32 s68, s68, 4096
    s_cmp_eq_u32 s68, 57344
    s_cselect_b32 s68, 0, s68
    buffer_load_dwordx4 v[120:123], v3, s[24:27], s68 offen offset:0 sc1
    v_max3_u32 v28, v28, v128, v132
    v_mfma_f32_32x32x16_bf16 v[32:47], v[132:135], a[168:171], v[32:47]
    v_mfma_f32_32x32x16_bf16 v[48:63], v[136:139], a[180:183], v[48:63]
    buffer_load_dwordx4 v[124:127], v3, s[24:27], s68 offen offset:2048 sc1
    v_mfma_f32_32x32x16_bf16 v[32:47], v[136:139], a[176:179], v[32:47]
    v_mfma_f32_32x32x16_bf16 v[48:63], v[140:143], a[188:191], v[48:63]
    s_add_u32 s68, s68, 4096
    s_cmp_eq_u32 s68, 57344
    s_cselect_b32 s68, 0, s68
    buffer_load_dwordx4 v[128:131], v3, s[24:27], s68 offen offset:0 sc1
    v_max3_u32 v28, v28, v136, v140
    v_mfma_f32_32x32x16_bf16 v[32:47], v[140:143], a[184:187], v[32:47]
    v_mfma_f32_32x32x16_bf16 v[48:63], v[96:99], a[196:199], v[48:63]
    buffer_load_dwordx4 v[132:135], v3, s[24:27], s68 offen offset:2048 sc1
    v_mfma_f32_32x32x16_bf16 v[32:47], v[96:99], a[192:195], v[32:47]
    s_waitcnt vmcnt(20)
    v_mfma_f32_32x32x16_bf16 v[48:63], v[100:103], a[204:207], v[48:63]
    s_add_u32 s68, s68, 4096
    s_cmp_eq_u32 s68, 57344
    s_cselect_b32 s68, 0, s68
    buffer_load_dwordx4 v[136:139], v3, s[24:27], s68 offen offset:0 sc1
    v_max3_u32 v28, v28, v96, v100
    v_mfma_f32_32x32x16_bf16 v[32:47], v[100:103], a[200:203], v[32:47]
    s_waitcnt vmcnt(16)
    v_mfma_f32_32x32x16_bf16 v[48:63], v[104:107], a[212:215], v[48:63]
    buffer_load_dwordx4 v[140:143], v3, s[24:27], s68 offen offset:2048 sc1
    v_mfma_f32_32x32x16_bf16 v[32:47], v[104:107], a[208:211], v[32:47]
    s_waitcnt vmcnt(12)
    v_mfma_f32_32x32x16_bf16 v[48:63], v[108:111], a[220:223], v[48:63]
    s_add_u32 s68, s68, 4096
    s_cmp_eq_u32 s68, 57344
    s_cselect_b32 s68, 0, s68
    buffer_load_dwordx4 v[96:99], v3, s[24:27], s68 offen offset:0 sc1
    v_max3_u32 v28, v28, v104, v108
    v_mfma_f32_32x32x16_bf16 v[32:47], v[108:111], a[216:219], v[32:47]
    s_waitcnt vmcnt(8)
    v_mfma_f32_32x32x16_bf16 v[48:63], v[112:115], a[228:231], v[48:63]
    buffer_load_dwordx4 v[100:103], v3, s[24:27], s68 offen offset:2048 sc1
    v_mfma_f32_32x32x16_bf16 v[32:47], v[112:115], a[224:227], v[32:47]
    s_waitcnt vmcnt(8)
    v_mfma_f32_32x32x16_bf16 v[48:63], v[116:119], a[236:239], v[48:63]
    s_add_u32 s68, s68, 4096
    s_cmp_eq_u32 s68, 57344
    s_cselect_b32 s68, 0, s68
    buffer_load_dwordx4 v[104:107], v3, s[24:27], s68 offen offset:0 sc1
    v_max3_u32 v28, v28, v112, v116
    v_mfma_f32_32x32x16_bf16 v[32:47], v[116:119], a[232:235], v[32:47]
    s_waitcnt vmcnt(8)
    v_mfma_f32_32x32x16_bf16 v[48:63], v[120:123], a[244:247], v[48:63]
    buffer_load_dwordx4 v[108:111], v3, s[24:27], s68 offen offset:2048 sc1
    v_mfma_f32_32x32x16_bf16 v[32:47], v[120:123], a[240:243], v[32:47]
    s_waitcnt vmcnt(8)
    v_mfma_f32_32x32x16_bf16 v[48:63], v[124:127], a[252:255], v[48:63]
    s_add_u32 s68, s68, 4096
    s_cmp_eq_u32 s68, 57344
    s_cselect_b32 s68, 0, s68
    buffer_load_dwordx4 v[112:115], v3, s[24:27], s68 offen offset:0 sc1
    v_max3_u32 v28, v28, v120, v124
    v_mfma_f32_32x32x16_bf16 v[32:47], v[124:127], a[248:251], v[32:47]
    ds_read_b64_tr_b16 v[168:169], v26 offset:10240
    ds_read_b64_tr_b16 v[170:171], v26 offset:11264
    ds_read_b64_tr_b16 v[172:173], v27 offset:10240
    ds_read_b64_tr_b16 v[174:175], v27 offset:11264
    s_waitcnt lgkmcnt(0)
    s_add_u32 m0, s75, 10240
    s_add_u32 s80, s80, 65536
    s_cmp_eq_u32 s80, 1835008
    s_cselect_b32 s80, 0, s80
    buffer_load_dwordx4 v24, s[20:23], s80 offen lds
    buffer_load_dwordx4 v25, s[20:23], s80 offen offset:1024 lds
    s_waitcnt vmcnt(10)
    v_mfma_f32_32x32x16_bf16 v[48:63], v[128:131], v[164:167], v[48:63]
    buffer_load_dwordx4 v[116:119], v3, s[24:27], s68 offen offset:2048 sc1
    v_mfma_f32_32x32x16_bf16 v[32:47], v[128:131], v[160:163], v[32:47]
    ds_read_b64_tr_b16 v[176:177], v26 offset:0
    ds_read_b64_tr_b16 v[178:179], v26 offset:1024
    ds_read_b64_tr_b16 v[180:181], v27 offset:0
    ds_read_b64_tr_b16 v[182:183], v27 offset:1024
    s_waitcnt lgkmcnt(0)
    s_add_u32 m0, s75, 0
    s_add_u32 s80, s80, 65536
    s_cmp_eq_u32 s80, 1835008
    s_cselect_b32 s80, 0, s80
    buffer_load_dwordx4 v24, s[20:23], s80 offen lds
    buffer_load_dwordx4 v25, s[20:23], s80 offen offset:1024 lds
    s_waitcnt vmcnt(12)
    v_mfma_f32_32x32x16_bf16 v[48:63], v[132:135], v[172:175], v[48:63]
    s_add_u32 s68, s68, 4096
    s_cmp_eq_u32 s68, 57344
    s_cselect_b32 s68, 0, s68
    buffer_load_dwordx4 v[120:123], v3, s[24:27], s68 offen offset:0 sc1
    v_max3_u32 v28, v28, v128, v132
    v_mfma_f32_32x32x16_bf16 v[32:47], v[132:135], v[168:171], v[32:47]
    ds_read_b64_tr_b16 v[184:185], v26 offset:2048
    ds_read_b64_tr_b16 v[186:187], v26 offset:3072
    ds_read_b64_tr_b16 v[188:189], v27 offset:2048
    ds_read_b64_tr_b16 v[190:191], v27 offset:3072
    s_waitcnt lgkmcnt(0)
    s_add_u32 m0, s75, 2048
    s_add_u32 s80, s80, 65536
    s_cmp_eq_u32 s80, 1835008
    s_cselect_b32 s80, 0, s80
    buffer_load_dwordx4 v24, s[20:23], s80 offen lds
    buffer_load_dwordx4 v25, s[20:23], s80 offen offset:1024 lds
    s_waitcnt vmcnt(14)
    v_mfma_f32_32x32x16_bf16 v[48:63], v[136:139], v[180:183], v[48:63]
    buffer_load_dwordx4 v[124:127], v3, s[24:27], s68 offen offset:2048 sc1
    v_mfma_f32_32x32x16_bf16 v[32:47], v[136:139], v[176:179], v[32:47]
    ds_read_b64_tr_b16 v[192:193], v26 offset:4096
    ds_read_b64_tr_b16 v[194:195], v26 offset:5120
    ds_read_b64_tr_b16 v[196:197], v27 offset:4096
    ds_read_b64_tr_b16 v[198:199], v27 offset:5120
    s_waitcnt lgkmcnt(0)
    s_add_u32 m0, s75, 4096
    s_add_u32 s80, s80, 65536
    s_cmp_eq_u32 s80, 1835008
    s_cselect_b32 s80, 0, s80
    buffer_load_dwordx4 v24, s[20:23], s80 offen lds
    buffer_load_dwordx4 v25, s[20:23], s80 offen offset:1024 lds
    s_waitcnt vmcnt(16)
    v_mfma_f32_32x32x16_bf16 v[48:63], v[140:143], v[188:191], v[48:63]
    buffer_load_dword v7, v30, s[24:27], s93 offen offset:2044 sc1
    s_lshl_b32 s68, s78, 11
    buffer_load_dwordx4 v[128:131], v3, s[24:27], s68 offen offset:1024 sc1
    v_max3_u32 v28, v28, v136, v140
    v_mfma_f32_32x32x16_bf16 v[32:47], v[140:143], v[184:187], v[32:47]
    ds_read_b64_tr_b16 v[200:201], v26 offset:6144
    ds_read_b64_tr_b16 v[202:203], v26 offset:7168
    ds_read_b64_tr_b16 v[204:205], v27 offset:6144
    ds_read_b64_tr_b16 v[206:207], v27 offset:7168
    s_waitcnt lgkmcnt(0)
    s_add_u32 m0, s75, 6144
    s_add_u32 s80, s80, 65536
    s_cmp_eq_u32 s80, 1835008
    s_cselect_b32 s80, 0, s80
    buffer_load_dwordx4 v24, s[20:23], s80 offen lds
    buffer_load_dwordx4 v25, s[20:23], s80 offen offset:1024 lds
    s_waitcnt vmcnt(19)
    v_mfma_f32_32x32x16_bf16 v[48:63], v[96:99], v[196:199], v[48:63]
    buffer_load_dwordx4 v[132:135], v3, s[24:27], s68 offen offset:3072 sc1
    v_mfma_f32_32x32x16_bf16 v[32:47], v[96:99], v[192:195], v[32:47]
    ds_read_b64_tr_b16 v[208:209], v26 offset:8192
    ds_read_b64_tr_b16 v[210:211], v26 offset:9216
    ds_read_b64_tr_b16 v[212:213], v27 offset:8192
    ds_read_b64_tr_b16 v[214:215], v27 offset:9216
    s_waitcnt vmcnt(19)
    v_mfma_f32_32x32x16_bf16 v[48:63], v[100:103], v[204:207], v[48:63]
    s_add_u32 s68, s68, 4096
    s_cmp_eq_u32 s68, 57344
    s_cselect_b32 s68, 0, s68
    buffer_load_dwordx4 v[136:139], v3, s[24:27], s68 offen offset:1024 sc1
    v_max3_u32 v28, v28, v96, v100
    v_mfma_f32_32x32x16_bf16 v[32:47], v[100:103], v[200:203], v[32:47]
    s_waitcnt vmcnt(15)
    ds_read_b64_tr_b16 v[216:217], v26 offset:10240
    ds_read_b64_tr_b16 v[218:219], v26 offset:11264
    ds_read_b64_tr_b16 v[220:221], v27 offset:10240
    ds_read_b64_tr_b16 v[222:223], v27 offset:11264
    s_waitcnt lgkmcnt(4)
    v_mfma_f32_32x32x16_bf16 v[48:63], v[104:107], v[212:215], v[48:63]
    buffer_load_dwordx4 v[140:143], v3, s[24:27], s68 offen offset:3072 sc1
    v_mfma_f32_32x32x16_bf16 v[32:47], v[104:107], v[208:211], v[32:47]
    s_waitcnt vmcnt(13)
    ds_read_b64_tr_b16 v[224:225], v26 offset:0
    ds_read_b64_tr_b16 v[226:227], v26 offset:1024
    ds_read_b64_tr_b16 v[228:229], v27 offset:0
    ds_read_b64_tr_b16 v[230:231], v27 offset:1024
    s_waitcnt lgkmcnt(4)
    v_mfma_f32_32x32x16_bf16 v[48:63], v[108:111], v[220:223], v[48:63]
    s_add_u32 s68, s68, 4096
    s_cmp_eq_u32 s68, 57344
    s_cselect_b32 s68, 0, s68
    buffer_load_dwordx4 v[96:99], v3, s[24:27], s68 offen offset:1024 sc1
    v_max3_u32 v28, v28, v104, v108
    v_mfma_f32_32x32x16_bf16 v[32:47], v[108:111], v[216:219], v[32:47]
    s_waitcnt vmcnt(11)
    s_nop 0
    ds_read_b64_tr_b16 v[232:233], v26 offset:2048
    ds_read_b64_tr_b16 v[234:235], v26 offset:3072
    ds_read_b64_tr_b16 v[236:237], v27 offset:2048
    ds_read_b64_tr_b16 v[238:239], v27 offset:3072
    s_waitcnt lgkmcnt(4)
    v_mfma_f32_32x32x16_bf16 v[48:63], v[112:115], v[228:231], v[48:63]
    buffer_load_dwordx4 v[100:103], v3, s[24:27], s68 offen offset:3072 sc1
    v_mfma_f32_32x32x16_bf16 v[32:47], v[112:115], v[224:227], v[32:47]
    s_waitcnt vmcnt(9)
    ds_read_b64_tr_b16 v[240:241], v26 offset:4096
    ds_read_b64_tr_b16 v[242:243], v26 offset:5120
    ds_read_b64_tr_b16 v[244:245], v27 offset:4096
    ds_read_b64_tr_b16 v[246:247], v27 offset:5120
    s_waitcnt lgkmcnt(4)
    v_mfma_f32_32x32x16_bf16 v[48:63], v[116:119], v[236:239], v[48:63]
    s_add_u32 s68, s68, 4096
    s_cmp_eq_u32 s68, 57344
    s_cselect_b32 s68, 0, s68
    buffer_load_dwordx4 v[104:107], v3, s[24:27], s68 offen offset:1024 sc1
    v_max3_u32 v28, v28, v112, v116
    v_mfma_f32_32x32x16_bf16 v[32:47], v[116:119], v[232:235], v[32:47]
    s_waitcnt vmcnt(6)
    ds_read_b64_tr_b16 v[248:249], v26 offset:6144
    ds_read_b64_tr_b16 v[250:251], v26 offset:7168
    ds_read_b64_tr_b16 v[252:253], v27 offset:6144
    ds_read_b64_tr_b16 v[254:255], v27 offset:7168
    s_waitcnt lgkmcnt(4)
    v_mfma_f32_32x32x16_bf16 v[48:63], v[120:123], v[244:247], v[48:63]
    buffer_load_dwordx4 v[108:111], v3, s[24:27], s68 offen offset:3072 sc1
    v_mfma_f32_32x32x16_bf16 v[32:47], v[120:123], v[240:243], v[32:47]
    s_waitcnt lgkmcnt(0)
    v_mfma_f32_32x32x16_bf16 v[48:63], v[124:127], v[252:255], v[48:63]
    s_add_u32 s68, s68, 4096
    s_cmp_eq_u32 s68, 57344
    s_cselect_b32 s68, 0, s68
    buffer_load_dwordx4 v[112:115], v3, s[24:27], s68 offen offset:1024 sc1
    v_max3_u32 v28, v28, v120, v124
    v_mfma_f32_32x32x16_bf16 v[32:47], v[124:127], v[248:251], v[32:47]
    v_cmp_eq_u32_e64 vcc, -1, v28
    s_cbranch_vccnz VBAD_65
VOK_64:
BACK_63:
    s_nop 3
    ds_write_b128 v5, v[48:51] offset:2048
    ds_write_b128 v5, v[52:55] offset:3072
    ds_write_b128 v6, v[56:59] offset:4096
    ds_write_b128 v6, v[60:63] offset:5120
    s_nop 1
    ds_write_b128 v4, v[40:43] offset:0
    ds_write_b128 v4, v[44:47] offset:1024
    v_cmp_eq_u32_e64 vcc, -1, v7
    s_cbranch_vccnz FB_66
FBB_67:
    v_mov_b32_e64 v28, 0
    v_lshlrev_b32_e64 v144, 16, v8
    v_mfma_f32_32x32x16_bf16 v[80:95], v[128:131], a[132:135], 0
    buffer_load_dwordx4 v[116:119], v3, s[24:27], s68 offen offset:3072 sc1
    v_mfma_f32_32x32x16_bf16 v[64:79], v[128:131], a[128:131], 0
    v_and_b32 v145, 0xffff0000, v8
    v_lshlrev_b32_e64 v146, 16, v9
    v_and_b32 v147, 0xffff0000, v9
    s_waitcnt vmcnt(8)
    v_mfma_f32_32x32x16_bf16 v[80:95], v[132:135], a[140:143], v[80:95]
    s_add_u32 s68, s68, 4096
    s_cmp_eq_u32 s68, 57344
    s_cselect_b32 s68, 0, s68
    buffer_load_dwordx4 v[120:123], v3, s[24:27], s68 offen offset:1024 sc1
    v_max3_u32 v28, v28, v128, v132
    v_mfma_f32_32x32x16_bf16 v[64:79], v[132:135], a[136:139], v[64:79]
    v_lshlrev_b32_e64 v148, 16, v10
    v_and_b32 v149, 0xffff0000, v10
    v_lshlrev_b32 v150, 16, v11
    s_waitcnt vmcnt(8)
    v_mfma_f32_32x32x16_bf16 v[80:95], v[136:139], a[148:151], v[80:95]
    buffer_load_dwordx4 v[124:127], v3, s[24:27], s68 offen offset:3072 sc1
    v_mfma_f32_32x32x16_bf16 v[64:79], v[136:139], a[144:147], v[64:79]
    v_and_b32 v151, 0xffff0000, v11
    s_waitcnt lgkmcnt(0)
    s_barrier
    ds_read_b128 v[40:43], v20 offset:0
    s_waitcnt vmcnt(8)
    v_mfma_f32_32x32x16_bf16 v[80:95], v[140:143], a[156:159], v[80:95]
    s_add_u32 s68, s68, 4096
    s_cmp_eq_u32 s68, 57344
    s_cselect_b32 s68, 0, s68
    buffer_load_dwordx4 v[128:131], v3, s[24:27], s68 offen offset:1024 sc1
    v_max3_u32 v28, v28, v136, v140
    v_mfma_f32_32x32x16_bf16 v[64:79], v[140:143], a[152:155], v[64:79]
    ds_read_b128 v[48:51], v20 offset:2048
    ds_read_b128 v[56:59], v20 offset:4096
    ds_read_b128 v[44:47], v20 offset:1024
    s_waitcnt vmcnt(8)
    v_mfma_f32_32x32x16_bf16 v[80:95], v[96:99], a[164:167], v[80:95]
    buffer_load_dwordx4 v[132:135], v3, s[24:27], s68 offen offset:3072 sc1
    v_mfma_f32_32x32x16_bf16 v[64:79], v[96:99], a[160:163], v[64:79]
    ds_read_b128 v[52:55], v20 offset:3072
    ds_read_b128 v[60:63], v20 offset:5120
    v_add_f32 v32, v32, v19
    s_waitcnt vmcnt(8)
    v_mfma_f32_32x32x16_bf16 v[80:95], v[100:103], a[172:175], v[80:95]
    s_add_u32 s68, s68, 4096
    s_cmp_eq_u32 s68, 57344
    s_cselect_b32 s68, 0, s68
    buffer_load_dwordx4 v[136:139], v3, s[24:27], s68 offen offset:1024 sc1
    v_max3_u32 v28, v28, v96, v100
    v_mfma_f32_32x32x16_bf16 v[64:79], v[100:103], a[168:171], v[64:79]
    v_add_f32_e64 v33, v33, v19
    v_add_f32_e64 v34, v34, v19
    v_add_f32 v35, v35, v19
    s_waitcnt vmcnt(8)
    v_mfma_f32_32x32x16_bf16 v[80:95], v[104:107], a[180:183], v[80:95]
    buffer_load_dwordx4 v[140:143], v3, s[24:27], s68 offen offset:3072 sc1
    v_mfma_f32_32x32x16_bf16 v[64:79], v[104:107], a[176:179], v[64:79]
    v_add_f32_e64 v36, v36, v19
    v_add_f32_e64 v37, v37, v19
    v_add_f32_e64 v38, v38, v19
    s_waitcnt vmcnt(8)
    v_mfma_f32_32x32x16_bf16 v[80:95], v[108:111], a[188:191], v[80:95]
    s_add_u32 s68, s68, 4096
    s_cmp_eq_u32 s68, 57344
    s_cselect_b32 s68, 0, s68
    buffer_load_dwordx4 v[96:99], v3, s[24:27], s68 offen offset:1024 sc1
    v_max3_u32 v28, v28, v104, v108
    v_mfma_f32_32x32x16_bf16 v[64:79], v[108:111], a[184:187], v[64:79]
    v_add_f32 v39, v39, v19
    s_waitcnt lgkmcnt(5)
    v_add_f32_e64 v32, v32, v40
    v_add_f32 v33, v33, v41
    s_waitcnt vmcnt(8)
    v_mfma_f32_32x32x16_bf16 v[80:95], v[112:115], a[196:199], v[80:95]
    buffer_load_dwordx4 v[100:103], v3, s[24:27], s68 offen offset:3072 sc1
    v_mfma_f32_32x32x16_bf16 v[64:79], v[112:115], a[192:195], v[64:79]
    v_add_f32_e64 v34, v34, v42
    v_add_f32 v35, v35, v43
    s_waitcnt lgkmcnt(4)
    v_add_f32_e64 v32, v32, v48
    s_waitcnt vmcnt(8)
    v_mfma_f32_32x32x16_bf16 v[80:95], v[116:119], a[204:207], v[80:95]
    s_add_u32 s68, s68, 4096
    s_cmp_eq_u32 s68, 57344
    s_cselect_b32 s68, 0, s68
    buffer_load_dwordx4 v[104:107], v3, s[24:27], s68 offen offset:1024 sc1
    v_max3_u32 v28, v28, v112, v116
    v_mfma_f32_32x32x16_bf16 v[64:79], v[116:119], a[200:203], v[64:79]
    v_add_f32_e64 v33, v33, v49
    v_add_f32_e64 v34, v34, v50
    v_add_f32 v35, v35, v51
    s_waitcnt vmcnt(8)
    v_mfma_f32_32x32x16_bf16 v[80:95], v[120:123], a[212:215], v[80:95]
    buffer_load_dwordx4 v[108:111], v3, s[24:27], s68 offen offset:3072 sc1
    v_mfma_f32_32x32x16_bf16 v[64:79], v[120:123], a[208:211], v[64:79]
    s_waitcnt lgkmcnt(3)
    v_add_f32 v32, v32, v56
    v_add_f32_e64 v33, v33, v57
    v_add_f32_e64 v34, v34, v58
    s_waitcnt vmcnt(8)
    v_mfma_f32_32x32x16_bf16 v[80:95], v[124:127], a[220:223], v[80:95]
    s_add_u32 s68, s68, 4096
    s_cmp_eq_u32 s68, 57344
    s_cselect_b32 s68, 0, s68
    buffer_load_dwordx4 v[112:115], v3, s[24:27], s68 offen offset:1024 sc1
    v_max3_u32 v28, v28, v120, v124
    v_mfma_f32_32x32x16_bf16 v[64:79], v[124:127], a[216:219], v[64:79]
    v_add_f32 v35, v35, v59
    s_waitcnt lgkmcnt(2)
    v_add_f32_e64 v36, v36, v44
    v_add_f32 v37, v37, v45
    s_waitcnt vmcnt(8)
    v_mfma_f32_32x32x16_bf16 v[80:95], v[128:131], a[228:231], v[80:95]
    buffer_load_dwordx4 v[116:119], v3, s[24:27], s68 offen offset:3072 sc1
    v_mfma_f32_32x32x16_bf16 v[64:79], v[128:131], a[224:227], v[64:79]
    v_add_f32_e64 v38, v38, v46
    v_add_f32 v39, v39, v47
    s_waitcnt lgkmcnt(1)
    v_add_f32_e64 v36, v36, v52
    s_waitcnt vmcnt(8)
    v_mfma_f32_32x32x16_bf16 v[80:95], v[132:135], a[236:239], v[80:95]
    s_add_u32 s68, s68, 4096
    s_cmp_eq_u32 s68, 57344
    s_cselect_b32 s68, 0, s68
    buffer_load_dwordx4 v[120:123], v3, s[24:27], s68 offen offset:1024 sc1
    v_max3_u32 v28, v28, v128, v132
    v_mfma_f32_32x32x16_bf16 v[64:79], v[132:135], a[232:235], v[64:79]
    v_add_f32_e64 v37, v37, v53
    v_add_f32_e64 v38, v38, v54
    v_add_f32 v39, v39, v55
    s_waitcnt vmcnt(8)
    v_mfma_f32_32x32x16_bf16 v[80:95], v[136:139], a[244:247], v[80:95]
    buffer_load_dwordx4 v[124:127], v3, s[24:27], s68 offen offset:3072 sc1
    v_mfma_f32_32x32x16_bf16 v[64:79], v[136:139], a[240:243], v[64:79]
    s_waitcnt lgkmcnt(0)
    v_add_f32 v36, v36, v60
    v_add_f32_e64 v37, v37, v61
    v_add_f32_e64 v38, v38, v62
    s_waitcnt vmcnt(8)
    v_mfma_f32_32x32x16_bf16 v[80:95], v[140:143], a[252:255], v[80:95]
    s_add_u32 s68, s68, 4096
    s_cmp_eq_u32 s68, 57344
    s_cselect_b32 s68, 0, s68
    buffer_load_dwordx4 v[128:131], v3, s[24:27], s68 offen offset:1024 sc1
    v_max3_u32 v28, v28, v136, v140
    v_mfma_f32_32x32x16_bf16 v[64:79], v[140:143], a[248:251], v[64:79]
    v_add_f32_e64 v39, v39, v63
    v_add_f32_e64 v32, v32, v144
    v_add_f32 v33, v33, v145
    s_waitcnt vmcnt(8)
    v_mfma_f32_32x32x16_bf16 v[80:95], v[96:99], v[164:167], v[80:95]
    buffer_load_dwordx4 v[132:135], v3, s[24:27], s68 offen offset:3072 sc1
    v_mfma_f32_32x32x16_bf16 v[64:79], v[96:99], v[160:163], v[64:79]
    v_add_f32_e64 v34, v34, v146
    v_add_f32_e64 v35, v35, v147
    v_add_f32_e64 v36, v36, v148
    s_waitcnt vmcnt(8)
    v_mfma_f32_32x32x16_bf16 v[80:95], v[100:103], v[172:175], v[80:95]
    s_add_u32 s68, s68, 4096
    s_cmp_eq_u32 s68, 57344
    s_cselect_b32 s68, 0, s68
    buffer_load_dwordx4 v[136:139], v3, s[24:27], s68 offen offset:1024 sc1
    v_max3_u32 v28, v28, v96, v100
    v_mfma_f32_32x32x16_bf16 v[64:79], v[100:103], v[168:171], v[64:79]
    v_add_f32_e64 v37, v37, v149
    v_add_f32_e64 v38, v38, v150
    v_add_f32 v39, v39, v151
    s_waitcnt vmcnt(8)
    v_mfma_f32_32x32x16_bf16 v[80:95], v[104:107], v[180:183], v[80:95]
    buffer_load_dwordx4 v[140:143], v3, s[24:27], s68 offen offset:3072 sc1
    v_mfma_f32_32x32x16_bf16 v[64:79], v[104:107], v[176:179], v[64:79]
    v_cvt_pk_bf16_f32 v8, v32, v33
    v_cvt_pk_bf16_f32 v9, v34, v35
    v_cvt_pk_bf16_f32 v10, v36, v37
    v_cvt_pk_bf16_f32 v11, v38, v39
    buffer_store_dwordx4 v[8:11], v1, s[24:27], s94 offen offset:0 sc1
    s_waitcnt vmcnt(9)
    v_mfma_f32_32x32x16_bf16 v[80:95], v[108:111], v[188:191], v[80:95]
    v_max3_u32 v28, v28, v104, v108
    v_mfma_f32_32x32x16_bf16 v[64:79], v[108:111], v[184:187], v[64:79]
    s_add_u32 s65, s98, s75
    s_add_u32 m0, s75, 0
    s_nop 0
    buffer_load_dwordx4 v1, s[24:27], s65 offen offset:0 sc1 lds
    s_waitcnt vmcnt(9)
    v_mfma_f32_32x32x16_bf16 v[80:95], v[112:115], v[196:199], v[80:95]
    v_mfma_f32_32x32x16_bf16 v[64:79], v[112:115], v[192:195], v[64:79]
    buffer_load_dwordx4 v1, s[24:27], s65 offen offset:1024 sc1 lds
    s_waitcnt vmcnt(9)
    v_mfma_f32_32x32x16_bf16 v[80:95], v[116:119], v[204:207], v[80:95]
    v_max3_u32 v28, v28, v112, v116
    v_mfma_f32_32x32x16_bf16 v[64:79], v[116:119], v[200:203], v[64:79]
    buffer_load_dwordx4 v1, s[24:27], s65 offen offset:2048 sc1 lds
    s_waitcnt vmcnt(9)
    v_mfma_f32_32x32x16_bf16 v[80:95], v[120:123], v[212:215], v[80:95]
    v_mfma_f32_32x32x16_bf16 v[64:79], v[120:123], v[208:211], v[64:79]
    buffer_load_dwordx4 v1, s[24:27], s65 offen offset:3072 sc1 lds
    s_waitcnt vmcnt(9)
    v_mfma_f32_32x32x16_bf16 v[80:95], v[124:127], v[220:223], v[80:95]
    v_max3_u32 v28, v28, v120, v124
    v_mfma_f32_32x32x16_bf16 v[64:79], v[124:127], v[216:219], v[64:79]
    s_add_u32 m0, s75, 4096
    s_add_u32 s65, s65, 4096
    buffer_load_dwordx4 v1, s[24:27], s65 offen offset:0 sc1 lds
    s_waitcnt vmcnt(9)
    v_mfma_f32_32x32x16_bf16 v[80:95], v[128:131], v[228:231], v[80:95]
    v_mfma_f32_32x32x16_bf16 v[64:79], v[128:131], v[224:227], v[64:79]
    buffer_load_dwordx4 v1, s[24:27], s65 offen offset:1024 sc1 lds
    s_waitcnt vmcnt(9)
    v_mfma_f32_32x32x16_bf16 v[80:95], v[132:135], v[236:239], v[80:95]
    v_max3_u32 v28, v28, v128, v132
    v_mfma_f32_32x32x16_bf16 v[64:79], v[132:135], v[232:235], v[64:79]
    buffer_load_dwordx4 v1, s[24:27], s65 offen offset:2048 sc1 lds
    s_waitcnt vmcnt(9)
    v_mfma_f32_32x32x16_bf16 v[80:95], v[136:139], v[244:247], v[80:95]
    v_mfma_f32_32x32x16_bf16 v[64:79], v[136:139], v[240:243], v[64:79]
    buffer_load_dwordx4 v1, s[24:27], s65 offen offset:3072 sc1 lds
    s_waitcnt vmcnt(9)
    v_mfma_f32_32x32x16_bf16 v[80:95], v[140:143], v[252:255], v[80:95]
    v_max3_u32 v28, v28, v136, v140
    v_mfma_f32_32x32x16_bf16 v[64:79], v[140:143], v[248:251], v[64:79]
    s_add_u32 m0, s75, 8192
    s_add_u32 s65, s65, 4096
    buffer_load_dwordx4 v1, s[24:27], s65 offen offset:0 sc1 lds
    v_cmp_eq_u32_e64 vcc, -1, v28
    s_cbranch_vccnz VBAD_75
VOK_74:
BACK_73:
    v_lshl_add_u32 v155, v5, 1, v153
    s_nop 3
    ds_write_b128 v155, v[80:83] offset:14336
    ds_write_b128 v155, v[84:87] offset:15360
    ds_write_b128 v6, v[88:91] offset:6144
    ds_write_b128 v6, v[92:95] offset:7168
    v_lshl_add_u32 v154, v4, 1, v153
    ds_write_b128 v154, v[72:75] offset:12288
    ds_write_b128 v154, v[76:79] offset:13312
    buffer_load_dwordx4 v1, s[24:27], s65 offen offset:1024 sc1 lds
    buffer_load_dwordx4 v1, s[24:27], s65 offen offset:2048 sc1 lds
    buffer_load_dwordx4 v1, s[24:27], s65 offen offset:3072 sc1 lds
    v_lshlrev_b32 v144, 16, v12
    v_and_b32 v145, 0xffff0000, v12
    v_lshlrev_b32 v146, 16, v13
    v_and_b32 v147, 0xffff0000, v13
    v_lshlrev_b32_e64 v148, 16, v14
    v_and_b32 v149, 0xffff0000, v14
    v_lshlrev_b32_e64 v150, 16, v15
    v_and_b32 v151, 0xffff0000, v15
    v_pk_add_f32 v[144:145], v[144:145], v[18:19] op_sel:[0,1] op_sel_hi:[1,1]
    v_pk_add_f32 v[146:147], v[146:147], v[18:19] op_sel:[0,1] op_sel_hi:[1,1]
    v_pk_add_f32 v[148:149], v[148:149], v[18:19] op_sel:[0,1] op_sel_hi:[1,1]
    v_pk_add_f32 v[150:151], v[150:151], v[18:19] op_sel:[0,1] op_sel_hi:[1,1]
    v_pk_add_f32 v[64:65], v[64:65], v[144:145]
    v_pk_add_f32 v[66:67], v[66:67], v[146:147]
    v_pk_add_f32 v[68:69], v[68:69], v[148:149]
    v_pk_add_f32 v[70:71], v[70:71], v[150:151]
    v_lshl_add_u32 v154, v20, 1, v153
    s_waitcnt lgkmcnt(0)
    s_barrier
    ds_read_b128 v[32:35], v154 offset:12288
    ds_read_b128 v[40:43], v154 offset:14336
    ds_read_b128 v[48:51], v20 offset:6144
    ds_read_b128 v[36:39], v154 offset:13312
    ds_read_b128 v[44:47], v154 offset:15360
    ds_read_b128 v[52:55], v20 offset:7168
    s_waitcnt lgkmcnt(4)
    v_pk_add_f32 v[32:33], v[32:33], v[40:41]
    v_pk_add_f32 v[34:35], v[34:35], v[42:43]
    s_waitcnt lgkmcnt(3)
    v_pk_add_f32 v[64:65], v[64:65], v[48:49]
    v_pk_add_f32 v[66:67], v[66:67], v[50:51]
    v_pk_add_f32 v[64:65], v[64:65], v[32:33]
    v_pk_add_f32 v[66:67], v[66:67], v[34:35]
    s_waitcnt lgkmcnt(1)
    v_pk_add_f32 v[36:37], v[36:37], v[44:45]
    v_pk_add_f32 v[38:39], v[38:39], v[46:47]
    s_waitcnt lgkmcnt(0)
    v_pk_add_f32 v[68:69], v[68:69], v[52:53]
    v_pk_add_f32 v[70:71], v[70:71], v[54:55]
    v_pk_add_f32 v[68:69], v[68:69], v[36:37]
    v_pk_add_f32 v[70:71], v[70:71], v[38:39]
    s_add_u32 m0, s75, 12288
    s_add_u32 s65, s65, 4096
    buffer_load_dwordx4 v1, s[24:27], s65 offen offset:0 sc1 lds
    buffer_load_dwordx4 v1, s[24:27], s65 offen offset:1024 sc1 lds
    buffer_load_dwordx4 v1, s[24:27], s65 offen offset:2048 sc1 lds
    buffer_load_dwordx4 v1, s[24:27], s65 offen offset:3072 sc1 lds
    v_cvt_pk_bf16_f32 v12, v64, v65
    v_cvt_pk_bf16_f32 v13, v66, v67
    v_cvt_pk_bf16_f32 v14, v68, v69
    v_cvt_pk_bf16_f32 v15, v70, v71
    buffer_store_dwordx4 v[12:15], v1, s[24:27], s94 offen offset:2048 sc1
    v_dot2_f32_bf16 v32, v8, s59, 0
    v_dot2_f32_bf16 v33, v8, v8, 0
    v_dot2_f32_bf16 v34, v9, s59, 0
    v_dot2_f32_bf16 v35, v9, v9, 0
    v_dot2_f32_bf16 v32, v10, s59, v32
    v_dot2_f32_bf16 v33, v10, v10, v33
    v_dot2_f32_bf16 v34, v11, s59, v34
    v_dot2_f32_bf16 v35, v11, v11, v35
    v_dot2_f32_bf16 v32, v12, s59, v32
    v_dot2_f32_bf16 v33, v12, v12, v33
    v_dot2_f32_bf16 v34, v13, s59, v34
    v_dot2_f32_bf16 v35, v13, v13, v35
    v_dot2_f32_bf16 v32, v14, s59, v32
    v_dot2_f32_bf16 v33, v14, v14, v33
    v_dot2_f32_bf16 v34, v15, s59, v34
    v_dot2_f32_bf16 v35, v15, v15, v35
    v_lshlrev_b32 v4, 3, v0
    s_nop 1
    v_pk_add_f32 v[32:33], v[32:33], v[34:35]
    v_mov_b32 v34, v32
    v_mov_b32 v35, v33
    s_nop 0
    v_permlane32_swap_b32 v32, v34
    v_permlane32_swap_b32 v33, v35
    v_pk_add_f32 v[32:33], v[32:33], v[34:35]
    s_mov_b32 exec_hi, 0
    v_and_b32 v33, 0x7fffffff, v33
    buffer_store_dwordx2 v[32:33], v4, s[24:27], s96 offen sc1
    s_mov_b64 exec, -1
    s_and_b32 s67, s76, 1
    s_lshl_b32 s67, s67, 14
    s_add_u32 s66, s95, s67
    v_and_b32 v29, 15, v0
    v_lshrrev_b32 v31, 1, v29
    v_and_b32_e64 v29, 1, v29
    v_lshlrev_b32 v29, 10, v29
    v_lshl_add_u32 v29, v31, 12, v29
    buffer_load_dword v7, v29, s[24:27], s95 offen offset:1020 sc1
    s_mov_b32 s68, s66
    buffer_load_dwordx4 v[192:195], v1, s[24:27], s68 offen offset:0 sc1
    buffer_load_dwordx4 v[196:199], v1, s[24:27], s68 offen offset:1024 sc1
    s_add_u32 s68, s68, 4096
    buffer_load_dwordx4 v[200:203], v1, s[24:27], s68 offen offset:0 sc1
    buffer_load_dwordx4 v[204:207], v1, s[24:27], s68 offen offset:1024 sc1
    s_add_u32 s68, s68, 4096
    buffer_load_dwordx4 v[208:211], v1, s[24:27], s68 offen offset:0 sc1
    buffer_load_dwordx4 v[212:215], v1, s[24:27], s68 offen offset:1024 sc1
    s_add_u32 s68, s68, 4096
    buffer_load_dwordx4 v[216:219], v1, s[24:27], s68 offen offset:0 sc1
    buffer_load_dwordx4 v[220:223], v1, s[24:27], s68 offen offset:1024 sc1
    s_and_b32 s67, s76, 1
    s_lshl_b32 s67, s67, 14
    v_add_u32_e64 v124, s67, v1
    v_xor_b32 v2, 16384, v124
    v_add_u32 v3, 65536, v2
    v_add_u32 v125, 65536, v124
    v_accvgpr_write_b32 a248, s59
    v_accvgpr_write_b32 a249, s59
    v_accvgpr_write_b32 a250, s59
    v_accvgpr_write_b32 a251, s59
    v_mov_b32 v121, 0
    v_mov_b32 v122, 0
    v_mov_b32 v123, 0
    v_mov_b32 v86, 0
    v_mov_b32 v87, 0
    v_mov_b32 v114, 0
    v_mov_b32 v115, 0
    v_mov_b32 v118, 0
    v_mov_b32_e64 v119, 0
    s_add_u32 s84, s84, 0xbe000
    s_add_u32 s85, s85, 0x200000
    s_add_u32 s86, s86, 0x200000
    s_add_u32 s87, s87, 0xbe000
    s_add_u32 s88, s88, 0x40000
    s_add_u32 s89, s89, 0x40000
    s_add_u32 s90, s90, 0x200000
    s_add_u32 s91, s91, 0x200000
    s_add_u32 s92, s92, 0x200000
    s_add_u32 s93, s93, 0x200000
    v_mov_b32 v84, v16
    v_mov_b32 v85, v16
    v_mov_b32 v112, v17
    v_mov_b32 v113, v17
    v_and_b32 v4, 31, v0
    v_lshlrev_b32 v4, 3, v4
    v_lshl_add_u32 v89, v21, 12, v4
    s_lshl_b32 s64, s3, 13
    s_add_u32 s81, s98, s64
    s_mov_b32 s63, s66
    s_lshl_b32 s67, s56, 5
    v_xor_b32 v26, s67, v26
    v_xor_b32 v27, s67, v27
    s_lshl_b32 s66, s53, 103
    s_mul_i32 s67, s3, 1835008
    s_add_u32 s66, s66, s67
    v_lshrrev_b32 v4, 3, v0
    v_mul_u32_u24 v24, 3584, v4
    v_bfe_u32 v5, v0, 4, 1
    v_lshlrev_b32 v5, 2, v5
    v_and_b32 v4, 7, v0
    v_xor_b32_e64 v4, v4, v5
    v_lshl_add_u32 v24, v4, 4, v24
    v_add_u32 v24, s66, v24
    v_add_u32 v25, 27648, v24
    s_add_u32 s67, s77, 16
    s_sub_u32 s80, s67, 32
    s_cselect_b32 s80, s67, s80
    s_mul_i32 s80, s80, 57344
    s_mov_b32 s66, s63
    v_mov_b32 v30, 0
    v_mov_b32 v31, 0
    s_waitcnt vmcnt(8)
    v_cmp_eq_u32_e64 vcc, -1, v7
    s_cbranch_vccnz FB_78
FBB_79:
    s_barrier
XGO_76:
    ds_read_b128 a[216:219], v124 offset:32768
    ds_read_b128 a[220:223], v125 offset:0
    ds_read_b128 a[224:227], v124 offset:33792
    ds_read_b128 a[228:231], v125 offset:1024
    ds_read_b128 a[232:235], v124 offset:36864
    ds_read_b128 a[236:239], v125 offset:4096
    v_mov_b32_e64 v126, 0
    s_mov_b32 s65, s81
    s_waitcnt vmcnt(7) lgkmcnt(4)
    v_mfma_f32_32x32x16_bf16 v[32:47], v[192:195], a[216:219], 0
    s_xor_b32 s68, s66, 16384
    buffer_load_dwordx4 v[224:227], v1, s[24:27], s68 offen offset:0 sc1
    v_mfma_f32_32x32x16_bf16 v[48:63], v[192:195], a[220:223], 0
    ds_read_b128 a[240:243], v124 offset:37888
    ds_read_b128 a[244:247], v125 offset:5120
    s_waitcnt vmcnt(7) lgkmcnt(4)
    v_mfma_f32_32x32x16_bf16 v[32:47], v[196:199], a[224:227], v[32:47]
    buffer_load_dwordx4 v[228:231], v1, s[24:27], s68 offen offset:1024 sc1
    v_mfma_f32_32x32x16_bf16 v[48:63], v[196:199], a[228:231], v[48:63]
    v_max3_u32 v126, v126, v192, v196
    ds_read_b128 a[216:219], v124 offset:40960
    ds_read_b128 a[220:223], v125 offset:8192
    s_waitcnt vmcnt(7) lgkmcnt(4)
    v_mfma_f32_32x32x16_bf16 v[32:47], v[200:203], a[232:235], v[32:47]
    s_add_u32 s68, s68, 4096
    buffer_load_dwordx4 v[232:235], v1, s[24:27], s68 offen offset:0 sc1
    v_mfma_f32_32x32x16_bf16 v[48:63], v[200:203], a[236:239], v[48:63]
    ds_read_b128 a[224:227], v124 offset:41984
    ds_read_b128 a[228:231], v125 offset:9216
    s_waitcnt vmcnt(7) lgkmcnt(4)
    v_mfma_f32_32x32x16_bf16 v[32:47], v[204:207], a[240:243], v[32:47]
    buffer_load_dwordx4 v[236:239], v1, s[24:27], s68 offen offset:1024 sc1
    v_mfma_f32_32x32x16_bf16 v[48:63], v[204:207], a[244:247], v[48:63]
    v_max3_u32 v126, v126, v200, v204
    ds_read_b128 a[232:235], v124 offset:45056
    ds_read_b128 a[236:239], v125 offset:12288
    s_waitcnt vmcnt(7) lgkmcnt(4)
    v_mfma_f32_32x32x16_bf16 v[32:47], v[208:211], a[216:219], v[32:47]
    s_add_u32 s68, s68, 4096
    buffer_load_dwordx4 v[240:243], v1, s[24:27], s68 offen offset:0 sc1
    v_mfma_f32_32x32x16_bf16 v[48:63], v[208:211], a[220:223], v[48:63]
    ds_read_b128 a[240:243], v124 offset:46080
    ds_read_b128 a[244:247], v125 offset:13312
    s_waitcnt vmcnt(7) lgkmcnt(4)
    s_nop 0
    v_mfma_f32_32x32x16_bf16 v[32:47], v[212:215], a[224:227], v[32:47]
    buffer_load_dwordx4 v[244:247], v1, s[24:27], s68 offen offset:1024 sc1
    v_mfma_f32_32x32x16_bf16 v[48:63], v[212:215], a[228:231], v[48:63]
    v_max3_u32 v126, v126, v208, v212
    ds_read_b128 a[216:219], v2 offset:32768
    ds_read_b128 a[220:223], v3 offset:0
    s_waitcnt vmcnt(7) lgkmcnt(4)
    v_mfma_f32_32x32x16_bf16 v[32:47], v[216:219], a[232:235], v[32:47]
    s_add_u32 s68, s68, 4096
    buffer_load_dwordx4 v[248:251], v1, s[24:27], s68 offen offset:0 sc1
    v_mfma_f32_32x32x16_bf16 v[48:63], v[216:219], a[236:239], v[48:63]
    ds_read_b128 a[224:227], v2 offset:33792
    ds_read_b128 a[228:231], v3 offset:1024
    s_waitcnt vmcnt(7) lgkmcnt(4)
    v_mfma_f32_32x32x16_bf16 v[32:47], v[220:223], a[240:243], v[32:47]
    buffer_load_dwordx4 v[252:255], v1, s[24:27], s68 offen offset:1024 sc1
    v_mfma_f32_32x32x16_bf16 v[48:63], v[220:223], a[244:247], v[48:63]
    v_max3_u32 v126, v126, v216, v220
    ds_read_b128 a[232:235], v2 offset:36864
    ds_read_b128 a[236:239], v3 offset:4096
    s_waitcnt vmcnt(7) lgkmcnt(4)
    v_mfma_f32_32x32x16_bf16 v[32:47], v[224:227], a[216:219], v[32:47]
    v_mfma_f32_32x32x16_bf16 v[48:63], v[224:227], a[220:223], v[48:63]
    ds_read_b128 a[240:243], v2 offset:37888
    ds_read_b128 a[244:247], v3 offset:5120
    s_waitcnt vmcnt(6) lgkmcnt(4)
    v_mfma_f32_32x32x16_bf16 v[32:47], v[228:231], a[224:227], v[32:47]
    v_mfma_f32_32x32x16_bf16 v[48:63], v[228:231], a[228:231], v[48:63]
    v_max3_u32 v126, v126, v224, v228
    ds_read_b128 a[216:219], v2 offset:40960
    ds_read_b128 a[220:223], v3 offset:8192
    s_waitcnt vmcnt(5) lgkmcnt(4)
    v_mfma_f32_32x32x16_bf16 v[32:47], v[232:235], a[232:235], v[32:47]
    v_mfma_f32_32x32x16_bf16 v[48:63], v[232:235], a[236:239], v[48:63]
    ds_read_b128 a[224:227], v2 offset:41984
    ds_read_b128 a[228:231], v3 offset:9216
    s_waitcnt vmcnt(4) lgkmcnt(4)
    v_mfma_f32_32x32x16_bf16 v[32:47], v[236:239], a[240:243], v[32:47]
    v_mfma_f32_32x32x16_bf16 v[48:63], v[236:239], a[244:247], v[48:63]
    v_max3_u32 v126, v126, v232, v236
    ds_read_b128 a[232:235], v2 offset:45056
    ds_read_b128 a[236:239], v3 offset:12288
    s_waitcnt vmcnt(3) lgkmcnt(4)
    v_mfma_f32_32x32x16_bf16 v[32:47], v[240:243], a[216:219], v[32:47]
    v_mfma_f32_32x32x16_bf16 v[48:63], v[240:243], a[220:223], v[48:63]
    ds_read_b128 a[240:243], v2 offset:46080
    ds_read_b128 a[244:247], v3 offset:13312
    s_waitcnt vmcnt(2) lgkmcnt(4)
    v_mfma_f32_32x32x16_bf16 v[32:47], v[244:247], a[224:227], v[32:47]
    buffer_load_dwordx2 v[96:97], v89, s[24:27], s97 offen offset:0 sc1
    buffer_load_dwordx2 v[98:99], v89, s[24:27], s97 offen offset:512 sc1
    buffer_load_dwordx2 v[100:101], v89, s[24:27], s97 offen offset:1024 sc1
    buffer_load_dwordx2 v[102:103], v89, s[24:27], s97 offen offset:1536 sc1
    buffer_load_dwordx2 v[104:105], v89, s[24:27], s97 offen offset:2048 sc1
    buffer_load_dwordx2 v[106:107], v89, s[24:27], s97 offen offset:2560 sc1
    buffer_load_dwordx2 v[108:109], v89, s[24:27], s97 offen offset:3072 sc1
    buffer_load_dwordx2 v[110:111], v89, s[24:27], s97 offen offset:3584 sc1
    v_mfma_f32_32x32x16_bf16 v[48:63], v[244:247], a[228:231], v[48:63]
    v_max3_u32 v126, v126, v240, v244
    ds_read_b128 a[216:219], v124 offset:34816
    ds_read_b128 a[220:223], v125 offset:2048
    s_waitcnt vmcnt(9) lgkmcnt(4)
    v_mfma_f32_32x32x16_bf16 v[32:47], v[248:251], a[232:235], v[32:47]
    s_mov_b32 s68, s66
    buffer_load_dwordx4 v[128:131], v1, s[24:27], s68 offen offset:2048 sc1
    buffer_load_dwordx4 v[132:135], v1, s[24:27], s68 offen offset:3072 sc1
    s_add_u32 s68, s68, 4096
    buffer_load_dwordx4 v[136:139], v1, s[24:27], s68 offen offset:2048 sc1
    buffer_load_dwordx4 v[140:143], v1, s[24:27], s68 offen offset:3072 sc1
    v_mfma_f32_32x32x16_bf16 v[48:63], v[248:251], a[236:239], v[48:63]
    ds_read_b128 a[224:227], v124 offset:35840
    ds_read_b128 a[228:231], v125 offset:3072
    s_waitcnt vmcnt(12) lgkmcnt(4)
    s_nop 0
    v_mfma_f32_32x32x16_bf16 v[32:47], v[252:255], a[240:243], v[32:47]
    s_add_u32 s68, s68, 4096
    buffer_load_dwordx4 v[144:147], v1, s[24:27], s68 offen offset:2048 sc1
    buffer_load_dwordx4 v[148:151], v1, s[24:27], s68 offen offset:3072 sc1
    s_add_u32 s68, s68, 4096
    buffer_load_dwordx4 v[152:155], v1, s[24:27], s68 offen offset:2048 sc1
    buffer_load_dwordx4 v[156:159], v1, s[24:27], s68 offen offset:3072 sc1
    v_mfma_f32_32x32x16_bf16 v[48:63], v[252:255], a[244:247], v[48:63]
    v_max3_u32 v126, v126, v248, v252
    ds_read_b128 a[232:235], v124 offset:38912
    ds_read_b128 a[236:239], v125 offset:6144
    s_waitcnt vmcnt(8)
    v_max3_u32 v7, v97, v99, v101
    v_max3_u32 v7, v7, v103, v105
    v_max3_u32 v7, v7, v107, v109
    v_max_u32 v7, v7, v111
    v_cmp_eq_u32 vcc, -1, v7
    s_cbranch_vccnz FB_84
FBB_85:
    v_pk_add_f32 v[96:97], v[96:97], v[104:105]
    v_pk_add_f32 v[98:99], v[98:99], v[106:107]
    v_pk_add_f32 v[100:101], v[100:101], v[108:109]
    v_pk_add_f32 v[102:103], v[102:103], v[110:111]
    v_pk_add_f32 v[96:97], v[96:97], v[100:101]
    v_pk_add_f32 v[98:99], v[98:99], v[102:103]
    v_pk_add_f32 v[96:97], v[96:97], v[98:99]
    v_mov_b32_e64 v98, v96
    v_mov_b32 v99, v97
    s_nop 0
    v_permlane32_swap_b32 v96, v98
    v_permlane32_swap_b32 v97, v99
    v_pk_add_f32 v[96:97], v[96:97], v[98:99]
    v_mul_f32 v96, 0xbb000000, v96
    v_mul_f32 v97, 0x3b000000, v97
    v_cmp_eq_u32_e64 vcc, 0, v21
    v_fma_f32 v97, -v96, v96, v97
    v_max_f32_e64 v97, 0, v97
    v_add_f32 v97, 0x3727c5ac, v97
    v_rsq_f32 v20, v97
    v_cndmask_b32 v96, 0, v96, vcc
    v_cvt_pk_bf16_f32 v28, v96, v96
    v_cndmask_b32_e64 v97, 0, v20, vcc
    v_and_b32 v4, 0xffff0000, v28
    v_sub_f32_e64 v96, v96, v4
    v_cvt_pk_bf16_f32 v29, v96, v96
    v_cvt_pk_bf16_f32 v4, v97, v97
    v_and_b32 v4, 0xffff0000, v4
    v_sub_f32 v120, v97, v4
    v_cvt_pk_bf16_f32 v120, v4, v120
    s_nop 1
    v_mfma_f32_32x32x16_bf16 v[64:79], v[120:123], a[248:251], 0
    v_mfma_f32_32x32x16_bf16 v[32:47], v[28:31], v[84:87], v[32:47]
    v_mfma_f32_32x32x16_bf16 v[48:63], v[28:31], v[112:115], v[48:63]
    s_waitcnt vmcnt(7) lgkmcnt(4)
    v_mfma_f32_32x32x16_bf16 v[32:47], v[128:131], a[216:219], v[32:47]
    s_xor_b32 s68, s66, 16384
    buffer_load_dwordx4 v[160:163], v1, s[24:27], s68 offen offset:2048 sc1
    v_mfma_f32_32x32x16_bf16 v[48:63], v[128:131], a[220:223], v[48:63]
    ds_read_b128 a[240:243], v124 offset:39936
    ds_read_b128 a[244:247], v125 offset:7168
    s_waitcnt vmcnt(7) lgkmcnt(4)
    v_mfma_f32_32x32x16_bf16 v[32:47], v[132:135], a[224:227], v[32:47]
    buffer_load_dwordx4 v[164:167], v1, s[24:27], s68 offen offset:3072 sc1
    v_mfma_f32_32x32x16_bf16 v[48:63], v[132:135], a[228:231], v[48:63]
    v_max3_u32 v126, v126, v128, v132
    ds_read_b128 a[216:219], v124 offset:43008
    ds_read_b128 a[220:223], v125 offset:10240
    s_waitcnt vmcnt(7) lgkmcnt(4)
    v_mfma_f32_32x32x16_bf16 v[32:47], v[136:139], a[232:235], v[32:47]
    s_add_u32 s68, s68, 4096
    buffer_load_dwordx4 v[168:171], v1, s[24:27], s68 offen offset:2048 sc1
    v_mfma_f32_32x32x16_bf16 v[48:63], v[136:139], a[236:239], v[48:63]
    ds_read_b128 a[224:227], v124 offset:44032
    ds_read_b128 a[228:231], v125 offset:11264
    s_waitcnt vmcnt(7) lgkmcnt(4)
    v_mfma_f32_32x32x16_bf16 v[32:47], v[140:143], a[240:243], v[32:47]
    buffer_load_dwordx4 v[172:175], v1, s[24:27], s68 offen offset:3072 sc1
    v_mfma_f32_32x32x16_bf16 v[48:63], v[140:143], a[244:247], v[48:63]
    v_max3_u32 v126, v126, v136, v140
    ds_read_b128 a[232:235], v124 offset:47104
    ds_read_b128 a[236:239], v125 offset:14336
    s_waitcnt vmcnt(7) lgkmcnt(4)
    v_mfma_f32_32x32x16_bf16 v[32:47], v[144:147], a[216:219], v[32:47]
    s_add_u32 s68, s68, 4096
    buffer_load_dwordx4 v[176:179], v1, s[24:27], s68 offen offset:2048 sc1
    v_mfma_f32_32x32x16_bf16 v[48:63], v[144:147], a[220:223], v[48:63]
    ds_read_b128 a[240:243], v124 offset:48128
    ds_read_b128 a[244:247], v125 offset:15360
    s_waitcnt vmcnt(7) lgkmcnt(4)
    v_mfma_f32_32x32x16_bf16 v[32:47], v[148:151], a[224:227], v[32:47]
    buffer_load_dwordx4 v[180:183], v1, s[24:27], s68 offen offset:3072 sc1
    v_mfma_f32_32x32x16_bf16 v[48:63], v[148:151], a[228:231], v[48:63]
    v_max3_u32 v126, v126, v144, v148
    ds_read_b128 a[216:219], v2 offset:34816
    ds_read_b128 a[220:223], v3 offset:2048
    s_waitcnt vmcnt(7) lgkmcnt(4)
    v_mfma_f32_32x32x16_bf16 v[32:47], v[152:155], a[232:235], v[32:47]
    s_add_u32 s68, s68, 4096
    buffer_load_dwordx4 v[184:187], v1, s[24:27], s68 offen offset:2048 sc1
    v_mfma_f32_32x32x16_bf16 v[48:63], v[152:155], a[236:239], v[48:63]
    ds_read_b128 a[224:227], v2 offset:35840
    ds_read_b128 a[228:231], v3 offset:3072
    s_waitcnt vmcnt(7) lgkmcnt(4)
    v_mfma_f32_32x32x16_bf16 v[32:47], v[156:159], a[240:243], v[32:47]
    buffer_load_dwordx4 v[188:191], v1, s[24:27], s68 offen offset:3072 sc1
    v_mfma_f32_32x32x16_bf16 v[48:63], v[156:159], a[244:247], v[48:63]
    v_max3_u32 v126, v126, v152, v156
    ds_read_b128 a[232:235], v2 offset:38912
    ds_read_b128 a[236:239], v3 offset:6144
    s_waitcnt vmcnt(7) lgkmcnt(4)
    v_mfma_f32_32x32x16_bf16 v[32:47], v[160:163], a[216:219], v[32:47]
    s_add_u32 m0, s64, 0
    s_nop 0
    buffer_load_dwordx4 v1, s[24:27], s65 offen offset:0 sc1 lds
    v_mfma_f32_32x32x16_bf16 v[48:63], v[160:163], a[220:223], v[48:63]
    ds_read_b128 a[240:243], v2 offset:39936
    ds_read_b128 a[244:247], v3 offset:7168
    s_waitcnt vmcnt(7) lgkmcnt(4)
    v_mfma_f32_32x32x16_bf16 v[32:47], v[164:167], a[224:227], v[32:47]
    buffer_load_dwordx4 v1, s[24:27], s65 offen offset:1024 sc1 lds
    v_mfma_f32_32x32x16_bf16 v[48:63], v[164:167], a[228:231], v[48:63]
    v_max3_u32 v126, v126, v160, v164
    ds_read_b128 a[216:219], v2 offset:43008
    ds_read_b128 a[220:223], v3 offset:10240
    s_waitcnt vmcnt(7) lgkmcnt(4)
    v_mfma_f32_32x32x16_bf16 v[32:47], v[168:171], a[232:235], v[32:47]
    buffer_load_dwordx4 v1, s[24:27], s65 offen offset:2048 sc1 lds
    v_mfma_f32_32x32x16_bf16 v[48:63], v[168:171], a[236:239], v[48:63]
    ds_read_b128 a[224:227], v2 offset:44032
    ds_read_b128 a[228:231], v3 offset:11264
    s_waitcnt vmcnt(7) lgkmcnt(4)
    v_mfma_f32_32x32x16_bf16 v[32:47], v[172:175], a[240:243], v[32:47]
    buffer_load_dwordx4 v1, s[24:27], s65 offen offset:3072 sc1 lds
    v_mfma_f32_32x32x16_bf16 v[48:63], v[172:175], a[244:247], v[48:63]
    v_max3_u32 v126, v126, v168, v172
    ds_read_b128 a[232:235], v2 offset:47104
    ds_read_b128 a[236:239], v3 offset:14336
    s_waitcnt vmcnt(7) lgkmcnt(4)
    v_mfma_f32_32x32x16_bf16 v[32:47], v[176:179], a[216:219], v[32:47]
    s_add_u32 s65, s65, 4096
    s_add_u32 m0, s64, 4096
    s_nop 0
    buffer_load_dwordx4 v1, s[24:27], s65 offen offset:0 sc1 lds
    v_mfma_f32_32x32x16_bf16 v[48:63], v[176:179], a[220:223], v[48:63]
    ds_read_b128 a[240:243], v2 offset:48128
    ds_read_b128 a[244:247], v3 offset:15360
    s_waitcnt vmcnt(7) lgkmcnt(4)
    v_mfma_f32_32x32x16_bf16 v[32:47], v[180:183], a[224:227], v[32:47]
    buffer_load_dwordx4 v1, s[24:27], s65 offen offset:1024 sc1 lds
    v_mfma_f32_32x32x16_bf16 v[48:63], v[180:183], a[228:231], v[48:63]
    v_max3_u32 v126, v126, v176, v180
    s_waitcnt vmcnt(7) lgkmcnt(2)
    v_mfma_f32_32x32x16_bf16 v[32:47], v[184:187], a[232:235], v[32:47]
    buffer_load_dwordx4 v1, s[24:27], s65 offen offset:2048 sc1 lds
    v_mfma_f32_32x32x16_bf16 v[48:63], v[184:187], a[236:239], v[48:63]
    v_bfe_u32 v4, v0, 4, 1
    v_lshl_add_u32 v4, v4, 1, v21
    v_mul_u32_u24 v4, 17, v4
    v_and_b32 v5, 15, v0
    v_add_u32 v4, v4, v5
    v_lshlrev_b32 v4, 5, v4
    v_add_u32_e64 v6, s75, v4
    s_mul_i32 s62, s3, 544
    s_add_u32 s62, s62, 45056
    v_add_u32 v127, s62, v1
    s_waitcnt vmcnt(7) lgkmcnt(0)
    v_mfma_f32_32x32x16_bf16 v[32:47], v[188:191], a[240:243], v[32:47]
    buffer_load_dwordx4 v1, s[24:27], s65 offen offset:3072 sc1 lds
    v_mfma_f32_32x32x16_bf16 v[48:63], v[188:191], a[244:247], v[48:63]
    v_max3_u32 v126, v126, v184, v188
    v_cmp_eq_u32_e64 vcc, -1, v126
    s_cbranch_vccnz VBAD_91
VOK_90:
    s_nop 6
    v_pk_fma_f32 v[32:33], v[32:33], v[64:65], s[60:61] op_sel_hi:[1,1,0]
    v_pk_fma_f32 v[34:35], v[34:35], v[66:67], s[60:61] op_sel_hi:[1,1,0]
    v_pk_fma_f32 v[36:37], v[36:37], v[68:69], s[60:61] op_sel_hi:[1,1,0]
    v_pk_fma_f32 v[38:39], v[38:39], v[70:71], s[60:61] op_sel_hi:[1,1,0]
    v_pk_fma_f32 v[40:41], v[40:41], v[72:73], s[60:61] op_sel_hi:[1,1,0]
    v_pk_fma_f32 v[42:43], v[42:43], v[74:75], s[60:61] op_sel_hi:[1,1,0]
    v_pk_fma_f32 v[44:45], v[44:45], v[76:77], s[60:61] op_sel_hi:[1,1,0]
    v_pk_fma_f32 v[46:47], v[46:47], v[78:79], s[60:61] op_sel_hi:[1,1,0]
    v_pk_mul_f32 v[96:97], v[32:33], s[74:75] op_sel_hi:[1,0]
    v_pk_mul_f32 v[98:99], v[34:35], s[74:75] op_sel_hi:[1,0]
    v_pk_mul_f32 v[100:101], v[36:37], s[74:75] op_sel_hi:[1,0]
    v_pk_mul_f32 v[102:103], v[38:39], s[74:75] op_sel_hi:[1,0]
    v_pk_mul_f32 v[104:105], v[40:41], s[74:75] op_sel_hi:[1,0]
    v_pk_mul_f32 v[106:107], v[42:43], s[74:75] op_sel_hi:[1,0]
    v_pk_mul_f32 v[108:109], v[44:45], s[74:75] op_sel_hi:[1,0]
    v_pk_mul_f32 v[110:111], v[46:47], s[74:75] op_sel_hi:[1,0]
    v_exp_f32_e64 v96, v96 clamp
    v_max_f32_e64 v32, s60, v32
    v_exp_f32_e64 v97, v97 clamp
    v_max_f32_e64 v33, s60, v33
    v_exp_f32_e64 v98, v98 clamp
    v_max_f32_e64 v34, s60, v34
    v_exp_f32_e64 v99, v99 clamp
    v_max_f32_e64 v35, s60, v35
    v_exp_f32_e64 v100, v100 clamp
    v_max_f32_e64 v36, s60, v36
    v_exp_f32_e64 v101, v101 clamp
    v_max_f32_e64 v37, s60, v37
    v_exp_f32_e64 v102, v102 clamp
    v_max_f32_e64 v38, s60, v38
    v_exp_f32_e64 v103, v103 clamp
    v_max_f32_e64 v39, s60, v39
    v_exp_f32_e64 v104, v104 clamp
    v_max_f32_e64 v40, s60, v40
    v_exp_f32_e64 v105, v105 clamp
    v_max_f32_e64 v41, s60, v41
    v_exp_f32_e64 v106, v106 clamp
    v_max_f32_e64 v42, s60, v42
    v_exp_f32_e64 v107, v107 clamp
    v_max_f32_e64 v43, s60, v43
    v_exp_f32_e64 v108, v108 clamp
    v_max_f32_e64 v44, s60, v44
    v_exp_f32_e64 v109, v109 clamp
    v_max_f32_e64 v45, s60, v45
    v_exp_f32_e64 v110, v110 clamp
    v_max_f32_e64 v46, s60, v46
    v_exp_f32_e64 v111, v111 clamp
    v_max_f32_e64 v47, s60, v47
    v_pk_add_f32 v[32:33], v[32:33], v[96:97]
    v_pk_add_f32 v[34:35], v[34:35], v[98:99]
    v_pk_add_f32 v[36:37], v[36:37], v[100:101]
    v_pk_add_f32 v[38:39], v[38:39], v[102:103]
    v_pk_add_f32 v[40:41], v[40:41], v[104:105]
    v_pk_add_f32 v[42:43], v[42:43], v[106:107]
    v_pk_add_f32 v[44:45], v[44:45], v[108:109]
    v_pk_add_f32 v[46:47], v[46:47], v[110:111]
    v_cvt_pk_bf16_f32 v88, v32, v33
    v_cvt_pk_bf16_f32 v89, v34, v35
    v_cvt_pk_bf16_f32 v90, v36, v37
    v_cvt_pk_bf16_f32 v91, v38, v39
    v_cvt_pk_bf16_f32 v92, v40, v41
    v_cvt_pk_bf16_f32 v93, v42, v43
    v_cvt_pk_bf16_f32 v94, v44, v45
    v_cvt_pk_bf16_f32 v95, v46, v47
    v_pk_mul_f32 v[48:49], v[48:49], v[64:65]
    v_pk_mul_f32 v[50:51], v[50:51], v[66:67]
    v_pk_mul_f32 v[52:53], v[52:53], v[68:69]
    v_pk_mul_f32 v[54:55], v[54:55], v[70:71]
    v_pk_mul_f32 v[56:57], v[56:57], v[72:73]
    v_pk_mul_f32 v[58:59], v[58:59], v[74:75]
    v_pk_mul_f32 v[60:61], v[60:61], v[76:77]
    v_pk_mul_f32 v[62:63], v[62:63], v[78:79]
    v_mfma_f32_32x32x16_bf16 v[96:111], v[88:91], a[248:251], 0
    v_cvt_pk_bf16_f32 v80, v48, v49
    v_cvt_pk_bf16_f32 v81, v50, v51
    v_cvt_pk_bf16_f32 v82, v52, v53
    v_cvt_pk_bf16_f32 v83, v54, v55
    v_mfma_f32_32x32x16_bf16 v[96:111], v[92:95], a[248:251], v[96:111]
    v_cvt_pk_bf16_f32 v84, v56, v57
    v_cvt_pk_bf16_f32 v85, v58, v59
    v_cvt_pk_bf16_f32 v86, v60, v61
    v_cvt_pk_bf16_f32 v87, v62, v63
    v_and_b32 v4, 16, v0
    v_cmp_ne_u32 vcc, 0, v4
    v_mfma_f32_32x32x16_bf16 v[64:79], v[88:91], v[80:83], 0
    v_mfma_f32_32x32x16_bf16 v[64:79], v[92:95], v[84:87], v[64:79]
    s_barrier
    s_nop 2
    v_cndmask_b32 v40, v96, v104, vcc
    v_cndmask_b32 v41, v97, v105, vcc
    v_cndmask_b32 v42, v98, v106, vcc
    v_cndmask_b32 v43, v99, v107, vcc
    v_cndmask_b32 v44, v100, v108, vcc
    v_cndmask_b32 v45, v101, v109, vcc
    v_cndmask_b32 v46, v102, v110, vcc
    v_cndmask_b32 v47, v103, v111, vcc
    s_mov_b32 exec_lo, 0x10001
    s_mov_b32 exec_hi, 0x10001
    ds_write_b128 v6, v[40:43] offset:12800
    ds_write_b128 v6, v[44:47] offset:12816
    s_mov_b64 exec, -1
    v_cndmask_b32 v32, v64, v72, vcc
    v_cndmask_b32 v33, v65, v73, vcc
    v_cndmask_b32 v34, v66, v74, vcc
    v_cndmask_b32_e64 v35, v67, v75, vcc
    ds_write_b128 v6, v[32:35] offset:12288
    v_cndmask_b32 v36, v68, v76, vcc
    v_cndmask_b32 v37, v69, v77, vcc
    v_cndmask_b32 v38, v70, v78, vcc
    v_cndmask_b32 v39, v71, v79, vcc
    ds_write_b128 v6, v[36:39] offset:12304
    s_waitcnt lgkmcnt(0)
    s_barrier
    ds_read_b128 v[64:67], v127 offset:0
    ds_read_b128 v[68:71], v127 offset:16384
    ds_read_b128 v[72:75], v127 offset:32768
    ds_read_b128 v[76:79], v127 offset:49152
    v_mov_b32_e64 v116, v18
    v_mov_b32 v117, v18
    s_nop 1
    v_mfma_f32_32x32x16_bf16 v[32:47], v[116:119], v[28:31], 0
    s_waitcnt lgkmcnt(0)
    v_add_f32 v64, v64, v68
    v_add_f32 v65, v65, v69
    v_add_f32 v66, v66, v70
    v_add_f32 v67, v67, v71
    v_add_f32 v72, v72, v76
    v_add_f32 v73, v73, v77
    v_add_f32 v74, v74, v78
    v_add_f32 v75, v75, v79
    v_add_f32 v64, v64, v72
    v_add_f32 v65, v65, v73
    v_add_f32 v66, v66, v74
    v_add_f32_e64 v67, v67, v75
    s_mov_b32 exec_lo, 0xffffffff
    s_mov_b32 exec_hi, 0xff
    v_writelane_b32 v64, s101, 34
    buffer_store_dwordx4 v[64:67], v1, s[24:27], s84 offen offset:0 sc1
    s_mov_b64 exec, -1
    s_waitcnt vmcnt(1)
    s_barrier
    ds_read_b128 a[216:219], v124 offset:2048
    ds_read_b128 a[220:223], v124 offset:3072
    ds_read_b128 a[224:227], v124 offset:6144
    ds_read_b128 a[228:231], v124 offset:7168
    ds_read_b128 a[232:235], v124 offset:10240
    ds_read_b128 a[236:239], v124 offset:11264
    s_waitcnt lgkmcnt(5)
    v_mfma_f32_32x32x16_bf16 v[32:47], a[216:219], v[128:131], v[32:47]
    ds_read_b128 a[240:243], v124 offset:14336
    s_waitcnt lgkmcnt(5)
    v_mfma_f32_32x32x16_bf16 v[32:47], a[220:223], v[132:135], v[32:47]
    ds_read_b128 a[244:247], v124 offset:15360
    s_waitcnt lgkmcnt(5)
    v_mfma_f32_32x32x16_bf16 v[32:47], a[224:227], v[136:139], v[32:47]
    ds_read_b128 a[216:219], v2 offset:2048
    v_mov_b32 v80, -1
    v_mov_b32_e64 v81, -1
    v_mov_b32_e64 v82, -1
    v_mov_b32 v83, -1
    s_waitcnt lgkmcnt(5)
    v_mfma_f32_32x32x16_bf16 v[32:47], a[228:231], v[140:143], v[32:47]
    ds_read_b128 a[220:223], v2 offset:3072
    v_and_b32_e64 v5, 15, v0
    v_lshlrev_b32 v5, 4, v5
    v_lshl_add_u32 v5, v21, 9, v5
    v_bfe_u32 v4, v0, 4, 1
    v_lshl_add_u32 v5, v4, 10, v5
    buffer_store_dwordx4 v[80:83], v5, s[24:27], s90 offen offset:0 sc1
    buffer_store_dwordx4 v[80:83], v5, s[24:27], s90 offen offset:2048 sc1
    s_waitcnt lgkmcnt(5)
    v_mfma_f32_32x32x16_bf16 v[32:47], a[232:235], v[144:147], v[32:47]
    ds_read_b128 a[224:227], v2 offset:6144
    s_waitcnt lgkmcnt(5)
    v_mfma_f32_32x32x16_bf16 v[32:47], a[236:239], v[148:151], v[32:47]
    ds_read_b128 a[228:231], v2 offset:7168
    s_waitcnt lgkmcnt(5)
    v_mfma_f32_32x32x16_bf16 v[32:47], a[240:243], v[152:155], v[32:47]
    ds_read_b128 a[232:235], v2 offset:10240
    buffer_store_dwordx4 v[80:83], v1, s[24:27], s92 offen offset:0 sc1
    buffer_store_dwordx4 v[80:83], v1, s[24:27], s92 offen offset:1024 sc1
    s_waitcnt lgkmcnt(5)
    v_mfma_f32_32x32x16_bf16 v[32:47], a[244:247], v[156:159], v[32:47]
    ds_read_b128 a[236:239], v2 offset:11264
    s_waitcnt lgkmcnt(5)
    v_mfma_f32_32x32x16_bf16 v[32:47], a[216:219], v[160:163], v[32:47]
    ds_read_b128 a[240:243], v2 offset:14336
    s_waitcnt lgkmcnt(5)
    v_mfma_f32_32x32x16_bf16 v[32:47], a[220:223], v[164:167], v[32:47]
    ds_read_b128 a[244:247], v2 offset:15360
    s_waitcnt lgkmcnt(5)
    v_mfma_f32_32x32x16_bf16 v[32:47], a[224:227], v[168:171], v[32:47]
    ds_read_b128 a[216:219], v124 offset:0
    s_waitcnt lgkmcnt(5)
    v_mfma_f32_32x32x16_bf16 v[32:47], a[228:231], v[172:175], v[32:47]
    ds_read_b128 a[220:223], v124 offset:1024
    s_waitcnt lgkmcnt(5)
    v_mfma_f32_32x32x16_bf16 v[32:47], a[232:235], v[176:179], v[32:47]
    ds_read_b128 a[224:227], v124 offset:4096
    s_waitcnt lgkmcnt(5)
    v_mfma_f32_32x32x16_bf16 v[32:47], a[236:239], v[180:183], v[32:47]
    ds_read_b128 a[228:231], v124 offset:5120
    s_waitcnt lgkmcnt(5)
    v_mfma_f32_32x32x16_bf16 v[32:47], a[240:243], v[184:187], v[32:47]
    ds_read_b128 a[232:235], v124 offset:8192
    s_waitcnt lgkmcnt(5)
    v_mfma_f32_32x32x16_bf16 v[32:47], a[244:247], v[188:191], v[32:47]
    ds_read_b128 a[236:239], v124 offset:9216
    s_waitcnt lgkmcnt(5)
    v_mfma_f32_32x32x16_bf16 v[32:47], a[216:219], v[192:195], v[32:47]
    ds_read_b128 a[240:243], v124 offset:12288
    s_waitcnt lgkmcnt(5)
    v_mfma_f32_32x32x16_bf16 v[32:47], a[220:223], v[196:199], v[32:47]
    ds_read_b128 a[244:247], v124 offset:13312
    s_waitcnt lgkmcnt(5)
    v_mfma_f32_32x32x16_bf16 v[32:47], a[224:227], v[200:203], v[32:47]
    ds_read_b128 a[216:219], v2 offset:0
    s_waitcnt lgkmcnt(5)
    v_mfma_f32_32x32x16_bf16 v[32:47], a[228:231], v[204:207], v[32:47]
    ds_read_b128 a[220:223], v2 offset:1024
    s_waitcnt lgkmcnt(5)
    v_mfma_f32_32x32x16_bf16 v[32:47], a[232:235], v[208:211], v[32:47]
    ds_read_b128 a[224:227], v2 offset:4096
    s_waitcnt lgkmcnt(5)
    v_mfma_f32_32x32x16_bf16 v[32:47], a[236:239], v[212:215], v[32:47]
    ds_read_b128 a[228:231], v2 offset:5120
    s_waitcnt lgkmcnt(5)
    v_mfma_f32_32x32x16_bf16 v[32:47], a[240:243], v[216:219], v[32:47]
    ds_read_b128 a[232:235], v2 offset:8192
    s_waitcnt lgkmcnt(5)
    v_mfma_f32_32x32x16_bf16 v[32:47], a[244:247], v[220:223], v[32:47]
    ds_read_b128 a[236:239], v2 offset:9216
    s_waitcnt lgkmcnt(5)
    v_mfma_f32_32x32x16_bf16 v[32:47], a[216:219], v[224:227], v[32:47]
    ds_read_b128 a[240:243], v2 offset:12288
    s_waitcnt lgkmcnt(5)
    v_mfma_f32_32x32x16_bf16 v[32:47], a[220:223], v[228:231], v[32:47]
    ds_read_b128 a[244:247], v2 offset:13312
    s_waitcnt lgkmcnt(5)
    v_mfma_f32_32x32x16_bf16 v[32:47], a[224:227], v[232:235], v[32:47]
    s_waitcnt lgkmcnt(4)
    v_mfma_f32_32x32x16_bf16 v[32:47], a[228:231], v[236:239], v[32:47]
    s_waitcnt lgkmcnt(3)
    v_mfma_f32_32x32x16_bf16 v[32:47], a[232:235], v[240:243], v[32:47]
    s_waitcnt lgkmcnt(2)
    v_mfma_f32_32x32x16_bf16 v[32:47], a[236:239], v[244:247], v[32:47]
    s_waitcnt lgkmcnt(1)
    v_mfma_f32_32x32x16_bf16 v[32:47], a[240:243], v[248:251], v[32:47]
    s_waitcnt lgkmcnt(0)
    v_mfma_f32_32x32x16_bf16 v[32:47], a[244:247], v[252:255], v[32:47]
    s_cmp_lt_u32 s79, 64
    s_cbranch_scc1 RED_93
NOA1E_92:
    s_nop 9
    v_pk_fma_f32 v[32:33], v[32:33], v[20:21], s[60:61] op_sel_hi:[1,0,0]
    v_pk_fma_f32 v[34:35], v[34:35], v[20:21], s[60:61] op_sel_hi:[1,0,0]
    v_pk_fma_f32 v[36:37], v[36:37], v[20:21], s[60:61] op_sel_hi:[1,0,0]
    v_pk_fma_f32 v[38:39], v[38:39], v[20:21], s[60:61] op_sel_hi:[1,0,0]
    v_pk_mul_f32 v[96:97], v[32:33], s[74:75] op_sel_hi:[1,0]
    v_pk_mul_f32 v[98:99], v[34:35], s[74:75] op_sel_hi:[1,0]
    v_pk_mul_f32 v[100:101], v[36:37], s[74:75] op_sel_hi:[1,0]
    v_pk_mul_f32 v[102:103], v[38:39], s[74:75] op_sel_hi:[1,0]
    v_exp_f32_e64 v96, v96 clamp
    v_max_f32_e64 v32, s60, v32
    v_exp_f32_e64 v97, v97 clamp
    v_max_f32 v33, s60, v33
    v_exp_f32_e64 v98, v98 clamp
    v_max_f32 v34, s60, v34
    v_exp_f32_e64 v99, v99 clamp
    v_max_f32 v35, s60, v35
    v_exp_f32_e64 v100, v100 clamp
    v_max_f32 v36, s60, v36
    v_exp_f32_e64 v101, v101 clamp
    v_max_f32_e64 v37, s60, v37
    v_exp_f32_e64 v102, v102 clamp
    v_max_f32_e64 v38, s60, v38
    v_exp_f32_e64 v103, v103 clamp
    v_max_f32_e64 v39, s60, v39
    v_pk_add_f32 v[32:33], v[32:33], v[96:97]
    v_pk_add_f32 v[34:35], v[34:35], v[98:99]
    v_pk_add_f32 v[36:37], v[36:37], v[100:101]
    v_pk_add_f32 v[38:39], v[38:39], v[102:103]
    v_cvt_pk_bf16_f32 v88, v32, v33
    v_cvt_pk_bf16_f32 v89, v34, v35
    v_cvt_pk_bf16_f32 v90, v36, v37
    v_cvt_pk_bf16_f32 v91, v38, v39
    buffer_store_dwordx4 v[88:91], v1, s[24:27], s85 offen offset:0 sc1
    v_pk_fma_f32 v[40:41], v[40:41], v[20:21], s[60:61] op_sel_hi:[1,0,0]
    v_pk_fma_f32 v[42:43], v[42:43], v[20:21], s[60:61] op_sel_hi:[1,0,0]
    v_pk_fma_f32 v[44:45], v[44:45], v[20:21], s[60:61] op_sel_hi:[1,0,0]
    v_pk_fma_f32 v[46:47], v[46:47], v[20:21], s[60:61] op_sel_hi:[1,0,0]
    v_pk_mul_f32 v[104:105], v[40:41], s[74:75] op_sel_hi:[1,0]
    v_pk_mul_f32 v[106:107], v[42:43], s[74:75] op_sel_hi:[1,0]
    v_pk_mul_f32 v[108:109], v[44:45], s[74:75] op_sel_hi:[1,0]
    v_pk_mul_f32 v[110:111], v[46:47], s[74:75] op_sel_hi:[1,0]
    v_exp_f32_e64 v104, v104 clamp
    v_max_f32_e64 v40, s60, v40
    v_exp_f32_e64 v105, v105 clamp
    v_max_f32_e64 v41, s60, v41
    v_exp_f32_e64 v106, v106 clamp
    v_max_f32_e64 v42, s60, v42
    v_exp_f32_e64 v107, v107 clamp
    v_max_f32_e64 v43, s60, v43
    v_exp_f32_e64 v108, v108 clamp
    v_max_f32_e64 v44, s60, v44
    v_exp_f32_e64 v109, v109 clamp
    v_max_f32_e64 v45, s60, v45
    v_exp_f32_e64 v110, v110 clamp
    v_max_f32_e64 v46, s60, v46
    v_exp_f32_e64 v111, v111 clamp
    v_max_f32_e64 v47, s60, v47
    v_pk_add_f32 v[40:41], v[40:41], v[104:105]
    v_pk_add_f32 v[42:43], v[42:43], v[106:107]
    v_pk_add_f32 v[44:45], v[44:45], v[108:109]
    v_pk_add_f32 v[46:47], v[46:47], v[110:111]
    v_cvt_pk_bf16_f32 v92, v40, v41
    v_cvt_pk_bf16_f32 v93, v42, v43
    v_cvt_pk_bf16_f32 v94, v44, v45
    v_cvt_pk_bf16_f32 v95, v46, v47
    buffer_store_dwordx4 v[92:95], v1, s[24:27], s85 offen offset:1024 sc1
    s_cmp_lt_u32 s79, 64
    s_cbranch_scc1 RED_95
NOA1_94:
    s_add_u32 m0, s75, 0
    s_nop 0
    buffer_load_dwordx4 v24, s[16:19], s80 offen lds
    buffer_load_dwordx4 v25, s[16:19], s80 offen offset:1024 lds
    s_add_u32 m0, s75, 2048
    s_add_u32 s80, s80, 57344
    s_cmp_eq_u32 s80, 1835008
    s_cselect_b32 s80, 0, s80
    buffer_load_dwordx4 v24, s[16:19], s80 offen lds
    buffer_load_dwordx4 v25, s[16:19], s80 offen offset:1024 lds
    s_add_u32 m0, s75, 4096
    s_add_u32 s80, s80, 57344
    s_cmp_eq_u32 s80, 1835008
    s_cselect_b32 s80, 0, s80
    buffer_load_dwordx4 v24, s[16:19], s80 offen lds
    buffer_load_dwordx4 v25, s[16:19], s80 offen offset:1024 lds
    s_add_u32 m0, s75, 6144
    s_add_u32 s80, s80, 57344
    s_cmp_eq_u32 s80, 1835008
    s_cselect_b32 s80, 0, s80
    buffer_load_dwordx4 v24, s[16:19], s80 offen lds
    buffer_load_dwordx4 v25, s[16:19], s80 offen offset:1024 lds
    s_add_u32 m0, s75, 8192
    s_add_u32 s80, s80, 57344
    s_cmp_eq_u32 s80, 1835008
    s_cselect_b32 s80, 0, s80
    buffer_load_dwordx4 v24, s[16:19], s80 offen lds
    buffer_load_dwordx4 v25, s[16:19], s80 offen offset:1024 lds
    v_bfe_u32 v4, v0, 2, 2
    v_lshl_add_u32 v4, v21, 2, v4
    v_lshlrev_b32_e64 v2, 7, v4
    v_bfe_u32 v5, v0, 3, 1
    v_lshl_add_u32 v2, v5, 6, v2
    v_bfe_u32 v5, v0, 4, 1
    v_lshl_add_u32 v2, v5, 5, v2
    v_and_b32_e64 v5, 3, v0
    v_lshl_add_u32 v2, v5, 3, v2
    s_lshl_b32 s67, s56, 5
    v_xor_b32 v2, s67, v2
    v_add_u32 v2, 98304, v2
    v_xor_b32 v3, 64, v2
    s_lshl_b32 s64, s56, 15
    v_add_u32 v2, s64, v2
    v_add_u32 v3, s64, v3
    v_and_b32_e64 v4, 31, v0
    v_mul_u32_u24 v29, 384, v4
    v_min_u32 v4, 16, v4
    v_lshlrev_b32 v4, 4, v4
    v_mul_u32_u24 v5, 384, v21
    v_add_u32 v28, v4, v5
    v_and_b32 v6, 7, v0
    v_lshlrev_b32 v6, 11, v6
    s_waitcnt vmcnt(8)
    ds_read_b64_tr_b16 a[216:217], v26 offset:0
    ds_read_b64_tr_b16 a[218:219], v26 offset:1024
    ds_read_b64_tr_b16 a[220:221], v27 offset:0
    ds_read_b64_tr_b16 a[222:223], v27 offset:1024
    s_add_u32 m0, s75, 10240
    s_add_u32 s80, s80, 57344
    s_cmp_eq_u32 s80, 1835008
    s_cselect_b32 s80, 0, s80
    buffer_load_dwordx4 v24, s[16:19], s80 offen lds
    buffer_load_dwordx4 v25, s[16:19], s80 offen offset:1024 lds
    s_waitcnt vmcnt(8)
    ds_read_b64_tr_b16 a[224:225], v26 offset:2048
    ds_read_b64_tr_b16 a[226:227], v26 offset:3072
    ds_read_b64_tr_b16 a[228:229], v27 offset:2048
    ds_read_b64_tr_b16 a[230:231], v27 offset:3072
    s_waitcnt lgkmcnt(4)
    s_add_u32 m0, s75, 0
    s_add_u32 s80, s80, 57344
    s_cmp_eq_u32 s80, 1835008
    s_cselect_b32 s80, 0, s80
    buffer_load_dwordx4 v24, s[16:19], s80 offen lds
    buffer_load_dwordx4 v25, s[16:19], s80 offen offset:1024 lds
    s_waitcnt vmcnt(8)
    ds_read_b64_tr_b16 a[232:233], v26 offset:4096
    ds_read_b64_tr_b16 a[234:235], v26 offset:5120
    ds_read_b64_tr_b16 a[236:237], v27 offset:4096
    ds_read_b64_tr_b16 a[238:239], v27 offset:5120
    s_waitcnt lgkmcnt(4)
    s_add_u32 m0, s75, 2048
    s_add_u32 s80, s80, 57344
    s_cmp_eq_u32 s80, 1835008
    s_cselect_b32 s80, 0, s80
    buffer_load_dwordx4 v24, s[16:19], s80 offen lds
    buffer_load_dwordx4 v25, s[16:19], s80 offen offset:1024 lds
    s_waitcnt vmcnt(8)
    ds_read_b64_tr_b16 a[240:241], v26 offset:6144
    ds_read_b64_tr_b16 a[242:243], v26 offset:7168
    ds_read_b64_tr_b16 a[244:245], v27 offset:6144
    ds_read_b64_tr_b16 a[246:247], v27 offset:7168
    s_waitcnt lgkmcnt(4)
    s_add_u32 m0, s75, 4096
    s_add_u32 s80, s80, 57344
    s_cmp_eq_u32 s80, 1835008
    s_cselect_b32 s80, 0, s80
    buffer_load_dwordx4 v24, s[16:19], s80 offen lds
    buffer_load_dwordx4 v25, s[16:19], s80 offen offset:1024 lds
    s_waitcnt vmcnt(8)
    ds_read_b64_tr_b16 a[248:249], v26 offset:8192
    ds_read_b64_tr_b16 a[250:251], v26 offset:9216
    ds_read_b64_tr_b16 a[252:253], v27 offset:8192
    ds_read_b64_tr_b16 a[254:255], v27 offset:9216
    s_waitcnt lgkmcnt(4)
    s_add_u32 m0, s75, 6144
    s_add_u32 s80, s80, 57344
    s_cmp_eq_u32 s80, 1835008
    s_cselect_b32 s80, 0, s80
    buffer_load_dwordx4 v24, s[16:19], s80 offen lds
    buffer_load_dwordx4 v25, s[16:19], s80 offen offset:1024 lds
    s_waitcnt lgkmcnt(0)
    s_add_u32 m0, s75, 8192
    s_add_u32 s80, s80, 57344
    s_cmp_eq_u32 s80, 1835008
    s_cselect_b32 s80, 0, s80
    buffer_load_dwordx4 v24, s[16:19], s80 offen lds
    buffer_load_dwordx4 v25, s[16:19], s80 offen offset:1024 lds
    buffer_load_dword v7, v6, s[24:27], s86 offen offset:2044 sc1
    s_waitcnt vmcnt(0)
    v_cmp_eq_u32 vcc, -1, v7
    s_cbranch_vccnz PRT_103
PDONE_102:
    s_mov_b32 s66, s86
    buffer_load_dwordx4 v[192:195], v1, s[24:27], s66 offen offset:0 sc1
    buffer_load_dwordx4 v[196:199], v1, s[24:27], s66 offen offset:1024 sc1
    buffer_load_dwordx4 v[200:203], v1, s[24:27], s66 offen offset:2048 sc1
    buffer_load_dwordx4 v[204:207], v1, s[24:27], s66 offen offset:3072 sc1
    s_add_u32 s66, s66, 4096
    buffer_load_dwordx4 v[208:211], v1, s[24:27], s66 offen offset:0 sc1
    buffer_load_dwordx4 v[212:215], v1, s[24:27], s66 offen offset:1024 sc1
    buffer_load_dwordx4 v[216:219], v1, s[24:27], s66 offen offset:2048 sc1
    buffer_load_dwordx4 v[220:223], v1, s[24:27], s66 offen offset:3072 sc1
    s_add_u32 s66, s66, 4096
    buffer_load_dwordx4 v[224:227], v1, s[24:27], s66 offen offset:0 sc1
    buffer_load_dwordx4 v[228:231], v1, s[24:27], s66 offen offset:1024 sc1
    buffer_load_dwordx4 v[232:235], v1, s[24:27], s66 offen offset:2048 sc1
    buffer_load_dwordx4 v[236:239], v1, s[24:27], s66 offen offset:3072 sc1
    s_add_u32 s66, s66, 4096
    buffer_load_dwordx4 v[240:243], v1, s[24:27], s66 offen offset:0 sc1
    buffer_load_dwordx4 v[244:247], v1, s[24:27], s66 offen offset:1024 sc1
    buffer_load_dwordx4 v[248:251], v1, s[24:27], s66 offen offset:2048 sc1
    buffer_load_dwordx4 v[252:255], v1, s[24:27], s66 offen offset:3072 sc1
GO_101:
    s_xor_b32 s62, s3, 1
    s_lshl_b32 s62, s62, 12
    v_add_u32_e64 v20, s62, v1
    s_barrier
    buffer_load_dword v7, v29, s[24:27], s87 offen offset:272 sc1
    s_mov_b32 s68, s87
    buffer_load_dwordx4 v[128:131], v28, s[24:27], s68 offen offset:0 sc1
    buffer_load_dwordx4 v[132:135], v28, s[24:27], s68 offen offset:768 sc1
    buffer_load_dwordx4 v[136:139], v28, s[24:27], s68 offen offset:1536 sc1
    buffer_load_dwordx4 v[140:143], v28, s[24:27], s68 offen offset:2304 sc1
    s_add_u32 s68, s68, 3072
    buffer_load_dwordx4 v[144:147], v28, s[24:27], s68 offen offset:0 sc1
    buffer_load_dwordx4 v[148:151], v28, s[24:27], s68 offen offset:768 sc1
    buffer_load_dwordx4 v[152:155], v28, s[24:27], s68 offen offset:1536 sc1
    buffer_load_dwordx4 v[156:159], v28, s[24:27], s68 offen offset:2304 sc1
    s_add_u32 s68, s68, 3072
    buffer_load_dwordx4 v[160:163], v28, s[24:27], s68 offen offset:0 sc1
    buffer_load_dwordx4 v[164:167], v28, s[24:27], s68 offen offset:768 sc1
    s_waitcnt vmcnt(10)
    v_cmp_ne_u32_e64 vcc, s101, v7
    s_cbranch_vccnz FB_109
FBB_110:
GO_108:
    ds_read_b64_tr_b16 v[104:105], v2 offset:0
    ds_read_b64_tr_b16 v[106:107], v2 offset:1024
    ds_read_b64_tr_b16 v[108:109], v3 offset:0
    ds_read_b64_tr_b16 v[110:111], v3 offset:1024
    ds_read_b64_tr_b16 v[112:113], v2 offset:2048
    ds_read_b64_tr_b16 v[114:115], v2 offset:3072
    ds_read_b64_tr_b16 v[116:117], v3 offset:2048
    ds_read_b64_tr_b16 v[118:119], v3 offset:3072
    v_mov_b32 v30, 0
    s_waitcnt vmcnt(9)
    v_mfma_f32_32x32x16_bf16 v[64:79], v[128:131], v[192:195], 0
    v_max3_u32 v30, v30, v128, v192
    buffer_load_dwordx4 v[168:171], v28, s[24:27], s68 offen offset:1536 sc1
    s_waitcnt vmcnt(9)
    v_mfma_f32_32x32x16_bf16 v[80:95], v[132:135], v[196:199], 0
    v_max3_u32 v30, v30, v132, v196
    buffer_load_dwordx4 v[172:175], v28, s[24:27], s68 offen offset:2304 sc1
    s_nop 5
    v_add_f32 v72, s60, v72
    v_rcp_f32 v72, v72
    s_nop 0
    v_mul_f32 v64, v64, v72
    v_mul_f32 v65, v65, v72
    v_mul_f32 v66, v66, v72
    v_mul_f32_e64 v67, v67, v72
    v_cvt_pk_bf16_f32 v96, v64, v65
    v_cvt_pk_bf16_f32 v97, v66, v67
    v_mul_f32 v68, v68, v72
    v_mul_f32 v69, v69, v72
    v_mul_f32_e64 v70, v70, v72
    v_mul_f32 v71, v71, v72
    v_cvt_pk_bf16_f32 v98, v68, v69
    v_cvt_pk_bf16_f32 v99, v70, v71
    s_waitcnt vmcnt(9)
    v_mfma_f32_32x32x16_bf16 v[64:79], v[136:139], v[200:203], 0
    v_max3_u32 v30, v30, v136, v200
    s_add_u32 s68, s68, 3072
    buffer_load_dwordx4 v[176:179], v28, s[24:27], s68 offen offset:0 sc1
    v_add_f32_e64 v88, s60, v88
    v_rcp_f32 v88, v88
    s_waitcnt lgkmcnt(4)
    v_mfma_f32_32x32x16_bf16 v[48:63], v[108:111], v[96:99], 0
    v_mul_f32 v80, v80, v88
    v_mul_f32 v81, v81, v88
    v_mul_f32 v82, v82, v88
    v_mul_f32 v83, v83, v88
    v_cvt_pk_bf16_f32 v100, v80, v81
    v_cvt_pk_bf16_f32 v101, v82, v83
    v_mfma_f32_32x32x16_bf16 v[32:47], v[104:107], v[96:99], 0
    v_mul_f32 v84, v84, v88
    v_mul_f32 v85, v85, v88
    v_mul_f32_e64 v86, v86, v88
    v_mul_f32 v87, v87, v88
    v_cvt_pk_bf16_f32 v102, v84, v85
    v_cvt_pk_bf16_f32 v103, v86, v87
    s_waitcnt vmcnt(9)
    v_mfma_f32_32x32x16_bf16 v[80:95], v[140:143], v[204:207], 0
    v_max3_u32 v30, v30, v140, v204
    buffer_load_dwordx4 v[180:183], v28, s[24:27], s68 offen offset:768 sc1
    ds_read_b64_tr_b16 v[120:121], v2 offset:4096
    ds_read_b64_tr_b16 v[122:123], v2 offset:5120
    ds_read_b64_tr_b16 v[124:125], v3 offset:4096
    ds_read_b64_tr_b16 v[126:127], v3 offset:5120
    v_add_f32_e64 v72, s60, v72
    v_rcp_f32 v72, v72
    s_waitcnt lgkmcnt(4)
    v_mfma_f32_32x32x16_bf16 v[48:63], v[116:119], v[100:103], v[48:63]
    v_mul_f32 v64, v64, v72
    v_mul_f32 v65, v65, v72
    v_mul_f32 v66, v66, v72
    v_mul_f32 v67, v67, v72
    v_cvt_pk_bf16_f32 v96, v64, v65
    v_cvt_pk_bf16_f32 v97, v66, v67
    v_mfma_f32_32x32x16_bf16 v[32:47], v[112:115], v[100:103], v[32:47]
    v_mul_f32 v68, v68, v72
    v_mul_f32 v69, v69, v72
    v_mul_f32_e64 v70, v70, v72
    v_mul_f32 v71, v71, v72
    v_cvt_pk_bf16_f32 v98, v68, v69
    v_cvt_pk_bf16_f32 v99, v70, v71
    s_waitcnt vmcnt(9)
    v_mfma_f32_32x32x16_bf16 v[64:79], v[144:147], v[208:211], 0
    v_max3_u32 v30, v30, v144, v208
    buffer_load_dwordx4 v[184:187], v28, s[24:27], s68 offen offset:1536 sc1
    ds_read_b64_tr_b16 v[104:105], v2 offset:6144
    ds_read_b64_tr_b16 v[106:107], v2 offset:7168
    ds_read_b64_tr_b16 v[108:109], v3 offset:6144
    ds_read_b64_tr_b16 v[110:111], v3 offset:7168
    v_add_f32_e64 v88, s60, v88
    v_rcp_f32 v88, v88
    s_waitcnt lgkmcnt(4)
    v_mfma_f32_32x32x16_bf16 v[48:63], v[124:127], v[96:99], v[48:63]
    v_mul_f32 v80, v80, v88
    v_mul_f32 v81, v81, v88
    v_mul_f32 v82, v82, v88
    v_mul_f32 v83, v83, v88
    v_cvt_pk_bf16_f32 v100, v80, v81
    v_cvt_pk_bf16_f32 v101, v82, v83
    v_mfma_f32_32x32x16_bf16 v[32:47], v[120:123], v[96:99], v[32:47]
    v_mul_f32 v84, v84, v88
    v_mul_f32 v85, v85, v88
    v_mul_f32_e64 v86, v86, v88
    v_mul_f32 v87, v87, v88
    v_cvt_pk_bf16_f32 v102, v84, v85
    v_cvt_pk_bf16_f32 v103, v86, v87
    s_waitcnt vmcnt(9)
    v_mfma_f32_32x32x16_bf16 v[80:95], v[148:151], v[212:215], 0
    v_max3_u32 v30, v30, v148, v212
    buffer_load_dwordx4 v[188:191], v28, s[24:27], s68 offen offset:2304 sc1
    ds_read_b64_tr_b16 v[112:113], v2 offset:8192
    ds_read_b64_tr_b16 v[114:115], v2 offset:9216
    ds_read_b64_tr_b16 v[116:117], v3 offset:8192
    ds_read_b64_tr_b16 v[118:119], v3 offset:9216
    v_add_f32_e64 v72, s60, v72
    v_rcp_f32 v72, v72
    s_waitcnt lgkmcnt(4)
    v_mfma_f32_32x32x16_bf16 v[48:63], v[108:111], v[100:103], v[48:63]
    v_mul_f32 v64, v64, v72
    v_mul_f32 v65, v65, v72
    v_mul_f32 v66, v66, v72
    v_mul_f32 v67, v67, v72
    v_cvt_pk_bf16_f32 v96, v64, v65
    v_cvt_pk_bf16_f32 v97, v66, v67
    v_mfma_f32_32x32x16_bf16 v[32:47], v[104:107], v[100:103], v[32:47]
    v_mul_f32 v68, v68, v72
    v_mul_f32 v69, v69, v72
    v_mul_f32_e64 v70, v70, v72
    v_mul_f32 v71, v71, v72
    v_cvt_pk_bf16_f32 v98, v68, v69
    v_cvt_pk_bf16_f32 v99, v70, v71
    s_waitcnt vmcnt(9)
    v_mfma_f32_32x32x16_bf16 v[64:79], v[152:155], v[216:219], 0
    v_max3_u32 v30, v30, v152, v216
    ds_read_b64_tr_b16 v[120:121], v2 offset:10240
    ds_read_b64_tr_b16 v[122:123], v2 offset:11264
    ds_read_b64_tr_b16 v[124:125], v3 offset:10240
    ds_read_b64_tr_b16 v[126:127], v3 offset:11264
    v_add_f32_e64 v88, s60, v88
    v_rcp_f32 v88, v88
    s_waitcnt lgkmcnt(4)
    v_mfma_f32_32x32x16_bf16 v[48:63], v[116:119], v[96:99], v[48:63]
    v_mul_f32 v80, v80, v88
    v_mul_f32 v81, v81, v88
    v_mul_f32 v82, v82, v88
    v_mul_f32 v83, v83, v88
    v_cvt_pk_bf16_f32 v100, v80, v81
    v_cvt_pk_bf16_f32 v101, v82, v83
    v_mfma_f32_32x32x16_bf16 v[32:47], v[112:115], v[96:99], v[32:47]
    v_mul_f32 v84, v84, v88
    v_mul_f32 v85, v85, v88
    v_mul_f32_e64 v86, v86, v88
    v_mul_f32 v87, v87, v88
    v_cvt_pk_bf16_f32 v102, v84, v85
    v_cvt_pk_bf16_f32 v103, v86, v87
    s_waitcnt vmcnt(8)
    v_mfma_f32_32x32x16_bf16 v[80:95], v[156:159], v[220:223], 0
    v_max3_u32 v30, v30, v156, v220
    ds_read_b64_tr_b16 v[104:105], v2 offset:12288
    ds_read_b64_tr_b16 v[106:107], v2 offset:13312
    ds_read_b64_tr_b16 v[108:109], v3 offset:12288
    ds_read_b64_tr_b16 v[110:111], v3 offset:13312
    v_add_f32_e64 v72, s60, v72
    v_rcp_f32 v72, v72
    s_waitcnt lgkmcnt(4)
    v_mfma_f32_32x32x16_bf16 v[48:63], v[124:127], v[100:103], v[48:63]
    v_mul_f32 v64, v64, v72
    v_mul_f32 v65, v65, v72
    v_mul_f32 v66, v66, v72
    v_mul_f32 v67, v67, v72
    v_cvt_pk_bf16_f32 v96, v64, v65
    v_cvt_pk_bf16_f32 v97, v66, v67
    v_mfma_f32_32x32x16_bf16 v[32:47], v[120:123], v[100:103], v[32:47]
    v_mul_f32_e64 v68, v68, v72
    v_mul_f32_e64 v69, v69, v72
    v_mul_f32_e64 v70, v70, v72
    v_mul_f32 v71, v71, v72
    v_cvt_pk_bf16_f32 v98, v68, v69
    v_cvt_pk_bf16_f32 v99, v70, v71
    s_waitcnt vmcnt(7)
    v_mfma_f32_32x32x16_bf16 v[64:79], v[160:163], v[224:227], 0
    v_max3_u32 v30, v30, v160, v224
    ds_read_b64_tr_b16 v[112:113], v2 offset:14336
    ds_read_b64_tr_b16 v[114:115], v2 offset:15360
    ds_read_b64_tr_b16 v[116:117], v3 offset:14336
    ds_read_b64_tr_b16 v[118:119], v3 offset:15360
    v_add_f32_e64 v88, s60, v88
    v_rcp_f32 v88, v88
    s_waitcnt lgkmcnt(4)
    v_mfma_f32_32x32x16_bf16 v[48:63], v[108:111], v[96:99], v[48:63]
    v_mul_f32 v80, v80, v88
    v_mul_f32 v81, v81, v88
    v_mul_f32 v82, v82, v88
    v_mul_f32 v83, v83, v88
    v_cvt_pk_bf16_f32 v100, v80, v81
    v_cvt_pk_bf16_f32 v101, v82, v83
    v_mfma_f32_32x32x16_bf16 v[32:47], v[104:107], v[96:99], v[32:47]
    v_mul_f32_e64 v84, v84, v88
    v_mul_f32_e64 v85, v85, v88
    v_mul_f32_e64 v86, v86, v88
    v_mul_f32 v87, v87, v88
    v_cvt_pk_bf16_f32 v102, v84, v85
    v_cvt_pk_bf16_f32 v103, v86, v87
    s_waitcnt vmcnt(6)
    v_mfma_f32_32x32x16_bf16 v[80:95], v[164:167], v[228:231], 0
    v_max3_u32 v30, v30, v164, v228
    ds_read_b64_tr_b16 v[120:121], v2 offset:16384
    ds_read_b64_tr_b16 v[122:123], v2 offset:17408
    ds_read_b64_tr_b16 v[124:125], v3 offset:16384
    ds_read_b64_tr_b16 v[126:127], v3 offset:17408
    v_add_f32_e64 v72, s60, v72
    v_rcp_f32 v72, v72
    s_waitcnt lgkmcnt(4)
    v_mfma_f32_32x32x16_bf16 v[48:63], v[116:119], v[100:103], v[48:63]
    v_mul_f32 v64, v64, v72
    v_mul_f32 v65, v65, v72
    v_mul_f32 v66, v66, v72
    v_mul_f32 v67, v67, v72
    v_cvt_pk_bf16_f32 v96, v64, v65
    v_cvt_pk_bf16_f32 v97, v66, v67
    v_mfma_f32_32x32x16_bf16 v[32:47], v[112:115], v[100:103], v[32:47]
    v_mul_f32_e64 v68, v68, v72
    v_mul_f32_e64 v69, v69, v72
    v_mul_f32_e64 v70, v70, v72
    v_mul_f32 v71, v71, v72
    v_cvt_pk_bf16_f32 v98, v68, v69
    v_cvt_pk_bf16_f32 v99, v70, v71
    s_waitcnt vmcnt(5)
    v_mfma_f32_32x32x16_bf16 v[64:79], v[168:171], v[232:235], 0
    v_max3_u32 v30, v30, v168, v232
    ds_read_b64_tr_b16 v[104:105], v2 offset:18432
    ds_read_b64_tr_b16 v[106:107], v2 offset:19456
    ds_read_b64_tr_b16 v[108:109], v3 offset:18432
    ds_read_b64_tr_b16 v[110:111], v3 offset:19456
    v_add_f32_e64 v88, s60, v88
    v_rcp_f32 v88, v88
    s_waitcnt lgkmcnt(4)
    v_mfma_f32_32x32x16_bf16 v[48:63], v[124:127], v[96:99], v[48:63]
    v_mul_f32 v80, v80, v88
    v_mul_f32 v81, v81, v88
    v_mul_f32 v82, v82, v88
    v_mul_f32 v83, v83, v88
    v_cvt_pk_bf16_f32 v100, v80, v81
    v_cvt_pk_bf16_f32 v101, v82, v83
    v_mfma_f32_32x32x16_bf16 v[32:47], v[120:123], v[96:99], v[32:47]
    v_mul_f32_e64 v84, v84, v88
    v_mul_f32_e64 v85, v85, v88
    v_mul_f32_e64 v86, v86, v88
    v_mul_f32 v87, v87, v88
    v_cvt_pk_bf16_f32 v102, v84, v85
    v_cvt_pk_bf16_f32 v103, v86, v87
    s_waitcnt vmcnt(4)
    v_mfma_f32_32x32x16_bf16 v[80:95], v[172:175], v[236:239], 0
    v_max3_u32 v30, v30, v172, v236
    ds_read_b64_tr_b16 v[112:113], v2 offset:20480
    ds_read_b64_tr_b16 v[114:115], v2 offset:21504
    ds_read_b64_tr_b16 v[116:117], v3 offset:20480
    ds_read_b64_tr_b16 v[118:119], v3 offset:21504
    v_add_f32_e64 v72, s60, v72
    v_rcp_f32 v72, v72
    s_waitcnt lgkmcnt(4)
    v_mfma_f32_32x32x16_bf16 v[48:63], v[108:111], v[100:103], v[48:63]
    v_mul_f32 v64, v64, v72
    v_mul_f32 v65, v65, v72
    v_mul_f32 v66, v66, v72
    v_mul_f32 v67, v67, v72
    v_cvt_pk_bf16_f32 v96, v64, v65
    v_cvt_pk_bf16_f32 v97, v66, v67
    v_mfma_f32_32x32x16_bf16 v[32:47], v[104:107], v[100:103], v[32:47]
    v_mul_f32_e64 v68, v68, v72
    v_mul_f32_e64 v69, v69, v72
    v_mul_f32_e64 v70, v70, v72
    v_mul_f32 v71, v71, v72
    v_cvt_pk_bf16_f32 v98, v68, v69
    v_cvt_pk_bf16_f32 v99, v70, v71
    s_waitcnt vmcnt(3)
    v_mfma_f32_32x32x16_bf16 v[64:79], v[176:179], v[240:243], 0
    v_max3_u32 v30, v30, v176, v240
    ds_read_b64_tr_b16 v[120:121], v2 offset:22528
    ds_read_b64_tr_b16 v[122:123], v2 offset:23552
    ds_read_b64_tr_b16 v[124:125], v3 offset:22528
    ds_read_b64_tr_b16 v[126:127], v3 offset:23552
    v_add_f32_e64 v88, s60, v88
    v_rcp_f32 v88, v88
    s_waitcnt lgkmcnt(4)
    v_mfma_f32_32x32x16_bf16 v[48:63], v[116:119], v[96:99], v[48:63]
    v_mul_f32 v80, v80, v88
    v_mul_f32 v81, v81, v88
    v_mul_f32 v82, v82, v88
    v_mul_f32 v83, v83, v88
    v_cvt_pk_bf16_f32 v100, v80, v81
    v_cvt_pk_bf16_f32 v101, v82, v83
    v_mfma_f32_32x32x16_bf16 v[32:47], v[112:115], v[96:99], v[32:47]
    v_mul_f32_e64 v84, v84, v88
    v_mul_f32_e64 v85, v85, v88
    v_mul_f32_e64 v86, v86, v88
    v_mul_f32 v87, v87, v88
    v_cvt_pk_bf16_f32 v102, v84, v85
    v_cvt_pk_bf16_f32 v103, v86, v87
    s_waitcnt vmcnt(2)
    v_mfma_f32_32x32x16_bf16 v[80:95], v[180:183], v[244:247], 0
    v_max3_u32 v30, v30, v180, v244
    ds_read_b64_tr_b16 v[104:105], v2 offset:24576
    ds_read_b64_tr_b16 v[106:107], v2 offset:25600
    ds_read_b64_tr_b16 v[108:109], v3 offset:24576
    ds_read_b64_tr_b16 v[110:111], v3 offset:25600
    v_add_f32_e64 v72, s60, v72
    v_rcp_f32 v72, v72
    s_waitcnt lgkmcnt(4)
    v_mfma_f32_32x32x16_bf16 v[48:63], v[124:127], v[100:103], v[48:63]
    v_mul_f32 v64, v64, v72
    v_mul_f32 v65, v65, v72
    v_mul_f32 v66, v66, v72
    v_mul_f32 v67, v67, v72
    v_cvt_pk_bf16_f32 v96, v64, v65
    v_cvt_pk_bf16_f32 v97, v66, v67
    v_mfma_f32_32x32x16_bf16 v[32:47], v[120:123], v[100:103], v[32:47]
    v_mul_f32_e64 v68, v68, v72
    v_mul_f32_e64 v69, v69, v72
    v_mul_f32_e64 v70, v70, v72
    v_mul_f32 v71, v71, v72
    v_cvt_pk_bf16_f32 v98, v68, v69
    v_cvt_pk_bf16_f32 v99, v70, v71
    s_waitcnt vmcnt(1)
    v_mfma_f32_32x32x16_bf16 v[64:79], v[184:187], v[248:251], 0
    v_max3_u32 v30, v30, v184, v248
    ds_read_b64_tr_b16 v[112:113], v2 offset:26624
    ds_read_b64_tr_b16 v[114:115], v2 offset:27648
    ds_read_b64_tr_b16 v[116:117], v3 offset:26624
    ds_read_b64_tr_b16 v[118:119], v3 offset:27648
    v_add_f32_e64 v88, s60, v88
    v_rcp_f32 v88, v88
    s_waitcnt lgkmcnt(4)
    v_mfma_f32_32x32x16_bf16 v[48:63], v[108:111], v[96:99], v[48:63]
    v_mul_f32 v80, v80, v88
    v_mul_f32 v81, v81, v88
    v_mul_f32 v82, v82, v88
    v_mul_f32 v83, v83, v88
    v_cvt_pk_bf16_f32 v100, v80, v81
    v_cvt_pk_bf16_f32 v101, v82, v83
    v_mfma_f32_32x32x16_bf16 v[32:47], v[104:107], v[96:99], v[32:47]
    v_mul_f32_e64 v84, v84, v88
    v_mul_f32_e64 v85, v85, v88
    v_mul_f32_e64 v86, v86, v88
    v_mul_f32 v87, v87, v88
    v_cvt_pk_bf16_f32 v102, v84, v85
    v_cvt_pk_bf16_f32 v103, v86, v87
    s_waitcnt vmcnt(0)
    v_mfma_f32_32x32x16_bf16 v[80:95], v[188:191], v[252:255], 0
    v_max3_u32 v30, v30, v188, v252
    ds_read_b64_tr_b16 v[120:121], v2 offset:28672
    ds_read_b64_tr_b16 v[122:123], v2 offset:29696
    ds_read_b64_tr_b16 v[124:125], v3 offset:28672
    ds_read_b64_tr_b16 v[126:127], v3 offset:29696
    v_add_f32_e64 v72, s60, v72
    v_rcp_f32 v72, v72
    s_waitcnt lgkmcnt(4)
    v_mfma_f32_32x32x16_bf16 v[48:63], v[116:119], v[100:103], v[48:63]
    v_mul_f32 v64, v64, v72
    v_mul_f32 v65, v65, v72
    v_mul_f32 v66, v66, v72
    v_mul_f32 v67, v67, v72
    v_cvt_pk_bf16_f32 v96, v64, v65
    v_cvt_pk_bf16_f32 v97, v66, v67
    v_mfma_f32_32x32x16_bf16 v[32:47], v[112:115], v[100:103], v[32:47]
    v_mul_f32 v68, v68, v72
    v_mul_f32 v69, v69, v72
    v_mul_f32 v70, v70, v72
    v_mul_f32 v71, v71, v72
    v_cvt_pk_bf16_f32 v98, v68, v69
    v_cvt_pk_bf16_f32 v99, v70, v71
    ds_read_b64_tr_b16 v[104:105], v2 offset:30720
    ds_read_b64_tr_b16 v[106:107], v2 offset:31744
    ds_read_b64_tr_b16 v[108:109], v3 offset:30720
    ds_read_b64_tr_b16 v[110:111], v3 offset:31744
    v_add_f32_e64 v88, s60, v88
    v_rcp_f32 v88, v88
    s_waitcnt lgkmcnt(4)
    v_mfma_f32_32x32x16_bf16 v[48:63], v[124:127], v[96:99], v[48:63]
    v_mul_f32 v80, v80, v88
    v_mul_f32 v81, v81, v88
    v_mul_f32 v82, v82, v88
    v_mul_f32 v83, v83, v88
    v_cvt_pk_bf16_f32 v100, v80, v81
    v_cvt_pk_bf16_f32 v101, v82, v83
    v_mfma_f32_32x32x16_bf16 v[32:47], v[120:123], v[96:99], v[32:47]
    v_mul_f32 v84, v84, v88
    v_mul_f32 v85, v85, v88
    v_mul_f32 v86, v86, v88
    v_mul_f32 v87, v87, v88
    v_cvt_pk_bf16_f32 v102, v84, v85
    v_cvt_pk_bf16_f32 v103, v86, v87
    s_waitcnt lgkmcnt(0)
    s_nop 0
    v_mfma_f32_32x32x16_bf16 v[48:63], v[108:111], v[100:103], v[48:63]
    v_mfma_f32_32x32x16_bf16 v[32:47], v[104:107], v[100:103], v[32:47]
    v_cmp_eq_u32 vcc, -1, v30
    s_cbranch_vccnz VBAD_116
VOK_115:
    s_lshl_b32 s62, s53, 103
    s_lshl_b32 s67, s55, 6
    s_add_u32 s62, s62, s67
    s_lshl_b32 s67, s56, 5
    s_add_u32 s62, s62, s67
    v_lshlrev_b32 v4, 3, v21
    buffer_load_dwordx2 v[152:153], v4, s[36:39], s62 offen offset:0
    buffer_load_dwordx2 v[154:155], v4, s[36:39], s62 offen offset:16
    s_nop 0
    ds_write_b128 v20, v[56:59] offset:2048
    ds_write_b128 v20, v[60:63] offset:3072
    ds_write_b128 v20, v[40:43] offset:0
    ds_write_b128 v20, v[44:47] offset:1024
    v_lshlrev_b32_e64 v64, 16, v8
    v_and_b32 v65, 0xffff0000, v8
    v_lshlrev_b32 v66, 16, v9
    v_and_b32 v67, 0xffff0000, v9
    v_lshlrev_b32 v68, 16, v10
    v_and_b32 v69, 0xffff0000, v10
    v_lshlrev_b32_e64 v70, 16, v11
    v_and_b32 v71, 0xffff0000, v11
    v_lshlrev_b32_e64 v72, 16, v12
    v_and_b32 v73, 0xffff0000, v12
    v_lshlrev_b32_e64 v74, 16, v13
    v_and_b32 v75, 0xffff0000, v13
    v_lshlrev_b32_e64 v76, 16, v14
    v_and_b32 v77, 0xffff0000, v14
    v_lshlrev_b32_e64 v78, 16, v15
    v_and_b32 v79, 0xffff0000, v15
    v_xor_b32 v5, 4096, v20
    v_pk_add_f32 v[48:49], v[48:49], v[72:73]
    v_pk_add_f32 v[50:51], v[50:51], v[74:75]
    v_pk_add_f32 v[52:53], v[52:53], v[76:77]
    v_pk_add_f32 v[54:55], v[54:55], v[78:79]
    v_pk_add_f32 v[32:33], v[32:33], v[64:65]
    v_pk_add_f32 v[34:35], v[34:35], v[66:67]
    v_pk_add_f32 v[36:37], v[36:37], v[68:69]
    v_pk_add_f32 v[38:39], v[38:39], v[70:71]
    s_waitcnt lgkmcnt(0)
    s_barrier
    ds_read_b128 v[64:67], v5 offset:0
    ds_read_b128 v[68:71], v5 offset:1024
    ds_read_b128 v[72:75], v5 offset:2048
    ds_read_b128 v[76:79], v5 offset:3072
    s_waitcnt lgkmcnt(3)
    v_pk_add_f32 v[32:33], v[32:33], v[64:65]
    v_pk_add_f32 v[34:35], v[34:35], v[66:67]
    v_cvt_pk_bf16_f32 v8, v32, v33
    v_cvt_pk_bf16_f32 v9, v34, v35
    s_waitcnt lgkmcnt(2)
    v_pk_add_f32 v[36:37], v[36:37], v[68:69]
    v_pk_add_f32 v[38:39], v[38:39], v[70:71]
    v_cvt_pk_bf16_f32 v10, v36, v37
    v_cvt_pk_bf16_f32 v11, v38, v39
    s_waitcnt lgkmcnt(1)
    v_pk_add_f32 v[48:49], v[48:49], v[72:73]
    v_pk_add_f32 v[50:51], v[50:51], v[74:75]
    v_cvt_pk_bf16_f32 v12, v48, v49
    v_cvt_pk_bf16_f32 v13, v50, v51
    s_waitcnt lgkmcnt(0)
    v_pk_add_f32 v[52:53], v[52:53], v[76:77]
    v_pk_add_f32 v[54:55], v[54:55], v[78:79]
    v_cvt_pk_bf16_f32 v14, v52, v53
    v_cvt_pk_bf16_f32 v15, v54, v55
    v_dot2_f32_bf16 v96, v8, s59, 0
    v_dot2_f32_bf16 v97, v8, v8, 0
    v_dot2_f32_bf16 v98, v9, s59, 0
    v_dot2_f32_bf16 v99, v9, v9, 0
    v_dot2_f32_bf16 v96, v10, s59, v96
    v_dot2_f32_bf16 v97, v10, v10, v97
    v_dot2_f32_bf16 v98, v11, s59, v98
    v_dot2_f32_bf16 v99, v11, v11, v99
    v_dot2_f32_bf16 v96, v12, s59, v96
    v_dot2_f32_bf16 v97, v12, v12, v97
    v_dot2_f32_bf16 v98, v13, s59, v98
    v_dot2_f32_bf16 v99, v13, v13, v99
    v_dot2_f32_bf16 v96, v14, s59, v96
    v_dot2_f32_bf16 v97, v14, v14, v97
    v_dot2_f32_bf16 v98, v15, s59, v98
    v_dot2_f32_bf16 v99, v15, v15, v99
    v_lshlrev_b32 v4, 3, v0
    s_nop 1
    v_pk_add_f32 v[96:97], v[96:97], v[98:99]
    v_mov_b32_e64 v98, v96
    v_mov_b32 v99, v97
    s_nop 0
    v_permlane32_swap_b32 v96, v98
    v_permlane32_swap_b32 v97, v99
    v_pk_add_f32 v[96:97], v[96:97], v[98:99]
    s_mov_b32 exec_hi, 0
    v_and_b32 v97, 0x7fffffff, v97
    buffer_store_dwordx2 v[96:97], v4, s[24:27], s88 offen sc1
    s_mov_b64 exec, -1
    ds_read_b64_tr_b16 v[160:161], v26 offset:10240
    ds_read_b64_tr_b16 v[162:163], v26 offset:11264
    ds_read_b64_tr_b16 v[164:165], v27 offset:10240
    ds_read_b64_tr_b16 v[166:167], v27 offset:11264
    ds_read_b64_tr_b16 v[168:169], v26 offset:0
    ds_read_b64_tr_b16 v[170:171], v26 offset:1024
    ds_read_b64_tr_b16 v[172:173], v27 offset:0
    ds_read_b64_tr_b16 v[174:175], v27 offset:1024
    ds_read_b64_tr_b16 v[176:177], v26 offset:2048
    ds_read_b64_tr_b16 v[178:179], v26 offset:3072
    ds_read_b64_tr_b16 v[180:181], v27 offset:2048
    ds_read_b64_tr_b16 v[182:183], v27 offset:3072
    ds_read_b64_tr_b16 v[184:185], v26 offset:4096
    ds_read_b64_tr_b16 v[186:187], v26 offset:5120
    ds_read_b64_tr_b16 v[188:189], v27 offset:4096
    ds_read_b64_tr_b16 v[190:191], v27 offset:5120
    ds_read_b64_tr_b16 v[192:193], v26 offset:6144
    ds_read_b64_tr_b16 v[194:195], v26 offset:7168
    ds_read_b64_tr_b16 v[196:197], v27 offset:6144
    ds_read_b64_tr_b16 v[198:199], v27 offset:7168
    ds_read_b64_tr_b16 v[200:201], v26 offset:8192
    ds_read_b64_tr_b16 v[202:203], v26 offset:9216
    ds_read_b64_tr_b16 v[204:205], v27 offset:8192
    ds_read_b64_tr_b16 v[206:207], v27 offset:9216
    s_waitcnt lgkmcnt(15)
    s_add_u32 m0, s75, 10240
    s_add_u32 s80, s80, 57344
    s_cmp_eq_u32 s80, 1835008
    s_cselect_b32 s80, 0, s80
    buffer_load_dwordx4 v24, s[16:19], s80 offen lds
    buffer_load_dwordx4 v25, s[16:19], s80 offen offset:1024 lds
    s_add_u32 m0, s75, 0
    s_add_u32 s80, s80, 57344
    s_cmp_eq_u32 s80, 1835008
    s_cselect_b32 s80, 0, s80
    buffer_load_dwordx4 v24, s[16:19], s80 offen lds
    buffer_load_dwordx4 v25, s[16:19], s80 offen offset:1024 lds
    s_waitcnt lgkmcnt(12)
    s_add_u32 m0, s75, 2048
    s_add_u32 s80, s80, 57344
    s_cmp_eq_u32 s80, 1835008
    s_cselect_b32 s80, 0, s80
    buffer_load_dwordx4 v24, s[16:19], s80 offen lds
    buffer_load_dwordx4 v25, s[16:19], s80 offen offset:1024 lds
    s_waitcnt lgkmcnt(8)
    s_add_u32 m0, s75, 4096
    s_add_u32 s80, s80, 57344
    s_cmp_eq_u32 s80, 1835008
    s_cselect_b32 s80, 0, s80
    buffer_load_dwordx4 v24, s[16:19], s80 offen lds
    buffer_load_dwordx4 v25, s[16:19], s80 offen offset:1024 lds
    v_lshlrev_b32 v64, 16, v8
    v_and_b32 v65, 0xffff0000, v8
    v_lshlrev_b32 v66, 16, v9
    v_and_b32 v67, 0xffff0000, v9
    v_lshlrev_b32_e64 v68, 16, v10
    v_and_b32 v69, 0xffff0000, v10
    v_lshlrev_b32_e64 v70, 16, v11
    v_and_b32 v71, 0xffff0000, v11
    v_lshlrev_b32_e64 v72, 16, v12
    v_and_b32 v73, 0xffff0000, v12
    v_lshlrev_b32_e64 v74, 16, v13
    v_and_b32 v75, 0xffff0000, v13
    v_lshlrev_b32_e64 v76, 16, v14
    v_and_b32 v77, 0xffff0000, v14
    v_lshlrev_b32_e64 v78, 16, v15
    v_and_b32 v79, 0xffff0000, v15
    v_and_b32 v4, 31, v0
    v_lshlrev_b32 v5, 2, v21
    v_sub_u32_e64 v4, v4, v5
    v_mov_b32 v7, 0x3f80
    v_subrev_u32 v5, 0, v4
    v_cmp_gt_u32 vcc, 2, v5
    v_lshlrev_b32 v5, 4, v5
    v_lshlrev_b32 v6, v5, v7
    v_cndmask_b32 v104, 0, v6, vcc
    v_subrev_u32 v5, 2, v4
    v_cmp_gt_u32 vcc, 2, v5
    v_lshlrev_b32 v5, 4, v5
    v_lshlrev_b32 v6, v5, v7
    v_cndmask_b32 v105, 0, v6, vcc
    v_subrev_u32 v5, 8, v4
    v_cmp_gt_u32 vcc, 2, v5
    v_lshlrev_b32 v5, 4, v5
    v_lshlrev_b32 v6, v5, v7
    v_cndmask_b32 v106, 0, v6, vcc
    v_subrev_u32 v5, 10, v4
    v_cmp_gt_u32 vcc, 2, v5
    v_lshlrev_b32 v5, 4, v5
    v_lshlrev_b32 v6, v5, v7
    v_cndmask_b32 v107, 0, v6, vcc
    v_subrev_u32 v5, 16, v4
    v_cmp_gt_u32 vcc, 2, v5
    v_lshlrev_b32 v5, 4, v5
    v_lshlrev_b32 v6, v5, v7
    v_cndmask_b32 v108, 0, v6, vcc
    v_subrev_u32 v5, 18, v4
    v_cmp_gt_u32 vcc, 2, v5
    v_lshlrev_b32 v5, 4, v5
    v_lshlrev_b32 v6, v5, v7
    v_cndmask_b32 v109, 0, v6, vcc
    v_subrev_u32 v5, 24, v4
    v_cmp_gt_u32 vcc, 2, v5
    v_lshlrev_b32 v5, 4, v5
    v_lshlrev_b32 v6, v5, v7
    v_cndmask_b32 v110, 0, v6, vcc
    v_subrev_u32 v5, 26, v4
    v_cmp_gt_u32 vcc, 2, v5
    v_lshlrev_b32 v5, 4, v5
    v_lshlrev_b32 v6, v5, v7
    v_cndmask_b32 v111, 0, v6, vcc
    v_and_b32 v20, 15, v0
    v_lshlrev_b32 v20, 4, v20
    v_lshl_add_u32 v20, v21, 9, v20
    v_bfe_u32 v4, v0, 4, 1
    v_lshl_add_u32 v20, v4, 10, v20
    v_and_b32 v4, 31, v0
    v_lshlrev_b32 v4, 3, v4
    v_lshl_add_u32 v6, v21, 12, v4
    v_mov_b32 v146, 0x3f800054
    buffer_load_dwordx2 v[128:129], v6, s[24:27], s89 offen offset:0 sc1
    buffer_load_dwordx2 v[130:131], v6, s[24:27], s89 offen offset:512 sc1
    buffer_load_dwordx2 v[132:133], v6, s[24:27], s89 offen offset:1024 sc1
    buffer_load_dwordx2 v[134:135], v6, s[24:27], s89 offen offset:1536 sc1
    buffer_load_dwordx2 v[136:137], v6, s[24:27], s89 offen offset:2048 sc1
    buffer_load_dwordx2 v[138:139], v6, s[24:27], s89 offen offset:2560 sc1
    buffer_load_dwordx2 v[140:141], v6, s[24:27], s89 offen offset:3072 sc1
    buffer_load_dwordx2 v[142:143], v6, s[24:27], s89 offen offset:3584 sc1
    s_waitcnt vmcnt(0)
    v_max3_u32 v7, v129, v131, v133
    v_max3_u32 v7, v7, v135, v137
    v_max3_u32 v7, v7, v139, v141
    v_max_u32 v7, v7, v143
    v_cmp_eq_u32 vcc, -1, v7
    s_cbranch_vccnz PRT_118
PDONE_117:
    ds_read_b64_tr_b16 v[208:209], v26 offset:10240
    ds_read_b64_tr_b16 v[210:211], v26 offset:11264
    ds_read_b64_tr_b16 v[212:213], v27 offset:10240
    ds_read_b64_tr_b16 v[214:215], v27 offset:11264
    ds_read_b64_tr_b16 v[216:217], v26 offset:0
    ds_read_b64_tr_b16 v[218:219], v26 offset:1024
    ds_read_b64_tr_b16 v[220:221], v27 offset:0
    ds_read_b64_tr_b16 v[222:223], v27 offset:1024
    ds_read_b64_tr_b16 v[224:225], v26 offset:2048
    ds_read_b64_tr_b16 v[226:227], v26 offset:3072
    ds_read_b64_tr_b16 v[228:229], v27 offset:2048
    ds_read_b64_tr_b16 v[230:231], v27 offset:3072
    ds_read_b64_tr_b16 v[232:233], v26 offset:4096
    ds_read_b64_tr_b16 v[234:235], v26 offset:5120
    ds_read_b64_tr_b16 v[236:237], v27 offset:4096
    ds_read_b64_tr_b16 v[238:239], v27 offset:5120
    s_waitcnt lgkmcnt(15)
    s_add_u32 m0, s75, 6144
    s_add_u32 s80, s80, 57344
    s_cmp_eq_u32 s80, 1835008
    s_cselect_b32 s80, 0, s80
    buffer_load_dwordx4 v24, s[16:19], s80 offen lds
    buffer_load_dwordx4 v25, s[16:19], s80 offen offset:1024 lds
    v_pk_add_f32 v[128:129], v[128:129], v[136:137]
    v_pk_add_f32 v[130:131], v[130:131], v[138:139]
    v_pk_add_f32 v[132:133], v[132:133], v[140:141]
    v_pk_add_f32 v[134:135], v[134:135], v[142:143]
    v_pk_add_f32 v[128:129], v[128:129], v[132:133]
    v_pk_add_f32 v[130:131], v[130:131], v[134:135]
    v_pk_add_f32 v[128:129], v[128:129], v[130:131]
    v_mov_b32_e64 v130, v128
    v_mov_b32 v131, v129
    s_nop 0
    v_permlane32_swap_b32 v128, v130
    v_permlane32_swap_b32 v129, v131
    v_pk_add_f32 v[128:129], v[128:129], v[130:131]
    v_mul_f32 v128, 0xbb000000, v128
    v_mul_f32 v129, 0x3b000000, v129
    v_fma_f32 v129, -v128, v128, v129
    v_max_f32_e64 v129, 0, v129
    v_fmaak_f32 v129, v129, v146, 0x2edbe6ff
    v_rsq_f32 v130, v129
    s_nop 0
    v_mul_f32_e64 v128, v128, v130
    v_pk_fma_f32 v[64:65], v[64:65], v[130:131], v[128:129] op_sel_hi:[1,0,0]
    v_pk_fma_f32 v[66:67], v[66:67], v[130:131], v[128:129] op_sel_hi:[1,0,0]
    v_pk_fma_f32 v[68:69], v[68:69], v[130:131], v[128:129] op_sel_hi:[1,0,0]
    v_pk_fma_f32 v[70:71], v[70:71], v[130:131], v[128:129] op_sel_hi:[1,0,0]
    v_pk_fma_f32 v[72:73], v[72:73], v[130:131], v[128:129] op_sel_hi:[1,0,0]
    v_pk_fma_f32 v[74:75], v[74:75], v[130:131], v[128:129] op_sel_hi:[1,0,0]
    v_pk_fma_f32 v[76:77], v[76:77], v[130:131], v[128:129] op_sel_hi:[1,0,0]
    v_pk_fma_f32 v[78:79], v[78:79], v[130:131], v[128:129] op_sel_hi:[1,0,0]
    v_cvt_pk_bf16_f32 v112, v64, v65
    v_cvt_pk_bf16_f32 v113, v66, v67
    v_cvt_pk_bf16_f32 v114, v68, v69
    v_cvt_pk_bf16_f32 v115, v70, v71
    s_nop 1
    s_nop 0
    v_mfma_f32_32x32x16_bf16 v[32:47], v[112:115], v[104:107], 0
    v_cvt_pk_bf16_f32 v116, v72, v73
    v_cvt_pk_bf16_f32 v117, v74, v75
    v_cvt_pk_bf16_f32 v118, v76, v77
    v_cvt_pk_bf16_f32 v119, v78, v79
    s_nop 1
    v_mfma_f32_32x32x16_bf16 v[32:47], v[116:119], v[108:111], v[32:47]
    s_nop 11
    v_cvt_pk_bf16_f32 v48, v32, v33
    v_cvt_pk_bf16_f32 v49, v34, v35
    v_cvt_pk_bf16_f32 v50, v36, v37
    v_cvt_pk_bf16_f32 v51, v38, v39
    buffer_store_dwordx4 v[48:51], v20, s[24:27], s90 offen offset:0 sc1
    v_cvt_pk_bf16_f32 v52, v40, v41
    v_cvt_pk_bf16_f32 v53, v42, v43
    v_cvt_pk_bf16_f32 v54, v44, v45
    v_cvt_pk_bf16_f32 v55, v46, v47
    buffer_store_dwordx4 v[52:55], v20, s[24:27], s90 offen offset:2048 sc1
    s_waitcnt vmcnt(2)
    ds_read_b64_tr_b16 v[240:241], v26 offset:6144
    ds_read_b64_tr_b16 v[242:243], v26 offset:7168
    ds_read_b64_tr_b16 v[244:245], v27 offset:6144
    ds_read_b64_tr_b16 v[246:247], v27 offset:7168
    s_waitcnt lgkmcnt(0)
    s_barrier
    s_lshl_b32 s67, s56, 5
    v_xor_b32 v26, s67, v26
    v_xor_b32 v27, s67, v27
    s_lshl_b32 s66, s48, 103
    s_mul_i32 s67, s3, 1835008
    s_add_u32 s66, s66, s67
    v_lshrrev_b32 v4, 3, v0
    v_mul_u32_u24 v24, 4096, v4
    v_bfe_u32 v5, v0, 4, 1
    v_lshlrev_b32 v5, 2, v5
    v_and_b32 v4, 7, v0
    v_xor_b32_e64 v4, v4, v5
    v_lshl_add_u32 v24, v4, 4, v24
    v_add_u32 v24, s66, v24
    v_add_u32 v25, 31744, v24
    s_add_u32 s67, s78, 11
    s_sub_u32 s80, s67, 28
    s_cselect_b32 s80, s67, s80
    s_mul_i32 s80, s80, 65536
    s_add_u32 m0, s57, 0
    s_nop 0
    buffer_load_dwordx4 v24, s[20:23], s80 offen lds
    buffer_load_dwordx4 v25, s[20:23], s80 offen offset:1024 lds
    s_add_u32 m0, s57, 2048
    s_add_u32 s80, s80, 65536
    s_cmp_eq_u32 s80, 1835008
    s_cselect_b32 s80, 0, s80
    buffer_load_dwordx4 v24, s[20:23], s80 offen lds
    buffer_load_dwordx4 v25, s[20:23], s80 offen offset:1024 lds
    s_add_u32 m0, s57, 4096
    s_add_u32 s80, s80, 65536
    s_cmp_eq_u32 s80, 1835008
    s_cselect_b32 s80, 0, s80
    buffer_load_dwordx4 v24, s[20:23], s80 offen lds
    buffer_load_dwordx4 v25, s[20:23], s80 offen offset:1024 lds
    s_add_u32 m0, s57, 6144
    s_add_u32 s80, s80, 65536
    s_cmp_eq_u32 s80, 1835008
    s_cselect_b32 s80, 0, s80
    buffer_load_dwordx4 v24, s[20:23], s80 offen lds
    buffer_load_dwordx4 v25, s[20:23], s80 offen offset:1024 lds
    s_add_u32 m0, s57, 8192
    s_add_u32 s80, s80, 65536
    s_cmp_eq_u32 s80, 1835008
    s_cselect_b32 s80, 0, s80
    buffer_load_dwordx4 v24, s[20:23], s80 offen lds
    buffer_load_dwordx4 v25, s[20:23], s80 offen offset:1024 lds
    s_add_u32 m0, s57, 10240
    s_add_u32 s80, s80, 65536
    s_cmp_eq_u32 s80, 1835008
    s_cselect_b32 s80, 0, s80
    buffer_load_dwordx4 v24, s[20:23], s80 offen lds
    buffer_load_dwordx4 v25, s[20:23], s80 offen offset:1024 lds
    s_add_u32 m0, s57, 12288
    s_add_u32 s80, s80, 65536
    s_cmp_eq_u32 s80, 1835008
    s_cselect_b32 s80, 0, s80
    buffer_load_dwordx4 v24, s[20:23], s80 offen lds
    buffer_load_dwordx4 v25, s[20:23], s80 offen offset:1024 lds
    s_add_u32 m0, s57, 14336
    s_add_u32 s80, s80, 65536
    s_cmp_eq_u32 s80, 1835008
    s_cselect_b32 s80, 0, s80
    buffer_load_dwordx4 v24, s[20:23], s80 offen lds
    buffer_load_dwordx4 v25, s[20:23], s80 offen offset:1024 lds
    v_lshlrev_b32 v144, 16, v152
    v_and_b32 v145, 0xffff0000, v152
    v_lshlrev_b32_e64 v146, 16, v153
    v_and_b32 v147, 0xffff0000, v153
    v_lshlrev_b32_e64 v148, 16, v154
    v_and_b32 v149, 0xffff0000, v154
    v_lshlrev_b32_e64 v150, 16, v155
    v_and_b32 v151, 0xffff0000, v155
    v_add_u32 v2, s91, v1
    v_min_u32 v4, 31, v0
    v_lshrrev_b32 v5, 1, v4
    v_and_b32 v4, 1, v4
    v_lshlrev_b32_e64 v4, 8, v4
    v_lshl_add_u32 v29, v5, 12, v4
    s_lshl_b32 s62, s56, 8
    v_xor_b32 v3, s62, v1
    v_add_u32 v3, s93, v3
    v_min_u32 v30, 27, v0
    v_lshlrev_b32 v30, 11, v30
    s_xor_b32 s62, s3, 1
    s_lshl_b32 s62, s62, 13
    v_add_u32 v4, s62, v1
    s_xor_b32 s62, s3, 2
    s_lshl_b32 s62, s62, 13
    v_add_u32 v5, s62, v1
    s_xor_b32 s62, s3, 3
    s_lshl_b32 s62, s62, 13
    v_add_u32 v6, s62, v1
    s_lshl_b32 s62, s3, 13
    v_add_u32 v20, s62, v1
    v_sub_u32 v153, 32768, v1
    v_mov_b32 v152, 0xc0135761
    s_cmp_eq_u32 s54, 7
    s_cbranch_scc1 P3IDLE_121
    s_mov_b32 s64, s99
    buffer_load_dword v7, v29, s[24:27], s91 offen offset:3836 sc1
    s_lshl_b32 s68, s77, 11
    buffer_load_dwordx4 v[96:99], v2, s[24:27], s68 offen offset:0 sc1
    buffer_load_dwordx4 v[100:103], v2, s[24:27], s68 offen offset:2048 sc1
    s_add_u32 s68, s68, 4096
    s_cmp_eq_u32 s68, 65536
    s_cselect_b32 s68, 0, s68
    buffer_load_dwordx4 v[104:107], v2, s[24:27], s68 offen offset:0 sc1
    buffer_load_dwordx4 v[108:111], v2, s[24:27], s68 offen offset:2048 sc1
    s_add_u32 s68, s68, 4096
    s_cmp_eq_u32 s68, 65536
    s_cselect_b32 s68, 0, s68
    buffer_load_dwordx4 v[112:115], v2, s[24:27], s68 offen offset:0 sc1
    buffer_load_dwordx4 v[116:119], v2, s[24:27], s68 offen offset:2048 sc1
    s_add_u32 s68, s68, 4096
    s_cmp_eq_u32 s68, 65536
    s_cselect_b32 s68, 0, s68
    buffer_load_dwordx4 v[120:123], v2, s[24:27], s68 offen offset:0 sc1
    buffer_load_dwordx4 v[124:127], v2, s[24:27], s68 offen offset:2048 sc1
    s_add_u32 s68, s68, 4096
    s_cmp_eq_u32 s68, 65536
    s_cselect_b32 s68, 0, s68
    buffer_load_dwordx4 v[128:131], v2, s[24:27], s68 offen offset:0 sc1
    s_waitcnt vmcnt(9)
    v_cmp_eq_u32 vcc, -1, v7
    s_cbranch_vccnz FB_125
FBB_126:
GO_124:
    v_mov_b32 v28, 0
    s_waitcnt vmcnt(8)
    v_mfma_f32_32x32x16_bf16 v[48:63], a[4:7], v[96:99], 0
    buffer_load_dwordx4 v[132:135], v2, s[24:27], s68 offen offset:2048 sc1
    v_mfma_f32_32x32x16_bf16 v[32:47], a[0:3], v[96:99], 0
    s_waitcnt vmcnt(8)
    v_mfma_f32_32x32x16_bf16 v[48:63], a[12:15], v[100:103], v[48:63]
    s_add_u32 s68, s68, 4096
    s_cmp_eq_u32 s68, 65536
    s_cselect_b32 s68, 0, s68
    buffer_load_dwordx4 v[136:139], v2, s[24:27], s68 offen offset:0 sc1
    v_max3_u32 v28, v28, v96, v100
    v_mfma_f32_32x32x16_bf16 v[32:47], a[8:11], v[100:103], v[32:47]
    s_waitcnt vmcnt(8)
    v_mfma_f32_32x32x16_bf16 v[48:63], a[20:23], v[104:107], v[48:63]
    buffer_load_dwordx4 v[140:143], v2, s[24:27], s68 offen offset:2048 sc1
    v_mfma_f32_32x32x16_bf16 v[32:47], a[16:19], v[104:107], v[32:47]
    s_waitcnt vmcnt(8)
    v_mfma_f32_32x32x16_bf16 v[48:63], a[28:31], v[108:111], v[48:63]
    s_add_u32 s68, s68, 4096
    s_cmp_eq_u32 s68, 65536
    s_cselect_b32 s68, 0, s68
    buffer_load_dwordx4 v[96:99], v2, s[24:27], s68 offen offset:0 sc1
    v_max3_u32 v28, v28, v104, v108
    v_mfma_f32_32x32x16_bf16 v[32:47], a[24:27], v[108:111], v[32:47]
    s_waitcnt vmcnt(8)
    v_mfma_f32_32x32x16_bf16 v[48:63], a[36:39], v[112:115], v[48:63]
    buffer_load_dwordx4 v[100:103], v2, s[24:27], s68 offen offset:2048 sc1
    v_mfma_f32_32x32x16_bf16 v[32:47], a[32:35], v[112:115], v[32:47]
    s_waitcnt vmcnt(8)
    v_mfma_f32_32x32x16_bf16 v[48:63], a[44:47], v[116:119], v[48:63]
    s_add_u32 s68, s68, 4096
    s_cmp_eq_u32 s68, 65536
    s_cselect_b32 s68, 0, s68
    buffer_load_dwordx4 v[104:107], v2, s[24:27], s68 offen offset:0 sc1
    v_max3_u32 v28, v28, v112, v116
    v_mfma_f32_32x32x16_bf16 v[32:47], a[40:43], v[116:119], v[32:47]
    s_waitcnt vmcnt(8)
    v_mfma_f32_32x32x16_bf16 v[48:63], a[52:55], v[120:123], v[48:63]
    buffer_load_dwordx4 v[108:111], v2, s[24:27], s68 offen offset:2048 sc1
    v_mfma_f32_32x32x16_bf16 v[32:47], a[48:51], v[120:123], v[32:47]
    s_waitcnt vmcnt(8)
    v_mfma_f32_32x32x16_bf16 v[48:63], a[60:63], v[124:127], v[48:63]
    s_add_u32 s68, s68, 4096
    s_cmp_eq_u32 s68, 65536
    s_cselect_b32 s68, 0, s68
    buffer_load_dwordx4 v[112:115], v2, s[24:27], s68 offen offset:0 sc1
    v_max3_u32 v28, v28, v120, v124
    v_mfma_f32_32x32x16_bf16 v[32:47], a[56:59], v[124:127], v[32:47]
    s_waitcnt vmcnt(8)
    v_mfma_f32_32x32x16_bf16 v[48:63], a[68:71], v[128:131], v[48:63]
    buffer_load_dwordx4 v[116:119], v2, s[24:27], s68 offen offset:2048 sc1
    v_mfma_f32_32x32x16_bf16 v[32:47], a[64:67], v[128:131], v[32:47]
    s_waitcnt vmcnt(8)
    v_mfma_f32_32x32x16_bf16 v[48:63], a[76:79], v[132:135], v[48:63]
    s_add_u32 s68, s68, 4096
    s_cmp_eq_u32 s68, 65536
    s_cselect_b32 s68, 0, s68
    buffer_load_dwordx4 v[120:123], v2, s[24:27], s68 offen offset:0 sc1
    v_max3_u32 v28, v28, v128, v132
    v_mfma_f32_32x32x16_bf16 v[32:47], a[72:75], v[132:135], v[32:47]
    s_waitcnt vmcnt(8)
    v_mfma_f32_32x32x16_bf16 v[48:63], a[84:87], v[136:139], v[48:63]
    buffer_load_dwordx4 v[124:127], v2, s[24:27], s68 offen offset:2048 sc1
    v_mfma_f32_32x32x16_bf16 v[32:47], a[80:83], v[136:139], v[32:47]
    s_waitcnt vmcnt(8)
    v_mfma_f32_32x32x16_bf16 v[48:63], a[92:95], v[140:143], v[48:63]
    s_add_u32 s68, s68, 4096
    s_cmp_eq_u32 s68, 65536
    s_cselect_b32 s68, 0, s68
    buffer_load_dwordx4 v[128:131], v2, s[24:27], s68 offen offset:0 sc1
    v_max3_u32 v28, v28, v136, v140
    v_mfma_f32_32x32x16_bf16 v[32:47], a[88:91], v[140:143], v[32:47]
    s_waitcnt vmcnt(8)
    v_mfma_f32_32x32x16_bf16 v[48:63], a[100:103], v[96:99], v[48:63]
    buffer_load_dwordx4 v[132:135], v2, s[24:27], s68 offen offset:2048 sc1
    v_mfma_f32_32x32x16_bf16 v[32:47], a[96:99], v[96:99], v[32:47]
    s_waitcnt vmcnt(8)
    v_mfma_f32_32x32x16_bf16 v[48:63], a[108:111], v[100:103], v[48:63]
    s_add_u32 s68, s68, 4096
    s_cmp_eq_u32 s68, 65536
    s_cselect_b32 s68, 0, s68
    buffer_load_dwordx4 v[136:139], v2, s[24:27], s68 offen offset:0 sc1
    v_max3_u32 v28, v28, v96, v100
    v_mfma_f32_32x32x16_bf16 v[32:47], a[104:107], v[100:103], v[32:47]
    s_waitcnt vmcnt(8)
    v_mfma_f32_32x32x16_bf16 v[48:63], a[116:119], v[104:107], v[48:63]
    buffer_load_dwordx4 v[140:143], v2, s[24:27], s68 offen offset:2048 sc1
    v_mfma_f32_32x32x16_bf16 v[32:47], a[112:115], v[104:107], v[32:47]
    s_waitcnt vmcnt(8)
    v_mfma_f32_32x32x16_bf16 v[48:63], a[124:127], v[108:111], v[48:63]
    s_add_u32 s68, s68, 4096
    s_cmp_eq_u32 s68, 65536
    s_cselect_b32 s68, 0, s68
    buffer_load_dwordx4 v[96:99], v2, s[24:27], s68 offen offset:0 sc1
    v_max3_u32 v28, v28, v104, v108
    v_mfma_f32_32x32x16_bf16 v[32:47], a[120:123], v[108:111], v[32:47]
    s_waitcnt vmcnt(8)
    v_mfma_f32_32x32x16_bf16 v[48:63], a[220:223], v[112:115], v[48:63]
    buffer_load_dwordx4 v[100:103], v2, s[24:27], s68 offen offset:2048 sc1
    v_mfma_f32_32x32x16_bf16 v[32:47], a[216:219], v[112:115], v[32:47]
    s_waitcnt vmcnt(8)
    v_mfma_f32_32x32x16_bf16 v[48:63], a[228:231], v[116:119], v[48:63]
    s_add_u32 s68, s68, 4096
    s_cmp_eq_u32 s68, 65536
    s_cselect_b32 s68, 0, s68
    buffer_load_dwordx4 v[104:107], v2, s[24:27], s68 offen offset:0 sc1
    v_max3_u32 v28, v28, v112, v116
    v_mfma_f32_32x32x16_bf16 v[32:47], a[224:227], v[116:119], v[32:47]
    s_waitcnt vmcnt(8)
    v_mfma_f32_32x32x16_bf16 v[48:63], a[236:239], v[120:123], v[48:63]
    buffer_load_dwordx4 v[108:111], v2, s[24:27], s68 offen offset:2048 sc1
    v_mfma_f32_32x32x16_bf16 v[32:47], a[232:235], v[120:123], v[32:47]
    s_waitcnt vmcnt(8)
    v_mfma_f32_32x32x16_bf16 v[48:63], a[244:247], v[124:127], v[48:63]
    s_add_u32 s68, s68, 4096
    s_cmp_eq_u32 s68, 65536
    s_cselect_b32 s68, 0, s68
    buffer_load_dwordx4 v[112:115], v2, s[24:27], s68 offen offset:0 sc1
    v_max3_u32 v28, v28, v120, v124
    v_mfma_f32_32x32x16_bf16 v[32:47], a[240:243], v[124:127], v[32:47]
    s_waitcnt vmcnt(8)
    v_mfma_f32_32x32x16_bf16 v[48:63], a[252:255], v[128:131], v[48:63]
    buffer_load_dwordx4 v[116:119], v2, s[24:27], s68 offen offset:2048 sc1
    v_mfma_f32_32x32x16_bf16 v[32:47], a[248:251], v[128:131], v[32:47]
    s_waitcnt vmcnt(8)
    v_mfma_f32_32x32x16_bf16 v[48:63], v[164:167], v[132:135], v[48:63]
    s_add_u32 s68, s68, 4096
    s_cmp_eq_u32 s68, 65536
    s_cselect_b32 s68, 0, s68
    buffer_load_dwordx4 v[120:123], v2, s[24:27], s68 offen offset:0 sc1
    v_max3_u32 v28, v28, v128, v132
    v_mfma_f32_32x32x16_bf16 v[32:47], v[160:163], v[132:135], v[32:47]
    s_waitcnt vmcnt(8)
    v_mfma_f32_32x32x16_bf16 v[48:63], v[172:175], v[136:139], v[48:63]
    buffer_load_dwordx4 v[124:127], v2, s[24:27], s68 offen offset:2048 sc1
    v_mfma_f32_32x32x16_bf16 v[32:47], v[168:171], v[136:139], v[32:47]
    s_waitcnt vmcnt(8)
    v_mfma_f32_32x32x16_bf16 v[48:63], v[180:183], v[140:143], v[48:63]
    s_lshl_b32 s68, s77, 11
    buffer_load_dwordx4 v[128:131], v2, s[24:27], s68 offen offset:1024 sc1
    v_max3_u32 v28, v28, v136, v140
    v_mfma_f32_32x32x16_bf16 v[32:47], v[176:179], v[140:143], v[32:47]
    s_waitcnt vmcnt(8)
    v_mfma_f32_32x32x16_bf16 v[48:63], v[188:191], v[96:99], v[48:63]
    buffer_load_dwordx4 v[132:135], v2, s[24:27], s68 offen offset:3072 sc1
    v_mfma_f32_32x32x16_bf16 v[32:47], v[184:187], v[96:99], v[32:47]
    s_waitcnt vmcnt(8)
    v_mfma_f32_32x32x16_bf16 v[48:63], v[196:199], v[100:103], v[48:63]
    s_add_u32 s68, s68, 4096
    s_cmp_eq_u32 s68, 65536
    s_cselect_b32 s68, 0, s68
    buffer_load_dwordx4 v[136:139], v2, s[24:27], s68 offen offset:1024 sc1
    v_max3_u32 v28, v28, v96, v100
    v_mfma_f32_32x32x16_bf16 v[32:47], v[192:195], v[100:103], v[32:47]
    s_waitcnt vmcnt(8)
    v_mfma_f32_32x32x16_bf16 v[48:63], v[204:207], v[104:107], v[48:63]
    buffer_load_dwordx4 v[140:143], v2, s[24:27], s68 offen offset:3072 sc1
    v_mfma_f32_32x32x16_bf16 v[32:47], v[200:203], v[104:107], v[32:47]
    s_waitcnt vmcnt(8)
    v_mfma_f32_32x32x16_bf16 v[48:63], v[212:215], v[108:111], v[48:63]
    s_add_u32 s68, s68, 4096
    s_cmp_eq_u32 s68, 65536
    s_cselect_b32 s68, 0, s68
    buffer_load_dwordx4 v[96:99], v2, s[24:27], s68 offen offset:1024 sc1
    v_max3_u32 v28, v28, v104, v108
    v_mfma_f32_32x32x16_bf16 v[32:47], v[208:211], v[108:111], v[32:47]
    s_waitcnt vmcnt(8)
    v_mfma_f32_32x32x16_bf16 v[48:63], v[220:223], v[112:115], v[48:63]
    buffer_load_dwordx4 v[100:103], v2, s[24:27], s68 offen offset:3072 sc1
    v_mfma_f32_32x32x16_bf16 v[32:47], v[216:219], v[112:115], v[32:47]
    s_waitcnt vmcnt(8)
    v_mfma_f32_32x32x16_bf16 v[48:63], v[228:231], v[116:119], v[48:63]
    s_add_u32 s68, s68, 4096
    s_cmp_eq_u32 s68, 65536
    s_cselect_b32 s68, 0, s68
    buffer_load_dwordx4 v[104:107], v2, s[24:27], s68 offen offset:1024 sc1
    v_max3_u32 v28, v28, v112, v116
    v_mfma_f32_32x32x16_bf16 v[32:47], v[224:227], v[116:119], v[32:47]
    s_waitcnt vmcnt(8)
    v_mfma_f32_32x32x16_bf16 v[48:63], v[236:239], v[120:123], v[48:63]
    buffer_load_dwordx4 v[108:111], v2, s[24:27], s68 offen offset:3072 sc1
    v_mfma_f32_32x32x16_bf16 v[32:47], v[232:235], v[120:123], v[32:47]
    s_waitcnt vmcnt(8)
    v_mfma_f32_32x32x16_bf16 v[48:63], v[244:247], v[124:127], v[48:63]
    s_add_u32 s68, s68, 4096
    s_cmp_eq_u32 s68, 65536
    s_cselect_b32 s68, 0, s68
    buffer_load_dwordx4 v[112:115], v2, s[24:27], s68 offen offset:1024 sc1
    v_max3_u32 v28, v28, v120, v124
    v_mfma_f32_32x32x16_bf16 v[32:47], v[240:243], v[124:127], v[32:47]
    v_cmp_eq_u32 vcc, -1, v28
    s_cbranch_vccnz VBAD_134
VOK_133:
BACK_132:
    s_nop 3
    ds_write_b128 v5, v[48:51] offset:2048
    ds_write_b128 v5, v[52:55] offset:3072
    ds_write_b128 v6, v[56:59] offset:4096
    ds_write_b128 v6, v[60:63] offset:5120
    s_nop 1
    ds_write_b128 v4, v[40:43] offset:0
    ds_write_b128 v4, v[44:47] offset:1024
    s_add_u32 m0, s75, 0
    s_add_u32 s80, s80, 65536
    s_cmp_eq_u32 s80, 1835008
    s_cselect_b32 s80, 0, s80
    buffer_load_dwordx4 v24, s[20:23], s80 offen lds
    buffer_load_dwordx4 v25, s[20:23], s80 offen offset:1024 lds
    s_add_u32 m0, s75, 2048
    s_add_u32 s80, s80, 65536
    s_cmp_eq_u32 s80, 1835008
    s_cselect_b32 s80, 0, s80
    buffer_load_dwordx4 v24, s[20:23], s80 offen lds
    buffer_load_dwordx4 v25, s[20:23], s80 offen offset:1024 lds
    s_add_u32 m0, s75, 4096
    s_add_u32 s80, s80, 65536
    s_cmp_eq_u32 s80, 1835008
    s_cselect_b32 s80, 0, s80
    buffer_load_dwordx4 v24, s[20:23], s80 offen lds
    buffer_load_dwordx4 v25, s[20:23], s80 offen offset:1024 lds
    v_pk_add_f32 v[32:33], v[32:33], v[144:145]
    v_pk_add_f32 v[34:35], v[34:35], v[146:147]
    v_pk_add_f32 v[36:37], v[36:37], v[148:149]
    v_pk_add_f32 v[38:39], v[38:39], v[150:151]
    s_waitcnt lgkmcnt(0)
    s_barrier
    ds_read_b128 v[64:67], v20 offset:0
    ds_read_b128 v[72:75], v20 offset:2048
    ds_read_b128 v[80:83], v20 offset:4096
    ds_read_b128 v[68:71], v20 offset:1024
    ds_read_b128 v[76:79], v20 offset:3072
    ds_read_b128 v[84:87], v20 offset:5120
    s_waitcnt lgkmcnt(4)
    v_pk_add_f32 v[64:65], v[64:65], v[72:73]
    v_pk_add_f32 v[66:67], v[66:67], v[74:75]
    s_waitcnt lgkmcnt(3)
    v_pk_add_f32 v[32:33], v[32:33], v[80:81]
    v_pk_add_f32 v[34:35], v[34:35], v[82:83]
    v_pk_add_f32 v[32:33], v[32:33], v[64:65]
    v_pk_add_f32 v[34:35], v[34:35], v[66:67]
    s_waitcnt lgkmcnt(1)
    v_pk_add_f32 v[68:69], v[68:69], v[76:77]
    v_pk_add_f32 v[70:71], v[70:71], v[78:79]
    s_waitcnt lgkmcnt(0)
    v_pk_add_f32 v[36:37], v[36:37], v[84:85]
    v_pk_add_f32 v[38:39], v[38:39], v[86:87]
    v_pk_add_f32 v[36:37], v[36:37], v[68:69]
    v_pk_add_f32 v[38:39], v[38:39], v[70:71]
    v_pk_mul_f32 v[48:49], v[32:33], v[32:33]
    v_pk_mul_f32 v[50:51], v[34:35], v[34:35]
    v_pk_mul_f32 v[52:53], v[36:37], v[36:37]
    v_pk_mul_f32 v[54:55], v[38:39], v[38:39]
    v_pk_fma_f32 v[48:49], v[48:49], s[64:65], v[152:153] op_sel_hi:[1,0,0]
    v_pk_fma_f32 v[50:51], v[50:51], s[64:65], v[152:153] op_sel_hi:[1,0,0]
    v_pk_fma_f32 v[52:53], v[52:53], s[64:65], v[152:153] op_sel_hi:[1,0,0]
    v_pk_fma_f32 v[54:55], v[54:55], s[64:65], v[152:153] op_sel_hi:[1,0,0]
    v_pk_mul_f32 v[48:49], v[48:49], v[32:33]
    v_pk_mul_f32 v[50:51], v[50:51], v[34:35]
    v_pk_mul_f32 v[52:53], v[52:53], v[36:37]
    v_pk_mul_f32 v[54:55], v[54:55], v[38:39]
    v_exp_f32 v48, v48
    v_exp_f32 v49, v49
    v_exp_f32 v50, v50
    v_exp_f32 v51, v51
    v_exp_f32 v52, v52
    v_exp_f32 v53, v53
    v_exp_f32 v54, v54
    v_exp_f32 v55, v55
    v_pk_add_f32 v[48:49], v[48:49], 1.0 op_sel_hi:[1,0]
    v_pk_add_f32 v[50:51], v[50:51], 1.0 op_sel_hi:[1,0]
    v_pk_add_f32 v[52:53], v[52:53], 1.0 op_sel_hi:[1,0]
    v_pk_add_f32 v[54:55], v[54:55], 1.0 op_sel_hi:[1,0]
    v_rcp_f32 v48, v48
    v_rcp_f32 v49, v49
    v_rcp_f32 v50, v50
    v_rcp_f32 v51, v51
    v_rcp_f32_e64 v52, v52
    v_rcp_f32_e64 v53, v53
    v_rcp_f32_e64 v54, v54
    v_rcp_f32_e64 v55, v55
    v_pk_mul_f32 v[32:33], v[32:33], v[48:49]
    v_pk_mul_f32 v[34:35], v[34:35], v[50:51]
    v_pk_mul_f32 v[36:37], v[36:37], v[52:53]
    v_pk_mul_f32 v[38:39], v[38:39], v[54:55]
    v_cvt_pk_bf16_f32 v56, v32, v33
    v_cvt_pk_bf16_f32 v57, v34, v35
    v_cvt_pk_bf16_f32 v58, v36, v37
    v_cvt_pk_bf16_f32 v59, v38, v39
    buffer_store_dwordx4 v[56:59], v1, s[24:27], s92 offen offset:0 sc1
    v_mov_b32 v28, 0
    s_waitcnt vmcnt(15)
    v_mfma_f32_32x32x16_bf16 v[80:95], a[4:7], v[128:131], 0
    buffer_load_dwordx4 v[116:119], v2, s[24:27], s68 offen offset:3072 sc1
    v_mfma_f32_32x32x16_bf16 v[64:79], a[0:3], v[128:131], 0
    s_waitcnt vmcnt(15)
    v_mfma_f32_32x32x16_bf16 v[80:95], a[12:15], v[132:135], v[80:95]
    s_add_u32 s68, s68, 4096
    s_cmp_eq_u32 s68, 65536
    s_cselect_b32 s68, 0, s68
    buffer_load_dwordx4 v[120:123], v2, s[24:27], s68 offen offset:1024 sc1
    v_max3_u32 v28, v28, v128, v132
    v_mfma_f32_32x32x16_bf16 v[64:79], a[8:11], v[132:135], v[64:79]
    s_waitcnt vmcnt(15)
    v_mfma_f32_32x32x16_bf16 v[80:95], a[20:23], v[136:139], v[80:95]
    buffer_load_dwordx4 v[124:127], v2, s[24:27], s68 offen offset:3072 sc1
    v_mfma_f32_32x32x16_bf16 v[64:79], a[16:19], v[136:139], v[64:79]
    s_waitcnt vmcnt(15)
    v_mfma_f32_32x32x16_bf16 v[80:95], a[28:31], v[140:143], v[80:95]
    s_add_u32 s68, s68, 4096
    s_cmp_eq_u32 s68, 65536
    s_cselect_b32 s68, 0, s68
    buffer_load_dwordx4 v[128:131], v2, s[24:27], s68 offen offset:1024 sc1
    v_max3_u32 v28, v28, v136, v140
    v_mfma_f32_32x32x16_bf16 v[64:79], a[24:27], v[140:143], v[64:79]
    s_waitcnt vmcnt(15)
    v_mfma_f32_32x32x16_bf16 v[80:95], a[36:39], v[96:99], v[80:95]
    buffer_load_dwordx4 v[132:135], v2, s[24:27], s68 offen offset:3072 sc1
    v_mfma_f32_32x32x16_bf16 v[64:79], a[32:35], v[96:99], v[64:79]
    s_waitcnt vmcnt(15)
    v_mfma_f32_32x32x16_bf16 v[80:95], a[44:47], v[100:103], v[80:95]
    s_add_u32 s68, s68, 4096
    s_cmp_eq_u32 s68, 65536
    s_cselect_b32 s68, 0, s68
    buffer_load_dwordx4 v[136:139], v2, s[24:27], s68 offen offset:1024 sc1
    v_max3_u32 v28, v28, v96, v100
    v_mfma_f32_32x32x16_bf16 v[64:79], a[40:43], v[100:103], v[64:79]
    s_waitcnt vmcnt(15)
    v_mfma_f32_32x32x16_bf16 v[80:95], a[52:55], v[104:107], v[80:95]
    buffer_load_dwordx4 v[140:143], v2, s[24:27], s68 offen offset:3072 sc1
    v_mfma_f32_32x32x16_bf16 v[64:79], a[48:51], v[104:107], v[64:79]
    s_waitcnt vmcnt(15)
    v_mfma_f32_32x32x16_bf16 v[80:95], a[60:63], v[108:111], v[80:95]
    s_add_u32 s68, s68, 4096
    s_cmp_eq_u32 s68, 65536
    s_cselect_b32 s68, 0, s68
    buffer_load_dwordx4 v[96:99], v2, s[24:27], s68 offen offset:1024 sc1
    v_max3_u32 v28, v28, v104, v108
    v_mfma_f32_32x32x16_bf16 v[64:79], a[56:59], v[108:111], v[64:79]
    s_waitcnt vmcnt(15)
    v_mfma_f32_32x32x16_bf16 v[80:95], a[68:71], v[112:115], v[80:95]
    buffer_load_dwordx4 v[100:103], v2, s[24:27], s68 offen offset:3072 sc1
    v_mfma_f32_32x32x16_bf16 v[64:79], a[64:67], v[112:115], v[64:79]
    s_waitcnt vmcnt(8)
    v_mfma_f32_32x32x16_bf16 v[80:95], a[76:79], v[116:119], v[80:95]
    s_add_u32 s68, s68, 4096
    s_cmp_eq_u32 s68, 65536
    s_cselect_b32 s68, 0, s68
    buffer_load_dwordx4 v[104:107], v2, s[24:27], s68 offen offset:1024 sc1
    v_max3_u32 v28, v28, v112, v116
    v_mfma_f32_32x32x16_bf16 v[64:79], a[72:75], v[116:119], v[64:79]
    s_waitcnt vmcnt(8)
    v_mfma_f32_32x32x16_bf16 v[80:95], a[84:87], v[120:123], v[80:95]
    buffer_load_dwordx4 v[108:111], v2, s[24:27], s68 offen offset:3072 sc1
    v_mfma_f32_32x32x16_bf16 v[64:79], a[80:83], v[120:123], v[64:79]
    s_waitcnt vmcnt(8)
    v_mfma_f32_32x32x16_bf16 v[80:95], a[92:95], v[124:127], v[80:95]
    s_add_u32 s68, s68, 4096
    s_cmp_eq_u32 s68, 65536
    s_cselect_b32 s68, 0, s68
    buffer_load_dwordx4 v[112:115], v2, s[24:27], s68 offen offset:1024 sc1
    v_max3_u32 v28, v28, v120, v124
    v_mfma_f32_32x32x16_bf16 v[64:79], a[88:91], v[124:127], v[64:79]
    s_waitcnt vmcnt(8)
    v_mfma_f32_32x32x16_bf16 v[80:95], a[100:103], v[128:131], v[80:95]
    buffer_load_dwordx4 v[116:119], v2, s[24:27], s68 offen offset:3072 sc1
    v_mfma_f32_32x32x16_bf16 v[64:79], a[96:99], v[128:131], v[64:79]
    s_waitcnt vmcnt(8)
    v_mfma_f32_32x32x16_bf16 v[80:95], a[108:111], v[132:135], v[80:95]
    s_add_u32 s68, s68, 4096
    s_cmp_eq_u32 s68, 65536
    s_cselect_b32 s68, 0, s68
    buffer_load_dwordx4 v[120:123], v2, s[24:27], s68 offen offset:1024 sc1
    v_max3_u32 v28, v28, v128, v132
    v_mfma_f32_32x32x16_bf16 v[64:79], a[104:107], v[132:135], v[64:79]
    s_waitcnt vmcnt(8)
    v_mfma_f32_32x32x16_bf16 v[80:95], a[116:119], v[136:139], v[80:95]
    buffer_load_dwordx4 v[124:127], v2, s[24:27], s68 offen offset:3072 sc1
    v_mfma_f32_32x32x16_bf16 v[64:79], a[112:115], v[136:139], v[64:79]
    s_waitcnt vmcnt(8)
    v_mfma_f32_32x32x16_bf16 v[80:95], a[124:127], v[140:143], v[80:95]
    s_add_u32 s68, s68, 4096
    s_cmp_eq_u32 s68, 65536
    s_cselect_b32 s68, 0, s68
    buffer_load_dwordx4 v[128:131], v2, s[24:27], s68 offen offset:1024 sc1
    v_max3_u32 v28, v28, v136, v140
    v_mfma_f32_32x32x16_bf16 v[64:79], a[120:123], v[140:143], v[64:79]
    s_waitcnt vmcnt(8)
    v_mfma_f32_32x32x16_bf16 v[80:95], a[220:223], v[96:99], v[80:95]
    buffer_load_dwordx4 v[132:135], v2, s[24:27], s68 offen offset:3072 sc1
    v_mfma_f32_32x32x16_bf16 v[64:79], a[216:219], v[96:99], v[64:79]
    s_waitcnt vmcnt(8)
    v_mfma_f32_32x32x16_bf16 v[80:95], a[228:231], v[100:103], v[80:95]
    s_add_u32 s68, s68, 4096
    s_cmp_eq_u32 s68, 65536
    s_cselect_b32 s68, 0, s68
    buffer_load_dwordx4 v[136:139], v2, s[24:27], s68 offen offset:1024 sc1
    v_max3_u32 v28, v28, v96, v100
    v_mfma_f32_32x32x16_bf16 v[64:79], a[224:227], v[100:103], v[64:79]
    s_waitcnt vmcnt(8)
    v_mfma_f32_32x32x16_bf16 v[80:95], a[236:239], v[104:107], v[80:95]
    buffer_load_dwordx4 v[140:143], v2, s[24:27], s68 offen offset:3072 sc1
    v_mfma_f32_32x32x16_bf16 v[64:79], a[232:235], v[104:107], v[64:79]
    s_waitcnt vmcnt(8)
    v_mfma_f32_32x32x16_bf16 v[80:95], a[244:247], v[108:111], v[80:95]
    s_add_u32 s68, s68, 4096
    s_cmp_eq_u32 s68, 65536
    s_cselect_b32 s68, 0, s68
    buffer_load_dwordx4 v[96:99], v2, s[24:27], s68 offen offset:1024 sc1
    v_max3_u32 v28, v28, v104, v108
    v_mfma_f32_32x32x16_bf16 v[64:79], a[240:243], v[108:111], v[64:79]
    s_waitcnt vmcnt(8)
    v_mfma_f32_32x32x16_bf16 v[80:95], a[252:255], v[112:115], v[80:95]
    buffer_load_dwordx4 v[100:103], v2, s[24:27], s68 offen offset:3072 sc1
    v_mfma_f32_32x32x16_bf16 v[64:79], a[248:251], v[112:115], v[64:79]
    s_waitcnt vmcnt(8)
    v_mfma_f32_32x32x16_bf16 v[80:95], v[164:167], v[116:119], v[80:95]
    s_add_u32 s68, s68, 4096
    s_cmp_eq_u32 s68, 65536
    s_cselect_b32 s68, 0, s68
    buffer_load_dwordx4 v[104:107], v2, s[24:27], s68 offen offset:1024 sc1
    v_max3_u32 v28, v28, v112, v116
    v_mfma_f32_32x32x16_bf16 v[64:79], v[160:163], v[116:119], v[64:79]
    s_waitcnt vmcnt(8)
    v_mfma_f32_32x32x16_bf16 v[80:95], v[172:175], v[120:123], v[80:95]
    buffer_load_dwordx4 v[108:111], v2, s[24:27], s68 offen offset:3072 sc1
    v_mfma_f32_32x32x16_bf16 v[64:79], v[168:171], v[120:123], v[64:79]
    s_waitcnt vmcnt(8)
    v_mfma_f32_32x32x16_bf16 v[80:95], v[180:183], v[124:127], v[80:95]
    buffer_load_dword v7, v30, s[24:27], s93 offen offset:1020 sc1
    s_lshl_b32 s68, s78, 107
    buffer_load_dwordx4 v[112:115], v3, s[24:27], s68 offen offset:0 sc1
    v_max3_u32 v28, v28, v120, v124
    v_mfma_f32_32x32x16_bf16 v[64:79], v[176:179], v[124:127], v[64:79]
    s_waitcnt vmcnt(9)
    v_mfma_f32_32x32x16_bf16 v[80:95], v[188:191], v[128:131], v[80:95]
    buffer_load_dwordx4 v[116:119], v3, s[24:27], s68 offen offset:2048 sc1
    v_mfma_f32_32x32x16_bf16 v[64:79], v[184:187], v[128:131], v[64:79]
    s_waitcnt vmcnt(9)
    v_mfma_f32_32x32x16_bf16 v[80:95], v[196:199], v[132:135], v[80:95]
    s_add_u32 s68, s68, 4096
    s_cmp_eq_u32 s68, 57344
    s_cselect_b32 s68, 0, s68
    buffer_load_dwordx4 v[120:123], v3, s[24:27], s68 offen offset:0 sc1
    v_max3_u32 v28, v28, v128, v132
    v_mfma_f32_32x32x16_bf16 v[64:79], v[192:195], v[132:135], v[64:79]
    s_waitcnt vmcnt(9)
    v_mfma_f32_32x32x16_bf16 v[80:95], v[204:207], v[136:139], v[80:95]
    buffer_load_dwordx4 v[124:127], v3, s[24:27], s68 offen offset:2048 sc1
    v_mfma_f32_32x32x16_bf16 v[64:79], v[200:203], v[136:139], v[64:79]
    s_waitcnt vmcnt(9)
    v_mfma_f32_32x32x16_bf16 v[80:95], v[212:215], v[140:143], v[80:95]
    s_add_u32 s68, s68, 4096
    s_cmp_eq_u32 s68, 57344
    s_cselect_b32 s68, 0, s68
    buffer_load_dwordx4 v[128:131], v3, s[24:27], s68 offen offset:0 sc1
    v_max3_u32 v28, v28, v136, v140
    v_mfma_f32_32x32x16_bf16 v[64:79], v[208:211], v[140:143], v[64:79]
    s_waitcnt vmcnt(9)
    v_mfma_f32_32x32x16_bf16 v[80:95], v[220:223], v[96:99], v[80:95]
    buffer_load_dwordx4 v[132:135], v3, s[24:27], s68 offen offset:2048 sc1
    v_mfma_f32_32x32x16_bf16 v[64:79], v[216:219], v[96:99], v[64:79]
    s_waitcnt vmcnt(9)
    v_mfma_f32_32x32x16_bf16 v[80:95], v[228:231], v[100:103], v[80:95]
    s_add_u32 s68, s68, 4096
    s_cmp_eq_u32 s68, 57344
    s_cselect_b32 s68, 0, s68
    buffer_load_dwordx4 v[136:139], v3, s[24:27], s68 offen offset:0 sc1
    v_max3_u32 v28, v28, v96, v100
    v_mfma_f32_32x32x16_bf16 v[64:79], v[224:227], v[100:103], v[64:79]
    s_waitcnt vmcnt(9)
    v_mfma_f32_32x32x16_bf16 v[80:95], v[236:239], v[104:107], v[80:95]
    buffer_load_dwordx4 v[140:143], v3, s[24:27], s68 offen offset:2048 sc1
    v_mfma_f32_32x32x16_bf16 v[64:79], v[232:235], v[104:107], v[64:79]
    s_waitcnt vmcnt(9)
    v_mfma_f32_32x32x16_bf16 v[80:95], v[244:247], v[108:111], v[80:95]
    s_add_u32 s68, s68, 4096
    s_cmp_eq_u32 s68, 57344
    s_cselect_b32 s68, 0, s68
    buffer_load_dwordx4 v[96:99], v3, s[24:27], s68 offen offset:0 sc1
    v_max3_u32 v28, v28, v104, v108
    v_mfma_f32_32x32x16_bf16 v[64:79], v[240:243], v[108:111], v[64:79]
    v_cmp_eq_u32_e64 vcc, -1, v28
    s_cbranch_vccnz VBAD_138
VOK_137:
BACK_136:
    v_lshl_add_u32 v155, v5, 1, v153
    s_nop 2
    ds_write_b128 v155, v[80:83] offset:14336
    ds_write_b128 v155, v[84:87] offset:15360
    ds_write_b128 v6, v[88:91] offset:6144
    ds_write_b128 v6, v[92:95] offset:7168
    v_lshl_add_u32 v154, v4, 1, v153
    s_nop 0
    ds_write_b128 v154, v[72:75] offset:12288
    ds_write_b128 v154, v[76:79] offset:13312
    s_add_u32 m0, s75, 6144
    s_add_u32 s80, s80, 65536
    s_cmp_eq_u32 s80, 1835008
    s_cselect_b32 s80, 0, s80
    buffer_load_dwordx4 v24, s[20:23], s80 offen lds
    buffer_load_dwordx4 v25, s[20:23], s80 offen offset:1024 lds
    s_add_u32 m0, s75, 8192
    s_add_u32 s80, s80, 65536
    s_cmp_eq_u32 s80, 1835008
    s_cselect_b32 s80, 0, s80
    buffer_load_dwordx4 v24, s[20:23], s80 offen lds
    buffer_load_dwordx4 v25, s[20:23], s80 offen offset:1024 lds
    s_add_u32 m0, s75, 10240
    s_add_u32 s80, s80, 65536
    s_cmp_eq_u32 s80, 1835008
    s_cselect_b32 s80, 0, s80
    buffer_load_dwordx4 v24, s[20:23], s80 offen lds
    buffer_load_dwordx4 v25, s[20:23], s80 offen offset:1024 lds
    v_pk_add_f32 v[64:65], v[64:65], v[144:145]
    v_pk_add_f32 v[66:67], v[66:67], v[146:147]
    v_pk_add_f32 v[68:69], v[68:69], v[148:149]
    v_pk_add_f32 v[70:71], v[70:71], v[150:151]
    v_lshl_add_u32 v154, v20, 1, v153
    s_waitcnt lgkmcnt(0)
    s_barrier
    ds_read_b128 v[32:35], v154 offset:12288
    ds_read_b128 v[40:43], v154 offset:14336
    ds_read_b128 v[48:51], v20 offset:6144
    ds_read_b128 v[36:39], v154 offset:13312
    ds_read_b128 v[44:47], v154 offset:15360
    ds_read_b128 v[52:55], v20 offset:7168
    s_waitcnt lgkmcnt(4)
    v_pk_add_f32 v[32:33], v[32:33], v[40:41]
    v_pk_add_f32 v[34:35], v[34:35], v[42:43]
    s_waitcnt lgkmcnt(3)
    v_pk_add_f32 v[64:65], v[64:65], v[48:49]
    v_pk_add_f32 v[66:67], v[66:67], v[50:51]
    v_pk_add_f32 v[64:65], v[64:65], v[32:33]
    v_pk_add_f32 v[66:67], v[66:67], v[34:35]
    s_waitcnt lgkmcnt(1)
    v_pk_add_f32 v[36:37], v[36:37], v[44:45]
    v_pk_add_f32 v[38:39], v[38:39], v[46:47]
    s_waitcnt lgkmcnt(0)
    v_pk_add_f32 v[68:69], v[68:69], v[52:53]
    v_pk_add_f32 v[70:71], v[70:71], v[54:55]
    v_pk_add_f32 v[68:69], v[68:69], v[36:37]
    v_pk_add_f32 v[70:71], v[70:71], v[38:39]
    v_pk_mul_f32 v[80:81], v[64:65], v[64:65]
    v_pk_mul_f32 v[82:83], v[66:67], v[66:67]
    v_pk_mul_f32 v[84:85], v[68:69], v[68:69]
    v_pk_mul_f32 v[86:87], v[70:71], v[70:71]
    v_pk_fma_f32 v[80:81], v[80:81], s[64:65], v[152:153] op_sel_hi:[1,0,0]
    v_pk_fma_f32 v[82:83], v[82:83], s[64:65], v[152:153] op_sel_hi:[1,0,0]
    v_pk_fma_f32 v[84:85], v[84:85], s[64:65], v[152:153] op_sel_hi:[1,0,0]
    v_pk_fma_f32 v[86:87], v[86:87], s[64:65], v[152:153] op_sel_hi:[1,0,0]
    v_pk_mul_f32 v[80:81], v[80:81], v[64:65]
    v_pk_mul_f32 v[82:83], v[82:83], v[66:67]
    v_pk_mul_f32 v[84:85], v[84:85], v[68:69]
    v_pk_mul_f32 v[86:87], v[86:87], v[70:71]
    v_exp_f32 v80, v80
    v_exp_f32 v81, v81
    v_exp_f32 v82, v82
    v_exp_f32 v83, v83
    v_exp_f32 v84, v84
    v_exp_f32 v85, v85
    v_exp_f32 v86, v86
    v_exp_f32 v87, v87
    v_pk_add_f32 v[80:81], v[80:81], 1.0 op_sel_hi:[1,0]
    v_pk_add_f32 v[82:83], v[82:83], 1.0 op_sel_hi:[1,0]
    v_pk_add_f32 v[84:85], v[84:85], 1.0 op_sel_hi:[1,0]
    v_pk_add_f32 v[86:87], v[86:87], 1.0 op_sel_hi:[1,0]
    v_rcp_f32 v80, v80
    v_rcp_f32 v81, v81
    v_rcp_f32 v82, v82
    v_rcp_f32 v83, v83
    v_rcp_f32 v84, v84
    v_rcp_f32 v85, v85
    v_rcp_f32_e64 v86, v86
    v_rcp_f32_e64 v87, v87
    v_pk_mul_f32 v[64:65], v[64:65], v[80:81]
    v_pk_mul_f32 v[66:67], v[66:67], v[82:83]
    v_pk_mul_f32 v[68:69], v[68:69], v[84:85]
    v_pk_mul_f32 v[70:71], v[70:71], v[86:87]
    v_cvt_pk_bf16_f32 v88, v64, v65
    v_cvt_pk_bf16_f32 v89, v66, v67
    v_cvt_pk_bf16_f32 v90, v68, v69
    v_cvt_pk_bf16_f32 v91, v70, v71
    buffer_store_dwordx4 v[88:91], v1, s[24:27], s92 offen offset:1024 sc1
    s_waitcnt vmcnt(16)
    v_cmp_eq_u32 vcc, -1, v7
    s_cbranch_vccnz FB_139
FBB_140:
    s_nop 1
P3JOIN_122:
    v_mov_b32 v28, 0
    s_waitcnt vmcnt(14)
    v_mfma_f32_32x32x16_bf16 v[48:63], v[112:115], a[132:135], 0
    buffer_load_dwordx4 v[100:103], v3, s[24:27], s68 offen offset:2048 sc1
    v_mfma_f32_32x32x16_bf16 v[32:47], v[112:115], a[128:131], 0
    v_add_u32 v144, 65536, v26
    v_add_u32 v145, 65536, v27
    ds_read_b64_tr_b16 a[216:217], v144 offset:0
    ds_read_b64_tr_b16 a[218:219], v144 offset:1024
    ds_read_b64_tr_b16 a[220:221], v145 offset:0
    ds_read_b64_tr_b16 a[222:223], v145 offset:1024
    ds_read_b64_tr_b16 a[224:225], v144 offset:2048
    ds_read_b64_tr_b16 a[226:227], v144 offset:3072
    ds_read_b64_tr_b16 a[228:229], v145 offset:2048
    ds_read_b64_tr_b16 a[230:231], v145 offset:3072
    s_waitcnt vmcnt(14)
    v_mfma_f32_32x32x16_bf16 v[48:63], v[116:119], a[140:143], v[48:63]
    s_add_u32 s68, s68, 4096
    s_cmp_eq_u32 s68, 57344
    s_cselect_b32 s68, 0, s68
    buffer_load_dwordx4 v[104:107], v3, s[24:27], s68 offen offset:0 sc1
    v_max3_u32 v28, v28, v112, v116
    v_mfma_f32_32x32x16_bf16 v[32:47], v[116:119], a[136:139], v[32:47]
    ds_read_b64_tr_b16 a[232:233], v144 offset:4096
    ds_read_b64_tr_b16 a[234:235], v144 offset:5120
    ds_read_b64_tr_b16 a[236:237], v145 offset:4096
    ds_read_b64_tr_b16 a[238:239], v145 offset:5120
    ds_read_b64_tr_b16 a[240:241], v144 offset:6144
    ds_read_b64_tr_b16 a[242:243], v144 offset:7168
    ds_read_b64_tr_b16 a[244:245], v145 offset:6144
    ds_read_b64_tr_b16 a[246:247], v145 offset:7168
    s_waitcnt vmcnt(14)
    s_nop 0
    v_mfma_f32_32x32x16_bf16 v[48:63], v[120:123], a[148:151], v[48:63]
    buffer_load_dwordx4 v[108:111], v3, s[24:27], s68 offen offset:2048 sc1
    v_mfma_f32_32x32x16_bf16 v[32:47], v[120:123], a[144:147], v[32:47]
    ds_read_b64_tr_b16 a[248:249], v144 offset:8192
    ds_read_b64_tr_b16 a[250:251], v144 offset:9216
    ds_read_b64_tr_b16 a[252:253], v145 offset:8192
    ds_read_b64_tr_b16 a[254:255], v145 offset:9216
    ds_read_b64_tr_b16 v[160:161], v144 offset:10240
    ds_read_b64_tr_b16 v[162:163], v144 offset:11264
    ds_read_b64_tr_b16 v[164:165], v145 offset:10240
    ds_read_b64_tr_b16 v[166:167], v145 offset:11264
    s_waitcnt vmcnt(14)
    v_mfma_f32_32x32x16_bf16 v[48:63], v[124:127], a[156:159], v[48:63]
    s_add_u32 s68, s68, 4096
    s_cmp_eq_u32 s68, 57344
    s_cselect_b32 s68, 0, s68
    buffer_load_dwordx4 v[112:115], v3, s[24:27], s68 offen offset:0 sc1
    v_max3_u32 v28, v28, v120, v124
    v_mfma_f32_32x32x16_bf16 v[32:47], v[124:127], a[152:155], v[32:47]
    ds_read_b64_tr_b16 v[168:169], v144 offset:12288
    ds_read_b64_tr_b16 v[170:171], v144 offset:13312
    ds_read_b64_tr_b16 v[172:173], v145 offset:12288
    ds_read_b64_tr_b16 v[174:175], v145 offset:13312
    ds_read_b64_tr_b16 v[176:177], v144 offset:14336
    ds_read_b64_tr_b16 v[178:179], v144 offset:15360
    ds_read_b64_tr_b16 v[180:181], v145 offset:14336
    ds_read_b64_tr_b16 v[182:183], v145 offset:15360
    s_waitcnt vmcnt(14)
    s_nop 0
    v_mfma_f32_32x32x16_bf16 v[48:63], v[128:131], a[164:167], v[48:63]
    buffer_load_dwordx4 v[116:119], v3, s[24:27], s68 offen offset:2048 sc1
    v_mfma_f32_32x32x16_bf16 v[32:47], v[128:131], a[160:163], v[32:47]
    ds_read_b64_tr_b16 v[184:185], v26 offset:0
    ds_read_b64_tr_b16 v[186:187], v26 offset:1024
    ds_read_b64_tr_b16 v[188:189], v27 offset:0
    ds_read_b64_tr_b16 v[190:191], v27 offset:1024
    ds_read_b64_tr_b16 v[192:193], v26 offset:2048
    ds_read_b64_tr_b16 v[194:195], v26 offset:3072
    ds_read_b64_tr_b16 v[196:197], v27 offset:2048
    ds_read_b64_tr_b16 v[198:199], v27 offset:3072
    s_waitcnt lgkmcnt(4)
    s_add_u32 m0, s75, 0
    s_add_u32 s80, s80, 65536
    s_cmp_eq_u32 s80, 1835008
    s_cselect_b32 s80, 0, s80
    buffer_load_dwordx4 v24, s[20:23], s80 offen lds
    buffer_load_dwordx4 v25, s[20:23], s80 offen offset:1024 lds
    s_waitcnt lgkmcnt(0)
    s_add_u32 m0, s75, 2048
    s_add_u32 s80, s80, 65536
    s_cmp_eq_u32 s80, 1835008
    s_cselect_b32 s80, 0, s80
    buffer_load_dwordx4 v24, s[20:23], s80 offen lds
    buffer_load_dwordx4 v25, s[20:23], s80 offen offset:1024 lds
    s_waitcnt vmcnt(18)
    v_mfma_f32_32x32x16_bf16 v[48:63], v[132:135], a[172:175], v[48:63]
    s_add_u32 s68, s68, 4096
    s_cmp_eq_u32 s68, 57344
    s_cselect_b32 s68, 0, s68
    buffer_load_dwordx4 v[120:123], v3, s[24:27], s68 offen offset:0 sc1
    v_max3_u32 v28, v28, v128, v132
    v_mfma_f32_32x32x16_bf16 v[32:47], v[132:135], a[168:171], v[32:47]
    ds_read_b64_tr_b16 v[200:201], v26 offset:4096
    ds_read_b64_tr_b16 v[202:203], v26 offset:5120
    ds_read_b64_tr_b16 v[204:205], v27 offset:4096
    ds_read_b64_tr_b16 v[206:207], v27 offset:5120
    s_waitcnt vmcnt(14)
    ds_read_b64_tr_b16 v[208:209], v26 offset:6144
    ds_read_b64_tr_b16 v[210:211], v26 offset:7168
    ds_read_b64_tr_b16 v[212:213], v27 offset:6144
    ds_read_b64_tr_b16 v[214:215], v27 offset:7168
    s_waitcnt lgkmcnt(4)
    s_add_u32 m0, s75, 4096
    s_add_u32 s80, s80, 65536
    s_cmp_eq_u32 s80, 1835008
    s_cselect_b32 s80, 0, s80
    buffer_load_dwordx4 v24, s[20:23], s80 offen lds
    buffer_load_dwordx4 v25, s[20:23], s80 offen offset:1024 lds
    v_mfma_f32_32x32x16_bf16 v[48:63], v[136:139], a[180:183], v[48:63]
    buffer_load_dwordx4 v[124:127], v3, s[24:27], s68 offen offset:2048 sc1
    v_mfma_f32_32x32x16_bf16 v[32:47], v[136:139], a[176:179], v[32:47]
    s_waitcnt vmcnt(15)
    s_nop 0
    ds_read_b64_tr_b16 v[216:217], v26 offset:8192
    ds_read_b64_tr_b16 v[218:219], v26 offset:9216
    ds_read_b64_tr_b16 v[220:221], v27 offset:8192
    ds_read_b64_tr_b16 v[222:223], v27 offset:9216
    s_waitcnt vmcnt(13)
    ds_read_b64_tr_b16 v[224:225], v26 offset:10240
    ds_read_b64_tr_b16 v[226:227], v26 offset:11264
    ds_read_b64_tr_b16 v[228:229], v27 offset:10240
    ds_read_b64_tr_b16 v[230:231], v27 offset:11264
    v_mfma_f32_32x32x16_bf16 v[48:63], v[140:143], a[188:191], v[48:63]
    s_add_u32 s68, s68, 4096
    s_cmp_eq_u32 s68, 57344
    s_cselect_b32 s68, 0, s68
    buffer_load_dwordx4 v[128:131], v3, s[24:27], s68 offen offset:0 sc1
    v_max3_u32 v28, v28, v136, v140
    v_mfma_f32_32x32x16_bf16 v[32:47], v[140:143], a[184:187], v[32:47]
    v_mfma_f32_32x32x16_bf16 v[48:63], v[96:99], a[196:199], v[48:63]
    buffer_load_dwordx4 v[132:135], v3, s[24:27], s68 offen offset:2048 sc1
    v_mfma_f32_32x32x16_bf16 v[32:47], v[96:99], a[192:195], v[32:47]
    s_waitcnt vmcnt(14)
    v_mfma_f32_32x32x16_bf16 v[48:63], v[100:103], a[204:207], v[48:63]
    s_add_u32 s68, s68, 4096
    s_cmp_eq_u32 s68, 57344
    s_cselect_b32 s68, 0, s68
    buffer_load_dwordx4 v[136:139], v3, s[24:27], s68 offen offset:0 sc1
    v_max3_u32 v28, v28, v96, v100
    v_mfma_f32_32x32x16_bf16 v[32:47], v[100:103], a[200:203], v[32:47]
    s_waitcnt vmcnt(14)
    v_mfma_f32_32x32x16_bf16 v[48:63], v[104:107], a[212:215], v[48:63]
    buffer_load_dwordx4 v[140:143], v3, s[24:27], s68 offen offset:2048 sc1
    v_mfma_f32_32x32x16_bf16 v[32:47], v[104:107], a[208:211], v[32:47]
    s_waitcnt vmcnt(14)
    v_mfma_f32_32x32x16_bf16 v[48:63], v[108:111], a[220:223], v[48:63]
    s_add_u32 s68, s68, 4096
    s_cmp_eq_u32 s68, 57344
    s_cselect_b32 s68, 0, s68
    buffer_load_dwordx4 v[96:99], v3, s[24:27], s68 offen offset:0 sc1
    v_max3_u32 v28, v28, v104, v108
    v_mfma_f32_32x32x16_bf16 v[32:47], v[108:111], a[216:219], v[32:47]
    s_waitcnt vmcnt(14)
    v_mfma_f32_32x32x16_bf16 v[48:63], v[112:115], a[228:231], v[48:63]
    buffer_load_dwordx4 v[100:103], v3, s[24:27], s68 offen offset:2048 sc1
    v_mfma_f32_32x32x16_bf16 v[32:47], v[112:115], a[224:227], v[32:47]
    s_waitcnt vmcnt(14)
    v_mfma_f32_32x32x16_bf16 v[48:63], v[116:119], a[236:239], v[48:63]
    s_add_u32 s68, s68, 4096
    s_cmp_eq_u32 s68, 57344
    s_cselect_b32 s68, 0, s68
    buffer_load_dwordx4 v[104:107], v3, s[24:27], s68 offen offset:0 sc1
    v_max3_u32 v28, v28, v112, v116
    v_mfma_f32_32x32x16_bf16 v[32:47], v[116:119], a[232:235], v[32:47]
    s_waitcnt vmcnt(10)
    v_mfma_f32_32x32x16_bf16 v[48:63], v[120:123], a[244:247], v[48:63]
    buffer_load_dwordx4 v[108:111], v3, s[24:27], s68 offen offset:2048 sc1
    v_mfma_f32_32x32x16_bf16 v[32:47], v[120:123], a[240:243], v[32:47]
    s_waitcnt vmcnt(8)
    v_mfma_f32_32x32x16_bf16 v[48:63], v[124:127], a[252:255], v[48:63]
    s_add_u32 s68, s68, 4096
    s_cmp_eq_u32 s68, 57344
    s_cselect_b32 s68, 0, s68
    buffer_load_dwordx4 v[112:115], v3, s[24:27], s68 offen offset:0 sc1
    v_max3_u32 v28, v28, v120, v124
    v_mfma_f32_32x32x16_bf16 v[32:47], v[124:127], a[248:251], v[32:47]
    s_waitcnt vmcnt(8)
    v_mfma_f32_32x32x16_bf16 v[48:63], v[128:131], v[164:167], v[48:63]
    buffer_load_dwordx4 v[116:119], v3, s[24:27], s68 offen offset:2048 sc1
    v_mfma_f32_32x32x16_bf16 v[32:47], v[128:131], v[160:163], v[32:47]
    s_waitcnt vmcnt(8)
    v_mfma_f32_32x32x16_bf16 v[48:63], v[132:135], v[172:175], v[48:63]
    s_add_u32 s68, s68, 4096
    s_cmp_eq_u32 s68, 57344
    s_cselect_b32 s68, 0, s68
    buffer_load_dwordx4 v[120:123], v3, s[24:27], s68 offen offset:0 sc1
    v_max3_u32 v28, v28, v128, v132
    v_mfma_f32_32x32x16_bf16 v[32:47], v[132:135], v[168:171], v[32:47]
    s_waitcnt vmcnt(8)
    v_mfma_f32_32x32x16_bf16 v[48:63], v[136:139], v[180:183], v[48:63]
    buffer_load_dwordx4 v[124:127], v3, s[24:27], s68 offen offset:2048 sc1
    v_mfma_f32_32x32x16_bf16 v[32:47], v[136:139], v[176:179], v[32:47]
    s_waitcnt vmcnt(8)
    v_mfma_f32_32x32x16_bf16 v[48:63], v[140:143], v[188:191], v[48:63]
    buffer_load_dword v7, v30, s[24:27], s93 offen offset:2044 sc1
    s_lshl_b32 s68, s78, 107
    buffer_load_dwordx4 v[128:131], v3, s[24:27], s68 offen offset:1024 sc1
    v_max3_u32 v28, v28, v136, v140
    v_mfma_f32_32x32x16_bf16 v[32:47], v[140:143], v[184:187], v[32:47]
    s_waitcnt vmcnt(9)
    v_mfma_f32_32x32x16_bf16 v[48:63], v[96:99], v[196:199], v[48:63]
    buffer_load_dwordx4 v[132:135], v3, s[24:27], s68 offen offset:3072 sc1
    v_mfma_f32_32x32x16_bf16 v[32:47], v[96:99], v[192:195], v[32:47]
    s_waitcnt vmcnt(9)
    v_mfma_f32_32x32x16_bf16 v[48:63], v[100:103], v[204:207], v[48:63]
    s_add_u32 s68, s68, 4096
    s_cmp_eq_u32 s68, 57344
    s_cselect_b32 s68, 0, s68
    buffer_load_dwordx4 v[136:139], v3, s[24:27], s68 offen offset:1024 sc1
    v_max3_u32 v28, v28, v96, v100
    v_mfma_f32_32x32x16_bf16 v[32:47], v[100:103], v[200:203], v[32:47]
    s_waitcnt lgkmcnt(8)
    s_waitcnt vmcnt(9)
    v_mfma_f32_32x32x16_bf16 v[48:63], v[104:107], v[212:215], v[48:63]
    buffer_load_dwordx4 v[140:143], v3, s[24:27], s68 offen offset:3072 sc1
    v_mfma_f32_32x32x16_bf16 v[32:47], v[104:107], v[208:211], v[32:47]
    ds_read_b64_tr_b16 v[232:233], v26 offset:0
    ds_read_b64_tr_b16 v[234:235], v26 offset:1024
    ds_read_b64_tr_b16 v[236:237], v27 offset:0
    ds_read_b64_tr_b16 v[238:239], v27 offset:1024
    s_waitcnt lgkmcnt(8)
    s_waitcnt vmcnt(9)
    v_mfma_f32_32x32x16_bf16 v[48:63], v[108:111], v[220:223], v[48:63]
    s_add_u32 s68, s68, 4096
    s_cmp_eq_u32 s68, 57344
    s_cselect_b32 s68, 0, s68
    buffer_load_dwordx4 v[96:99], v3, s[24:27], s68 offen offset:1024 sc1
    v_max3_u32 v28, v28, v104, v108
    v_mfma_f32_32x32x16_bf16 v[32:47], v[108:111], v[216:219], v[32:47]
    ds_read_b64_tr_b16 v[240:241], v26 offset:2048
    ds_read_b64_tr_b16 v[242:243], v26 offset:3072
    ds_read_b64_tr_b16 v[244:245], v27 offset:2048
    ds_read_b64_tr_b16 v[246:247], v27 offset:3072
    s_waitcnt lgkmcnt(8)
    s_waitcnt vmcnt(9)
    v_mfma_f32_32x32x16_bf16 v[48:63], v[112:115], v[228:231], v[48:63]
    buffer_load_dwordx4 v[100:103], v3, s[24:27], s68 offen offset:3072 sc1
    v_mfma_f32_32x32x16_bf16 v[32:47], v[112:115], v[224:227], v[32:47]
    ds_read_b64_tr_b16 v[248:249], v26 offset:4096
    ds_read_b64_tr_b16 v[250:251], v26 offset:5120
    ds_read_b64_tr_b16 v[252:253], v27 offset:4096
    ds_read_b64_tr_b16 v[254:255], v27 offset:5120
    s_waitcnt lgkmcnt(8)
    s_nop 0
    s_waitcnt vmcnt(9)
    v_mfma_f32_32x32x16_bf16 v[48:63], v[116:119], v[236:239], v[48:63]
    s_add_u32 s68, s68, 4096
    s_cmp_eq_u32 s68, 57344
    s_cselect_b32 s68, 0, s68
    buffer_load_dwordx4 v[104:107], v3, s[24:27], s68 offen offset:1024 sc1
    v_max3_u32 v28, v28, v112, v116
    v_mfma_f32_32x32x16_bf16 v[32:47], v[116:119], v[232:235], v[32:47]
    s_waitcnt lgkmcnt(4)
    s_waitcnt vmcnt(9)
    v_mfma_f32_32x32x16_bf16 v[48:63], v[120:123], v[244:247], v[48:63]
    buffer_load_dwordx4 v[108:111], v3, s[24:27], s68 offen offset:3072 sc1
    v_mfma_f32_32x32x16_bf16 v[32:47], v[120:123], v[240:243], v[32:47]
    s_waitcnt lgkmcnt(0)
    s_waitcnt vmcnt(9)
    v_mfma_f32_32x32x16_bf16 v[48:63], v[124:127], v[252:255], v[48:63]
    s_add_u32 s68, s68, 4096
    s_cmp_eq_u32 s68, 57344
    s_cselect_b32 s68, 0, s68
    buffer_load_dwordx4 v[112:115], v3, s[24:27], s68 offen offset:1024 sc1
    v_max3_u32 v28, v28, v120, v124
    v_mfma_f32_32x32x16_bf16 v[32:47], v[124:127], v[248:251], v[32:47]
    v_cmp_eq_u32 vcc, -1, v28
    s_cbranch_vccnz VBAD_152
VOK_151:
BACK_150:
    s_nop 3
    ds_write_b128 v5, v[48:51] offset:2048
    ds_write_b128 v5, v[52:55] offset:3072
    ds_write_b128 v6, v[56:59] offset:4096
    ds_write_b128 v6, v[60:63] offset:5120
    s_nop 1
    ds_write_b128 v4, v[40:43] offset:0
    ds_write_b128 v4, v[44:47] offset:1024
    s_waitcnt vmcnt(9)
    v_cmp_eq_u32 vcc, -1, v7
    s_cbranch_vccnz FB_153
FBB_154:
    v_mov_b32_e64 v28, 0
    v_lshlrev_b32 v144, 16, v8
    s_waitcnt vmcnt(8)
    v_mfma_f32_32x32x16_bf16 v[80:95], v[128:131], a[132:135], 0
    buffer_load_dwordx4 v[116:119], v3, s[24:27], s68 offen offset:3072 sc1
    v_mfma_f32_32x32x16_bf16 v[64:79], v[128:131], a[128:131], 0
    v_and_b32 v145, 0xffff0000, v8
    v_lshlrev_b32_e64 v146, 16, v9
    v_and_b32 v147, 0xffff0000, v9
    s_waitcnt vmcnt(8)
    v_mfma_f32_32x32x16_bf16 v[80:95], v[132:135], a[140:143], v[80:95]
    s_add_u32 s68, s68, 4096
    s_cmp_eq_u32 s68, 57344
    s_cselect_b32 s68, 0, s68
    buffer_load_dwordx4 v[120:123], v3, s[24:27], s68 offen offset:1024 sc1
    v_max3_u32 v28, v28, v128, v132
    v_mfma_f32_32x32x16_bf16 v[64:79], v[132:135], a[136:139], v[64:79]
    v_lshlrev_b32_e64 v148, 16, v10
    v_and_b32 v149, 0xffff0000, v10
    v_lshlrev_b32 v150, 16, v11
    s_waitcnt vmcnt(8)
    v_mfma_f32_32x32x16_bf16 v[80:95], v[136:139], a[148:151], v[80:95]
    buffer_load_dwordx4 v[124:127], v3, s[24:27], s68 offen offset:3072 sc1
    v_mfma_f32_32x32x16_bf16 v[64:79], v[136:139], a[144:147], v[64:79]
    v_and_b32 v151, 0xffff0000, v11
    s_waitcnt lgkmcnt(0)
    s_barrier
    ds_read_b128 v[40:43], v20 offset:0
    s_waitcnt vmcnt(8)
    v_mfma_f32_32x32x16_bf16 v[80:95], v[140:143], a[156:159], v[80:95]
    s_add_u32 s68, s68, 4096
    s_cmp_eq_u32 s68, 57344
    s_cselect_b32 s68, 0, s68
    buffer_load_dwordx4 v[128:131], v3, s[24:27], s68 offen offset:1024 sc1
    v_max3_u32 v28, v28, v136, v140
    v_mfma_f32_32x32x16_bf16 v[64:79], v[140:143], a[152:155], v[64:79]
    ds_read_b128 v[48:51], v20 offset:2048
    ds_read_b128 v[56:59], v20 offset:4096
    ds_read_b128 v[44:47], v20 offset:1024
    s_waitcnt vmcnt(8)
    v_mfma_f32_32x32x16_bf16 v[80:95], v[96:99], a[164:167], v[80:95]
    buffer_load_dwordx4 v[132:135], v3, s[24:27], s68 offen offset:3072 sc1
    v_mfma_f32_32x32x16_bf16 v[64:79], v[96:99], a[160:163], v[64:79]
    ds_read_b128 v[52:55], v20 offset:3072
    ds_read_b128 v[60:63], v20 offset:5120
    v_add_f32 v32, v32, v19
    s_waitcnt vmcnt(8)
    v_mfma_f32_32x32x16_bf16 v[80:95], v[100:103], a[172:175], v[80:95]
    s_add_u32 s68, s68, 4096
    s_cmp_eq_u32 s68, 57344
    s_cselect_b32 s68, 0, s68
    buffer_load_dwordx4 v[136:139], v3, s[24:27], s68 offen offset:1024 sc1
    v_max3_u32 v28, v28, v96, v100
    v_mfma_f32_32x32x16_bf16 v[64:79], v[100:103], a[168:171], v[64:79]
    v_add_f32_e64 v33, v33, v19
    v_add_f32_e64 v34, v34, v19
    v_add_f32 v35, v35, v19
    s_waitcnt vmcnt(8)
    v_mfma_f32_32x32x16_bf16 v[80:95], v[104:107], a[180:183], v[80:95]
    buffer_load_dwordx4 v[140:143], v3, s[24:27], s68 offen offset:3072 sc1
    v_mfma_f32_32x32x16_bf16 v[64:79], v[104:107], a[176:179], v[64:79]
    v_add_f32_e64 v36, v36, v19
    v_add_f32_e64 v37, v37, v19
    v_add_f32_e64 v38, v38, v19
    s_waitcnt vmcnt(8)
    v_mfma_f32_32x32x16_bf16 v[80:95], v[108:111], a[188:191], v[80:95]
    s_add_u32 s68, s68, 4096
    s_cmp_eq_u32 s68, 57344
    s_cselect_b32 s68, 0, s68
    buffer_load_dwordx4 v[96:99], v3, s[24:27], s68 offen offset:1024 sc1
    v_max3_u32 v28, v28, v104, v108
    v_mfma_f32_32x32x16_bf16 v[64:79], v[108:111], a[184:187], v[64:79]
    v_add_f32 v39, v39, v19
    s_waitcnt lgkmcnt(5)
    v_add_f32_e64 v32, v32, v40
    v_add_f32 v33, v33, v41
    s_waitcnt vmcnt(8)
    v_mfma_f32_32x32x16_bf16 v[80:95], v[112:115], a[196:199], v[80:95]
    buffer_load_dwordx4 v[100:103], v3, s[24:27], s68 offen offset:3072 sc1
    v_mfma_f32_32x32x16_bf16 v[64:79], v[112:115], a[192:195], v[64:79]
    v_add_f32_e64 v34, v34, v42
    v_add_f32 v35, v35, v43
    s_waitcnt lgkmcnt(4)
    v_add_f32_e64 v32, v32, v48
    s_waitcnt vmcnt(8)
    v_mfma_f32_32x32x16_bf16 v[80:95], v[116:119], a[204:207], v[80:95]
    s_add_u32 s68, s68, 4096
    s_cmp_eq_u32 s68, 57344
    s_cselect_b32 s68, 0, s68
    buffer_load_dwordx4 v[104:107], v3, s[24:27], s68 offen offset:1024 sc1
    v_max3_u32 v28, v28, v112, v116
    v_mfma_f32_32x32x16_bf16 v[64:79], v[116:119], a[200:203], v[64:79]
    v_add_f32_e64 v33, v33, v49
    v_add_f32_e64 v34, v34, v50
    v_add_f32 v35, v35, v51
    s_waitcnt vmcnt(8)
    v_mfma_f32_32x32x16_bf16 v[80:95], v[120:123], a[212:215], v[80:95]
    buffer_load_dwordx4 v[108:111], v3, s[24:27], s68 offen offset:3072 sc1
    v_mfma_f32_32x32x16_bf16 v[64:79], v[120:123], a[208:211], v[64:79]
    s_waitcnt lgkmcnt(3)
    v_add_f32 v32, v32, v56
    v_add_f32_e64 v33, v33, v57
    v_add_f32_e64 v34, v34, v58
    s_waitcnt vmcnt(8)
    v_mfma_f32_32x32x16_bf16 v[80:95], v[124:127], a[220:223], v[80:95]
    s_add_u32 s68, s68, 4096
    s_cmp_eq_u32 s68, 57344
    s_cselect_b32 s68, 0, s68
    buffer_load_dwordx4 v[112:115], v3, s[24:27], s68 offen offset:1024 sc1
    v_max3_u32 v28, v28, v120, v124
    v_mfma_f32_32x32x16_bf16 v[64:79], v[124:127], a[216:219], v[64:79]
    v_add_f32 v35, v35, v59
    s_waitcnt lgkmcnt(2)
    v_add_f32_e64 v36, v36, v44
    v_add_f32 v37, v37, v45
    s_waitcnt vmcnt(8)
    v_mfma_f32_32x32x16_bf16 v[80:95], v[128:131], a[228:231], v[80:95]
    buffer_load_dwordx4 v[116:119], v3, s[24:27], s68 offen offset:3072 sc1
    v_mfma_f32_32x32x16_bf16 v[64:79], v[128:131], a[224:227], v[64:79]
    v_add_f32_e64 v38, v38, v46
    v_add_f32 v39, v39, v47
    s_waitcnt lgkmcnt(1)
    v_add_f32_e64 v36, v36, v52
    s_waitcnt vmcnt(8)
    v_mfma_f32_32x32x16_bf16 v[80:95], v[132:135], a[236:239], v[80:95]
    s_add_u32 s68, s68, 4096
    s_cmp_eq_u32 s68, 57344
    s_cselect_b32 s68, 0, s68
    buffer_load_dwordx4 v[120:123], v3, s[24:27], s68 offen offset:1024 sc1
    v_max3_u32 v28, v28, v128, v132
    v_mfma_f32_32x32x16_bf16 v[64:79], v[132:135], a[232:235], v[64:79]
    v_add_f32_e64 v37, v37, v53
    v_add_f32_e64 v38, v38, v54
    v_add_f32 v39, v39, v55
    s_waitcnt vmcnt(8)
    v_mfma_f32_32x32x16_bf16 v[80:95], v[136:139], a[244:247], v[80:95]
    buffer_load_dwordx4 v[124:127], v3, s[24:27], s68 offen offset:3072 sc1
    v_mfma_f32_32x32x16_bf16 v[64:79], v[136:139], a[240:243], v[64:79]
    s_waitcnt lgkmcnt(0)
    v_add_f32 v36, v36, v60
    v_add_f32_e64 v37, v37, v61
    v_add_f32_e64 v38, v38, v62
    s_waitcnt vmcnt(8)
    v_mfma_f32_32x32x16_bf16 v[80:95], v[140:143], a[252:255], v[80:95]
    s_add_u32 s68, s68, 4096
    s_cmp_eq_u32 s68, 57344
    s_cselect_b32 s68, 0, s68
    buffer_load_dwordx4 v[128:131], v3, s[24:27], s68 offen offset:1024 sc1
    v_max3_u32 v28, v28, v136, v140
    v_mfma_f32_32x32x16_bf16 v[64:79], v[140:143], a[248:251], v[64:79]
    v_add_f32_e64 v39, v39, v63
    v_add_f32_e64 v32, v32, v144
    v_add_f32 v33, v33, v145
    s_waitcnt vmcnt(8)
    v_mfma_f32_32x32x16_bf16 v[80:95], v[96:99], v[164:167], v[80:95]
    buffer_load_dwordx4 v[132:135], v3, s[24:27], s68 offen offset:3072 sc1
    v_mfma_f32_32x32x16_bf16 v[64:79], v[96:99], v[160:163], v[64:79]
    v_add_f32_e64 v34, v34, v146
    v_add_f32_e64 v35, v35, v147
    v_add_f32_e64 v36, v36, v148
    s_waitcnt vmcnt(8)
    v_mfma_f32_32x32x16_bf16 v[80:95], v[100:103], v[172:175], v[80:95]
    s_add_u32 s68, s68, 4096
    s_cmp_eq_u32 s68, 57344
    s_cselect_b32 s68, 0, s68
    buffer_load_dwordx4 v[136:139], v3, s[24:27], s68 offen offset:1024 sc1
    v_max3_u32 v28, v28, v96, v100
    v_mfma_f32_32x32x16_bf16 v[64:79], v[100:103], v[168:171], v[64:79]
    v_add_f32_e64 v37, v37, v149
    v_add_f32_e64 v38, v38, v150
    v_add_f32 v39, v39, v151
    s_waitcnt vmcnt(8)
    v_mfma_f32_32x32x16_bf16 v[80:95], v[104:107], v[180:183], v[80:95]
    buffer_load_dwordx4 v[140:143], v3, s[24:27], s68 offen offset:3072 sc1
    v_mfma_f32_32x32x16_bf16 v[64:79], v[104:107], v[176:179], v[64:79]
    v_cvt_pk_bf16_f32 v8, v32, v33
    v_cvt_pk_bf16_f32 v9, v34, v35
    v_cvt_pk_bf16_f32 v10, v36, v37
    v_cvt_pk_bf16_f32 v11, v38, v39
    s_nop 0
    v_permlane32_swap_b32 v8, v10
    v_permlane32_swap_b32 v9, v11
    buffer_store_dwordx4 v[8:11], v22, s[28:31], 0 offen offset:0
    s_waitcnt vmcnt(9)
    v_mfma_f32_32x32x16_bf16 v[80:95], v[108:111], v[188:191], v[80:95]
    v_max3_u32 v28, v28, v104, v108
    v_mfma_f32_32x32x16_bf16 v[64:79], v[108:111], v[184:187], v[64:79]
    s_waitcnt vmcnt(8)
    v_mfma_f32_32x32x16_bf16 v[80:95], v[112:115], v[196:199], v[80:95]
    v_mfma_f32_32x32x16_bf16 v[64:79], v[112:115], v[192:195], v[64:79]
    s_waitcnt vmcnt(7)
    v_mfma_f32_32x32x16_bf16 v[80:95], v[116:119], v[204:207], v[80:95]
    v_max3_u32 v28, v28, v112, v116
    v_mfma_f32_32x32x16_bf16 v[64:79], v[116:119], v[200:203], v[64:79]
    s_waitcnt vmcnt(6)
    v_mfma_f32_32x32x16_bf16 v[80:95], v[120:123], v[212:215], v[80:95]
    v_mfma_f32_32x32x16_bf16 v[64:79], v[120:123], v[208:211], v[64:79]
    s_waitcnt vmcnt(5)
    v_mfma_f32_32x32x16_bf16 v[80:95], v[124:127], v[220:223], v[80:95]
    v_max3_u32 v28, v28, v120, v124
    v_mfma_f32_32x32x16_bf16 v[64:79], v[124:127], v[216:219], v[64:79]
    s_waitcnt vmcnt(4)
    v_mfma_f32_32x32x16_bf16 v[80:95], v[128:131], v[228:231], v[80:95]
    v_mfma_f32_32x32x16_bf16 v[64:79], v[128:131], v[224:227], v[64:79]
    s_waitcnt vmcnt(3)
    v_mfma_f32_32x32x16_bf16 v[80:95], v[132:135], v[236:239], v[80:95]
    v_max3_u32 v28, v28, v128, v132
    v_mfma_f32_32x32x16_bf16 v[64:79], v[132:135], v[232:235], v[64:79]
    s_waitcnt vmcnt(2)
    v_mfma_f32_32x32x16_bf16 v[80:95], v[136:139], v[244:247], v[80:95]
    v_mfma_f32_32x32x16_bf16 v[64:79], v[136:139], v[240:243], v[64:79]
    s_waitcnt vmcnt(1)
    v_mfma_f32_32x32x16_bf16 v[80:95], v[140:143], v[252:255], v[80:95]
    v_max3_u32 v28, v28, v136, v140
    v_mfma_f32_32x32x16_bf16 v[64:79], v[140:143], v[248:251], v[64:79]
    v_cmp_eq_u32_e64 vcc, -1, v28
    s_cbranch_vccnz VBAD_162
VOK_161:
BACK_160:
    v_lshl_add_u32 v155, v5, 1, v153
    s_nop 6
    ds_write_b128 v155, v[80:83] offset:14336
    ds_write_b128 v155, v[84:87] offset:15360
    ds_write_b128 v6, v[88:91] offset:6144
    ds_write_b128 v6, v[92:95] offset:7168
    v_lshl_add_u32 v154, v4, 1, v153
    ds_write_b128 v154, v[72:75] offset:12288
    ds_write_b128 v154, v[76:79] offset:13312
    v_lshlrev_b32_e64 v144, 16, v12
    v_and_b32 v145, 0xffff0000, v12
    v_lshlrev_b32_e64 v146, 16, v13
    v_and_b32 v147, 0xffff0000, v13
    v_lshlrev_b32_e64 v148, 16, v14
    v_and_b32 v149, 0xffff0000, v14
    v_lshlrev_b32_e64 v150, 16, v15
    v_and_b32 v151, 0xffff0000, v15
    v_pk_add_f32 v[144:145], v[144:145], v[18:19] op_sel:[0,1] op_sel_hi:[1,1]
    v_pk_add_f32 v[146:147], v[146:147], v[18:19] op_sel:[0,1] op_sel_hi:[1,1]
    v_pk_add_f32 v[148:149], v[148:149], v[18:19] op_sel:[0,1] op_sel_hi:[1,1]
    v_pk_add_f32 v[150:151], v[150:151], v[18:19] op_sel:[0,1] op_sel_hi:[1,1]
    v_pk_add_f32 v[64:65], v[64:65], v[144:145]
    v_pk_add_f32 v[66:67], v[66:67], v[146:147]
    v_pk_add_f32 v[68:69], v[68:69], v[148:149]
    v_pk_add_f32 v[70:71], v[70:71], v[150:151]
    v_lshl_add_u32 v154, v20, 1, v153
    s_waitcnt lgkmcnt(0)
    s_barrier
    ds_read_b128 v[32:35], v154 offset:12288
    ds_read_b128 v[40:43], v154 offset:14336
    ds_read_b128 v[48:51], v20 offset:6144
    ds_read_b128 v[36:39], v154 offset:13312
    ds_read_b128 v[44:47], v154 offset:15360
    ds_read_b128 v[52:55], v20 offset:7168
    s_waitcnt lgkmcnt(4)
    v_pk_add_f32 v[32:33], v[32:33], v[40:41]
    v_pk_add_f32 v[34:35], v[34:35], v[42:43]
    s_waitcnt lgkmcnt(3)
    v_pk_add_f32 v[64:65], v[64:65], v[48:49]
    v_pk_add_f32 v[66:67], v[66:67], v[50:51]
    v_pk_add_f32 v[64:65], v[64:65], v[32:33]
    v_pk_add_f32 v[66:67], v[66:67], v[34:35]
    s_waitcnt lgkmcnt(1)
    v_pk_add_f32 v[36:37], v[36:37], v[44:45]
    v_pk_add_f32 v[38:39], v[38:39], v[46:47]
    s_waitcnt lgkmcnt(0)
    v_pk_add_f32 v[68:69], v[68:69], v[52:53]
    v_pk_add_f32 v[70:71], v[70:71], v[54:55]
    v_pk_add_f32 v[68:69], v[68:69], v[36:37]
    v_pk_add_f32 v[70:71], v[70:71], v[38:39]
    v_cvt_pk_bf16_f32 v12, v64, v65
    v_cvt_pk_bf16_f32 v13, v66, v67
    v_cvt_pk_bf16_f32 v14, v68, v69
    v_cvt_pk_bf16_f32 v15, v70, v71
    s_nop 0
    v_permlane32_swap_b32 v12, v14
    v_permlane32_swap_b32 v13, v15
    buffer_store_dwordx4 v[12:15], v22, s[28:31], 0 offen offset:64
    s_endpgm
RED_2:
    s_lshr_b32 s81, s79, 2
    s_mul_i32 s81, s81, 40960
    s_and_b32 s64, s79, 3
    s_mul_i32 s64, s64, 640
    s_add_u32 s81, s81, s64
    s_add_u32 s81, s81, 0x8000
    s_mov_b32 exec_lo, 0xffffffff
    s_mov_b32 exec_hi, 0x7
    s_mov_b32 s65, s81
    buffer_load_dwordx4 v[128:131], v1, s[24:27], s65 offen offset:0 sc1
    buffer_load_dwordx4 v[132:135], v1, s[24:27], s65 offen offset:2560 sc1
    s_add_u32 s65, s65, 5120
    buffer_load_dwordx4 v[136:139], v1, s[24:27], s65 offen offset:0 sc1
    buffer_load_dwordx4 v[140:143], v1, s[24:27], s65 offen offset:2560 sc1
    s_add_u32 s65, s65, 5120
    buffer_load_dwordx4 v[144:147], v1, s[24:27], s65 offen offset:0 sc1
    buffer_load_dwordx4 v[148:151], v1, s[24:27], s65 offen offset:2560 sc1
    s_add_u32 s65, s65, 5120
    buffer_load_dwordx4 v[152:155], v1, s[24:27], s65 offen offset:0 sc1
    buffer_load_dwordx4 v[156:159], v1, s[24:27], s65 offen offset:2560 sc1
    s_add_u32 s65, s65, 5120
    buffer_load_dwordx4 v[160:163], v1, s[24:27], s65 offen offset:0 sc1
    buffer_load_dwordx4 v[164:167], v1, s[24:27], s65 offen offset:2560 sc1
    s_add_u32 s65, s65, 5120
    buffer_load_dwordx4 v[168:171], v1, s[24:27], s65 offen offset:0 sc1
    buffer_load_dwordx4 v[172:175], v1, s[24:27], s65 offen offset:2560 sc1
    s_add_u32 s65, s65, 5120
    buffer_load_dwordx4 v[176:179], v1, s[24:27], s65 offen offset:0 sc1
    buffer_load_dwordx4 v[180:183], v1, s[24:27], s65 offen offset:2560 sc1
    s_add_u32 s65, s65, 5120
    buffer_load_dwordx4 v[184:187], v1, s[24:27], s65 offen offset:0 sc1
    buffer_load_dwordx4 v[188:191], v1, s[24:27], s65 offen offset:2560 sc1
    s_mov_b64 exec, -1
    s_nop 1
    s_branch NOA1E_1
PRT_6:
POLL_7:
    s_sub_u32 s58, s58, 1
    s_cbranch_scc0 PGO_8
    s_mov_b32 s58, 0
    s_branch PDONE_5
PGO_8:
    s_mov_b32 s65, s81
    buffer_load_dwordx4 v[128:131], v1, s[24:27], s65 offen offset:0 sc1
    buffer_load_dwordx4 v[132:135], v1, s[24:27], s65 offen offset:2560 sc1
    s_add_u32 s65, s65, 5120
    buffer_load_dwordx4 v[136:139], v1, s[24:27], s65 offen offset:0 sc1
    buffer_load_dwordx4 v[140:143], v1, s[24:27], s65 offen offset:2560 sc1
    s_add_u32 s65, s65, 5120
    buffer_load_dwordx4 v[144:147], v1, s[24:27], s65 offen offset:0 sc1
    buffer_load_dwordx4 v[148:151], v1, s[24:27], s65 offen offset:2560 sc1
    s_add_u32 s65, s65, 5120
    buffer_load_dwordx4 v[152:155], v1, s[24:27], s65 offen offset:0 sc1
    buffer_load_dwordx4 v[156:159], v1, s[24:27], s65 offen offset:2560 sc1
    s_add_u32 s65, s65, 5120
    buffer_load_dwordx4 v[160:163], v1, s[24:27], s65 offen offset:0 sc1
    buffer_load_dwordx4 v[164:167], v1, s[24:27], s65 offen offset:2560 sc1
    s_add_u32 s65, s65, 5120
    buffer_load_dwordx4 v[168:171], v1, s[24:27], s65 offen offset:0 sc1
    buffer_load_dwordx4 v[172:175], v1, s[24:27], s65 offen offset:2560 sc1
    s_add_u32 s65, s65, 5120
    buffer_load_dwordx4 v[176:179], v1, s[24:27], s65 offen offset:0 sc1
    buffer_load_dwordx4 v[180:183], v1, s[24:27], s65 offen offset:2560 sc1
    s_add_u32 s65, s65, 5120
    buffer_load_dwordx4 v[184:187], v1, s[24:27], s65 offen offset:0 sc1
    buffer_load_dwordx4 v[188:191], v1, s[24:27], s65 offen offset:2560 sc1
    s_waitcnt vmcnt(0)
    s_nop 0
    v_max3_u32 v7, v128, v132, v136
    v_min3_u32 v5, v128, v132, v136
    v_max3_u32 v7, v7, v140, v144
    v_min3_u32 v5, v5, v140, v144
    v_max3_u32 v7, v7, v148, v152
    v_min3_u32 v5, v5, v148, v152
    v_max3_u32 v7, v7, v156, v160
    v_min3_u32 v5, v5, v156, v160
    v_max3_u32 v7, v7, v164, v168
    v_min3_u32 v5, v5, v164, v168
    v_max3_u32 v7, v7, v172, v176
    v_min3_u32 v5, v5, v172, v176
    v_max3_u32 v7, v7, v180, v184
    v_min3_u32 v5, v5, v180, v184
    v_max_u32 v7, v7, v188
    v_min_u32 v5, v5, v188
    v_cmp_eq_u32_e64 vcc, -1, v7
    v_readlane_b32 s62, v7, 34
    v_readlane_b32 s63, v5, 34
    s_xor_b32 s62, s62, s101
    s_xor_b32 s63, s63, s101
    s_or_b32 s62, s62, s63
    s_or_b32 vcc_lo, vcc_lo, s62
    s_or_b64 vcc, vcc, vcc
    s_cbranch_vccnz POLL_7
    s_branch PDONE_5
RED_4:
    s_mul_i32 s64, s79, 384
    s_add_u32 s64, s64, 0x2000
    v_lshlrev_b32_e64 v6, 3, v0
    s_mov_b32 exec_lo, 0xffffffff
    s_mov_b32 exec_hi, 0x7
    s_waitcnt vmcnt(3)
    v_max3_u32 v7, v128, v132, v136
    v_min3_u32 v5, v128, v132, v136
    v_max3_u32 v7, v7, v140, v144
    v_min3_u32 v5, v5, v140, v144
    v_max3_u32 v7, v7, v148, v152
    v_min3_u32 v5, v5, v148, v152
    v_max3_u32 v7, v7, v156, v160
    v_min3_u32 v5, v5, v156, v160
    v_max3_u32 v7, v7, v164, v168
    v_min3_u32 v5, v5, v164, v168
    v_max3_u32 v7, v7, v172, v176
    v_min3_u32 v5, v5, v172, v176
    v_max3_u32 v7, v7, v180, v184
    v_min3_u32 v5, v5, v180, v184
    v_max_u32 v7, v7, v188
    v_min_u32 v5, v5, v188
    v_cmp_eq_u32_e64 vcc, -1, v7
    v_readlane_b32 s62, v7, 34
    v_readlane_b32 s63, v5, 34
    s_xor_b32 s62, s62, s101
    s_xor_b32 s63, s63, s101
    s_or_b32 s62, s62, s63
    s_or_b32 vcc_lo, vcc_lo, s62
    s_or_b64 vcc, vcc, vcc
    s_cbranch_vccnz PRT_6
PDONE_5:
    v_pk_add_f32 v[128:129], v[128:129], v[160:161]
    v_pk_add_f32 v[130:131], v[130:131], v[162:163]
    v_pk_add_f32 v[132:133], v[132:133], v[164:165]
    v_pk_add_f32 v[134:135], v[134:135], v[166:167]
    v_pk_add_f32 v[136:137], v[136:137], v[168:169]
    v_pk_add_f32 v[138:139], v[138:139], v[170:171]
    v_pk_add_f32 v[140:141], v[140:141], v[172:173]
    v_pk_add_f32 v[142:143], v[142:143], v[174:175]
    v_pk_add_f32 v[144:145], v[144:145], v[176:177]
    v_pk_add_f32 v[146:147], v[146:147], v[178:179]
    v_pk_add_f32 v[148:149], v[148:149], v[180:181]
    v_pk_add_f32 v[150:151], v[150:151], v[182:183]
    v_pk_add_f32 v[152:153], v[152:153], v[184:185]
    v_pk_add_f32 v[154:155], v[154:155], v[186:187]
    v_pk_add_f32 v[156:157], v[156:157], v[188:189]
    v_pk_add_f32 v[158:159], v[158:159], v[190:191]
    v_pk_add_f32 v[128:129], v[128:129], v[144:145]
    v_pk_add_f32 v[130:131], v[130:131], v[146:147]
    v_pk_add_f32 v[132:133], v[132:133], v[148:149]
    v_pk_add_f32 v[134:135], v[134:135], v[150:151]
    v_pk_add_f32 v[136:137], v[136:137], v[152:153]
    v_pk_add_f32 v[138:139], v[138:139], v[154:155]
    v_pk_add_f32 v[140:141], v[140:141], v[156:157]
    v_pk_add_f32 v[142:143], v[142:143], v[158:159]
    v_pk_add_f32 v[128:129], v[128:129], v[136:137]
    v_pk_add_f32 v[130:131], v[130:131], v[138:139]
    v_pk_add_f32 v[132:133], v[132:133], v[140:141]
    v_pk_add_f32 v[134:135], v[134:135], v[142:143]
    v_pk_add_f32 v[128:129], v[128:129], v[132:133]
    v_pk_add_f32 v[130:131], v[130:131], v[134:135]
    v_cvt_pk_bf16_f32 v132, v128, v129
    v_cvt_pk_bf16_f32 v133, v130, v131
    s_nop 0
    s_nop 0
    v_mov_b32_dpp v134, v132 quad_perm:[1,1,3,3] row_mask:0xf bank_mask:0xf
    v_mov_b32_dpp v135, v133 quad_perm:[1,1,3,3] row_mask:0xf bank_mask:0xf
    v_writelane_b32 v132, s101, 34
    s_mov_b32 exec_lo, 0x55555555
    s_mov_b32 exec_hi, 0x5555
    buffer_store_dwordx4 v[132:135], v6, s[24:27], s64 offen sc1
    s_mov_b64 exec, -1
    s_nop 1
    s_nop 1
    s_branch NOA1_3
FB_11:
    buffer_load_dword v7, v6, s[24:27], s62 offen sc1
    s_waitcnt vmcnt(0)
    v_cmp_ne_u32 vcc, s101, v7
    s_cbranch_vccz FBM_13
POLL_15:
    s_sleep 2
    s_sub_u32 s58, s58, 1
    s_cbranch_scc0 PGO_16
    s_mov_b32 s58, 0
    s_branch FBM_13
PGO_16:
    buffer_load_dword v7, v6, s[24:27], s62 offen sc1
    s_waitcnt vmcnt(0)
    v_cmp_ne_u32_e64 vcc, s101, v7
    s_cbranch_vccnz POLL_15
    s_branch FBM_13
FBM_13:
    s_mov_b32 s66, s86
    buffer_load_dwordx4 v[192:195], v1, s[24:27], s66 offen offset:0 sc1
    buffer_load_dwordx4 v[196:199], v1, s[24:27], s66 offen offset:1024 sc1
    buffer_load_dwordx4 v[200:203], v1, s[24:27], s66 offen offset:2048 sc1
    buffer_load_dwordx4 v[204:207], v1, s[24:27], s66 offen offset:3072 sc1
    s_add_u32 s66, s66, 4096
    buffer_load_dwordx4 v[208:211], v1, s[24:27], s66 offen offset:0 sc1
    buffer_load_dwordx4 v[212:215], v1, s[24:27], s66 offen offset:1024 sc1
    buffer_load_dwordx4 v[216:219], v1, s[24:27], s66 offen offset:2048 sc1
    buffer_load_dwordx4 v[220:223], v1, s[24:27], s66 offen offset:3072 sc1
    s_add_u32 s66, s66, 4096
    buffer_load_dwordx4 v[224:227], v1, s[24:27], s66 offen offset:0 sc1
    buffer_load_dwordx4 v[228:231], v1, s[24:27], s66 offen offset:1024 sc1
    buffer_load_dwordx4 v[232:235], v1, s[24:27], s66 offen offset:2048 sc1
    buffer_load_dwordx4 v[236:239], v1, s[24:27], s66 offen offset:3072 sc1
    s_add_u32 s66, s66, 4096
    buffer_load_dwordx4 v[240:243], v1, s[24:27], s66 offen offset:0 sc1
    buffer_load_dwordx4 v[244:247], v1, s[24:27], s66 offen offset:1024 sc1
    buffer_load_dwordx4 v[248:251], v1, s[24:27], s66 offen offset:2048 sc1
    buffer_load_dwordx4 v[252:255], v1, s[24:27], s66 offen offset:3072 sc1
    s_nop 1
    s_nop 0
    s_branch FBB_12
PQR_9:
    s_mov_b32 s66, s86
    buffer_load_dwordx4 v[192:195], v1, s[24:27], s66 offen offset:0 sc1
    buffer_load_dwordx4 v[196:199], v1, s[24:27], s66 offen offset:1024 sc1
    buffer_load_dwordx4 v[200:203], v1, s[24:27], s66 offen offset:2048 sc1
    buffer_load_dwordx4 v[204:207], v1, s[24:27], s66 offen offset:3072 sc1
    s_add_u32 s66, s66, 4096
    buffer_load_dwordx4 v[208:211], v1, s[24:27], s66 offen offset:0 sc1
    buffer_load_dwordx4 v[212:215], v1, s[24:27], s66 offen offset:1024 sc1
    buffer_load_dwordx4 v[216:219], v1, s[24:27], s66 offen offset:2048 sc1
    buffer_load_dwordx4 v[220:223], v1, s[24:27], s66 offen offset:3072 sc1
    s_add_u32 s66, s66, 4096
    buffer_load_dwordx4 v[224:227], v1, s[24:27], s66 offen offset:0 sc1
    buffer_load_dwordx4 v[228:231], v1, s[24:27], s66 offen offset:1024 sc1
    buffer_load_dwordx4 v[232:235], v1, s[24:27], s66 offen offset:2048 sc1
    buffer_load_dwordx4 v[236:239], v1, s[24:27], s66 offen offset:3072 sc1
    s_add_u32 s66, s66, 4096
    buffer_load_dwordx4 v[240:243], v1, s[24:27], s66 offen offset:0 sc1
    buffer_load_dwordx4 v[244:247], v1, s[24:27], s66 offen offset:1024 sc1
    buffer_load_dwordx4 v[248:251], v1, s[24:27], s66 offen offset:2048 sc1
    buffer_load_dwordx4 v[252:255], v1, s[24:27], s66 offen offset:3072 sc1
    s_waitcnt vmcnt(0)
    s_nop 1
    s_branch GO_10
P2REDO_17:
    s_mov_b32 s66, s86
    buffer_load_dwordx4 v[192:195], v1, s[24:27], s66 offen offset:0 sc1
    buffer_load_dwordx4 v[196:199], v1, s[24:27], s66 offen offset:1024 sc1
    buffer_load_dwordx4 v[200:203], v1, s[24:27], s66 offen offset:2048 sc1
    buffer_load_dwordx4 v[204:207], v1, s[24:27], s66 offen offset:3072 sc1
    s_add_u32 s66, s66, 4096
    buffer_load_dwordx4 v[208:211], v1, s[24:27], s66 offen offset:0 sc1
    buffer_load_dwordx4 v[212:215], v1, s[24:27], s66 offen offset:1024 sc1
    buffer_load_dwordx4 v[216:219], v1, s[24:27], s66 offen offset:2048 sc1
    buffer_load_dwordx4 v[220:223], v1, s[24:27], s66 offen offset:3072 sc1
    s_add_u32 s66, s66, 4096
    buffer_load_dwordx4 v[224:227], v1, s[24:27], s66 offen offset:0 sc1
    buffer_load_dwordx4 v[228:231], v1, s[24:27], s66 offen offset:1024 sc1
    buffer_load_dwordx4 v[232:235], v1, s[24:27], s66 offen offset:2048 sc1
    buffer_load_dwordx4 v[236:239], v1, s[24:27], s66 offen offset:3072 sc1
    s_add_u32 s66, s66, 4096
    buffer_load_dwordx4 v[240:243], v1, s[24:27], s66 offen offset:0 sc1
    buffer_load_dwordx4 v[244:247], v1, s[24:27], s66 offen offset:1024 sc1
    buffer_load_dwordx4 v[248:251], v1, s[24:27], s66 offen offset:2048 sc1
    buffer_load_dwordx4 v[252:255], v1, s[24:27], s66 offen offset:3072 sc1
    s_nop 1
    s_branch P2REDO2_18
FB_20:
    buffer_load_dword v7, v29, s[24:27], s87 offen offset:272 sc1
    s_waitcnt vmcnt(0)
    v_cmp_ne_u32 vcc, s101, v7
    s_cbranch_vccz FBM_22
POLL_24:
    s_sleep 2
    s_sub_u32 s58, s58, 1
    s_cbranch_scc0 PGO_25
    s_mov_b32 s58, 0
    s_branch FBM_22
PGO_25:
    buffer_load_dword v7, v29, s[24:27], s87 offen offset:272 sc1
    s_waitcnt vmcnt(0)
    v_cmp_ne_u32_e64 vcc, s101, v7
    s_cbranch_vccnz POLL_24
    s_branch FBM_22
FBM_22:
    s_mov_b32 s68, s87
    buffer_load_dwordx4 v[128:131], v28, s[24:27], s68 offen offset:0 sc1
    buffer_load_dwordx4 v[132:135], v28, s[24:27], s68 offen offset:768 sc1
    buffer_load_dwordx4 v[136:139], v28, s[24:27], s68 offen offset:1536 sc1
    buffer_load_dwordx4 v[140:143], v28, s[24:27], s68 offen offset:2304 sc1
    s_add_u32 s68, s68, 3072
    buffer_load_dwordx4 v[144:147], v28, s[24:27], s68 offen offset:0 sc1
    buffer_load_dwordx4 v[148:151], v28, s[24:27], s68 offen offset:768 sc1
    buffer_load_dwordx4 v[152:155], v28, s[24:27], s68 offen offset:1536 sc1
    buffer_load_dwordx4 v[156:159], v28, s[24:27], s68 offen offset:2304 sc1
    s_add_u32 s68, s68, 3072
    buffer_load_dwordx4 v[160:163], v28, s[24:27], s68 offen offset:0 sc1
    buffer_load_dwordx4 v[164:167], v28, s[24:27], s68 offen offset:768 sc1
    s_nop 1
    s_branch FBB_21
P2REDO2_18:
    s_mov_b32 s68, s87
    buffer_load_dwordx4 v[128:131], v28, s[24:27], s68 offen offset:0 sc1
    buffer_load_dwordx4 v[132:135], v28, s[24:27], s68 offen offset:768 sc1
    buffer_load_dwordx4 v[136:139], v28, s[24:27], s68 offen offset:1536 sc1
    buffer_load_dwordx4 v[140:143], v28, s[24:27], s68 offen offset:2304 sc1
    s_add_u32 s68, s68, 3072
    buffer_load_dwordx4 v[144:147], v28, s[24:27], s68 offen offset:0 sc1
    buffer_load_dwordx4 v[148:151], v28, s[24:27], s68 offen offset:768 sc1
    buffer_load_dwordx4 v[152:155], v28, s[24:27], s68 offen offset:1536 sc1
    buffer_load_dwordx4 v[156:159], v28, s[24:27], s68 offen offset:2304 sc1
    s_add_u32 s68, s68, 3072
    buffer_load_dwordx4 v[160:163], v28, s[24:27], s68 offen offset:0 sc1
    buffer_load_dwordx4 v[164:167], v28, s[24:27], s68 offen offset:768 sc1
    s_waitcnt vmcnt(0)
    s_nop 1
    s_branch GO_19
VBAD_27:
    s_waitcnt vmcnt(0)
    s_sub_u32 s58, s58, 64
    s_cbranch_scc0 P2REDO_17
    s_mov_b32 s58, 0
    s_nop 15
    s_nop 1
    s_branch VOK_26
PRT_29:
POLL_30:
    s_sleep 2
    s_sub_u32 s58, s58, 1
    s_cbranch_scc0 PGO_31
    s_mov_b32 s58, 0
    s_branch PDONE_28
PGO_31:
    buffer_load_dwordx2 v[128:129], v6, s[24:27], s89 offen offset:0 sc1
    buffer_load_dwordx2 v[130:131], v6, s[24:27], s89 offen offset:512 sc1
    buffer_load_dwordx2 v[132:133], v6, s[24:27], s89 offen offset:1024 sc1
    buffer_load_dwordx2 v[134:135], v6, s[24:27], s89 offen offset:1536 sc1
    buffer_load_dwordx2 v[136:137], v6, s[24:27], s89 offen offset:2048 sc1
    buffer_load_dwordx2 v[138:139], v6, s[24:27], s89 offen offset:2560 sc1
    buffer_load_dwordx2 v[140:141], v6, s[24:27], s89 offen offset:3072 sc1
    buffer_load_dwordx2 v[142:143], v6, s[24:27], s89 offen offset:3584 sc1
    s_waitcnt vmcnt(0)
    v_max3_u32 v7, v129, v131, v133
    v_max3_u32 v7, v7, v135, v137
    v_max3_u32 v7, v7, v139, v141
    v_max_u32 v7, v7, v143
    v_cmp_eq_u32 vcc, -1, v7
    s_cbranch_vccnz POLL_30
    s_branch PDONE_28
NONC_33:
    v_mov_b32 v4, s101
    s_mov_b64 exec, 1
    buffer_store_dword v4, off, s[24:27], 0 offset:0 sc1
    s_mov_b64 exec, -1
    s_nop 1
    s_branch NONW_32
FB_38:
    buffer_load_dword v7, v29, s[24:27], s91 offen offset:3836 sc1
    s_waitcnt vmcnt(0)
    v_cmp_eq_u32 vcc, -1, v7
    s_cbranch_vccz FBM_40
POLL_42:
    s_sleep 2
    s_sub_u32 s58, s58, 1
    s_cbranch_scc0 PGO_43
    s_mov_b32 s58, 0
    s_branch FBM_40
PGO_43:
    buffer_load_dword v7, v29, s[24:27], s91 offen offset:3836 sc1
    s_waitcnt vmcnt(0)
    v_cmp_eq_u32 vcc, -1, v7
    s_cbranch_vccnz POLL_42
    s_branch FBM_40
FBM_40:
    s_lshl_b32 s68, s77, 107
    buffer_load_dwordx4 v[96:99], v2, s[24:27], s68 offen offset:0 sc1
    buffer_load_dwordx4 v[100:103], v2, s[24:27], s68 offen offset:2048 sc1
    s_add_u32 s68, s68, 4096
    s_cmp_eq_u32 s68, 65536
    s_cselect_b32 s68, 0, s68
    buffer_load_dwordx4 v[104:107], v2, s[24:27], s68 offen offset:0 sc1
    buffer_load_dwordx4 v[108:111], v2, s[24:27], s68 offen offset:2048 sc1
    s_add_u32 s68, s68, 4096
    s_cmp_eq_u32 s68, 65536
    s_cselect_b32 s68, 0, s68
    buffer_load_dwordx4 v[112:115], v2, s[24:27], s68 offen offset:0 sc1
    buffer_load_dwordx4 v[116:119], v2, s[24:27], s68 offen offset:2048 sc1
    s_add_u32 s68, s68, 4096
    s_cmp_eq_u32 s68, 65536
    s_cselect_b32 s68, 0, s68
    buffer_load_dwordx4 v[120:123], v2, s[24:27], s68 offen offset:0 sc1
    buffer_load_dwordx4 v[124:127], v2, s[24:27], s68 offen offset:2048 sc1
    s_add_u32 s68, s68, 4096
    s_cmp_eq_u32 s68, 65536
    s_cselect_b32 s68, 0, s68
    buffer_load_dwordx4 v[128:131], v2, s[24:27], s68 offen offset:0 sc1
    s_nop 1
    s_branch FBB_39
SREDO_36:
    s_lshl_b32 s68, s77, 11
    buffer_load_dwordx4 v[96:99], v2, s[24:27], s68 offen offset:0 sc1
    buffer_load_dwordx4 v[100:103], v2, s[24:27], s68 offen offset:2048 sc1
    s_add_u32 s68, s68, 4096
    s_cmp_eq_u32 s68, 65536
    s_cselect_b32 s68, 0, s68
    buffer_load_dwordx4 v[104:107], v2, s[24:27], s68 offen offset:0 sc1
    buffer_load_dwordx4 v[108:111], v2, s[24:27], s68 offen offset:2048 sc1
    s_add_u32 s68, s68, 4096
    s_cmp_eq_u32 s68, 65536
    s_cselect_b32 s68, 0, s68
    buffer_load_dwordx4 v[112:115], v2, s[24:27], s68 offen offset:0 sc1
    buffer_load_dwordx4 v[116:119], v2, s[24:27], s68 offen offset:2048 sc1
    s_add_u32 s68, s68, 4096
    s_cmp_eq_u32 s68, 65536
    s_cselect_b32 s68, 0, s68
    buffer_load_dwordx4 v[120:123], v2, s[24:27], s68 offen offset:0 sc1
    buffer_load_dwordx4 v[124:127], v2, s[24:27], s68 offen offset:2048 sc1
    s_add_u32 s68, s68, 4096
    s_cmp_eq_u32 s68, 65536
    s_cselect_b32 s68, 0, s68
    buffer_load_dwordx4 v[128:131], v2, s[24:27], s68 offen offset:0 sc1
    s_waitcnt vmcnt(0)
    s_nop 1
    s_branch GO_37
VBAD_47:
    s_waitcnt vmcnt(0)
    s_sub_u32 s58, s58, 64
    s_cbranch_scc0 PLAIN_44
    s_mov_b32 s58, 0
    s_nop 15
    s_nop 1
    s_branch VOK_46
VBAD_51:
    s_waitcnt vmcnt(0)
    s_sub_u32 s58, s58, 64
    s_cbranch_scc0 PLAIN_48
    s_mov_b32 s58, 0
    s_nop 15
    s_nop 1
    s_branch VOK_50
FB_52:
    buffer_load_dword v7, v30, s[24:27], s93 offen offset:1020 sc1
    s_waitcnt vmcnt(0)
    v_cmp_eq_u32 vcc, -1, v7
    s_cbranch_vccz FBM_54
POLL_56:
    s_sleep 2
    s_sub_u32 s58, s58, 1
    s_cbranch_scc0 PGO_57
    s_mov_b32 s58, 0
    s_branch FBM_54
PGO_57:
    buffer_load_dword v7, v30, s[24:27], s93 offen offset:1020 sc1
    s_waitcnt vmcnt(0)
    v_cmp_eq_u32 vcc, -1, v7
    s_cbranch_vccnz POLL_56
    s_branch FBM_54
FBM_54:
    s_lshl_b32 s68, s78, 107
    buffer_load_dwordx4 v[112:115], v3, s[24:27], s68 offen offset:0 sc1
    buffer_load_dwordx4 v[116:119], v3, s[24:27], s68 offen offset:2048 sc1
    s_add_u32 s68, s68, 4096
    s_cmp_eq_u32 s68, 57344
    s_cselect_b32 s68, 0, s68
    buffer_load_dwordx4 v[120:123], v3, s[24:27], s68 offen offset:0 sc1
    buffer_load_dwordx4 v[124:127], v3, s[24:27], s68 offen offset:2048 sc1
    s_add_u32 s68, s68, 4096
    s_cmp_eq_u32 s68, 57344
    s_cselect_b32 s68, 0, s68
    buffer_load_dwordx4 v[128:131], v3, s[24:27], s68 offen offset:0 sc1
    buffer_load_dwordx4 v[132:135], v3, s[24:27], s68 offen offset:2048 sc1
    s_add_u32 s68, s68, 4096
    s_cmp_eq_u32 s68, 57344
    s_cselect_b32 s68, 0, s68
    buffer_load_dwordx4 v[136:139], v3, s[24:27], s68 offen offset:0 sc1
    buffer_load_dwordx4 v[140:143], v3, s[24:27], s68 offen offset:2048 sc1
    s_add_u32 s68, s68, 4096
    s_cmp_eq_u32 s68, 57344
    s_cselect_b32 s68, 0, s68
    buffer_load_dwordx4 v[96:99], v3, s[24:27], s68 offen offset:0 sc1
    buffer_load_dword v7, off, s[40:43], 0 offset:4094
    buffer_load_dword v7, off, s[40:43], 0 offset:4094
    buffer_load_dword v7, off, s[40:43], 0 offset:4094
    buffer_load_dword v7, off, s[40:43], 0 offset:4094
    buffer_load_dword v7, off, s[40:43], 0 offset:4094
    buffer_load_dword v7, off, s[40:43], 0 offset:4094
    buffer_load_dword v7, off, s[40:43], 0 offset:4094
    buffer_load_dword v7, off, s[40:43], 0 offset:4094
    buffer_load_dword v7, off, s[40:43], 0 offset:4094
    s_nop 1
    s_branch FBB_53
PRT_59:
POLL_60:
    s_sleep 2
    s_sub_u32 s58, s58, 1
    s_cbranch_scc0 PGO_61
    s_mov_b32 s58, 0
    s_branch PDONE_58
PGO_61:
    buffer_load_dword v7, v30, s[24:27], s93 offen offset:1020 sc1
    s_waitcnt vmcnt(0)
    v_cmp_eq_u32_e64 vcc, -1, v7
    s_cbranch_vccnz POLL_60
    s_branch PDONE_58
P3IDLE_34:
    v_lshrrev_b32_e64 v96, 2, v0
    v_lshlrev_b32_e64 v96, 12, v96
    v_and_b32_e64 v97, 3, v0
    v_lshl_add_u32 v96, v97, 7, v96
    s_bfe_u32 s62, s83, 0x20002
    s_mul_i32 s62, s62, 1835008
    s_and_b32 s63, s61, 7
    s_lshl_b32 s63, s63, 9
    s_add_u32 s62, s62, s63
    v_add_u32 v96, s62, v96
    s_add_u32 s63, s3, s78
    s_add_u32 s63, s63, 10
    s_sub_u32 s64, s63, 28
    s_cselect_b32 s63, s63, s64
    s_lshl_b32 s64, s63, 112
    buffer_load_dword v31, v96, s[20:23], s64 offen
    s_add_u32 s63, s63, 4
    s_sub_u32 s64, s63, 28
    s_cselect_b32 s63, s63, s64
    s_lshl_b32 s64, s63, 16
    buffer_load_dword v31, v96, s[20:23], s64 offen
    s_add_u32 s63, s63, 4
    s_sub_u32 s64, s63, 28
    s_cselect_b32 s63, s63, s64
    s_lshl_b32 s64, s63, 16
    buffer_load_dword v31, v96, s[20:23], s64 offen
    s_add_u32 s63, s63, 4
    s_sub_u32 s64, s63, 28
    s_cselect_b32 s63, s63, s64
    s_lshl_b32 s64, s63, 16
    buffer_load_dword v31, v96, s[20:23], s64 offen
    s_add_u32 s63, s63, 4
    s_sub_u32 s64, s63, 28
    s_cselect_b32 s63, s63, s64
    s_lshl_b32 s64, s63, 112
    buffer_load_dword v31, v96, s[20:23], s64 offen
    s_add_u32 s63, s63, 4
    s_add_u32 m0, s75, 10240
    s_add_u32 s80, s80, 65536
    s_cmp_eq_u32 s80, 1835008
    s_cselect_b32 s80, 0, s80
    buffer_load_dwordx4 v24, s[20:23], s80 offen lds
    buffer_load_dwordx4 v25, s[20:23], s80 offen offset:1024 lds
    s_waitcnt lgkmcnt(15)
    s_add_u32 m0, s75, 0
    s_add_u32 s80, s80, 65536
    s_cmp_eq_u32 s80, 1835008
    s_cselect_b32 s80, 0, s80
    buffer_load_dwordx4 v24, s[20:23], s80 offen lds
    buffer_load_dwordx4 v25, s[20:23], s80 offen offset:1024 lds
    s_waitcnt lgkmcnt(12)
    s_add_u32 m0, s75, 2048
    s_add_u32 s80, s80, 65536
    s_cmp_eq_u32 s80, 1835008
    s_cselect_b32 s80, 0, s80
    buffer_load_dwordx4 v24, s[20:23], s80 offen lds
    buffer_load_dwordx4 v25, s[20:23], s80 offen offset:1024 lds
    s_waitcnt lgkmcnt(8)
    s_add_u32 m0, s75, 4096
    s_add_u32 s80, s80, 65536
    s_cmp_eq_u32 s80, 1835008
    s_cselect_b32 s80, 0, s80
    buffer_load_dwordx4 v24, s[20:23], s80 offen lds
    buffer_load_dwordx4 v25, s[20:23], s80 offen offset:1024 lds
    s_waitcnt lgkmcnt(4)
    s_add_u32 m0, s75, 6144
    s_add_u32 s80, s80, 65536
    s_cmp_eq_u32 s80, 1835008
    s_cselect_b32 s80, 0, s80
    buffer_load_dwordx4 v24, s[20:23], s80 offen lds
    buffer_load_dwordx4 v25, s[20:23], s80 offen offset:1024 lds
    s_waitcnt lgkmcnt(0)
    s_add_u32 m0, s75, 8192
    s_add_u32 s80, s80, 65536
    s_cmp_eq_u32 s80, 1835008
    s_cselect_b32 s80, 0, s80
    buffer_load_dwordx4 v24, s[20:23], s80 offen lds
    buffer_load_dwordx4 v25, s[20:23], s80 offen offset:1024 lds
    buffer_load_dword v7, v30, s[24:27], s93 offen offset:1020 sc1
    s_waitcnt vmcnt(0)
    v_cmp_eq_u32 vcc, -1, v7
    s_cbranch_vccnz PRT_59
PDONE_58:
    s_lshl_b32 s68, s78, 11
    buffer_load_dwordx4 v[112:115], v3, s[24:27], s68 offen offset:0 sc1
    buffer_load_dwordx4 v[116:119], v3, s[24:27], s68 offen offset:2048 sc1
    s_add_u32 s68, s68, 4096
    s_cmp_eq_u32 s68, 57344
    s_cselect_b32 s68, 0, s68
    buffer_load_dwordx4 v[120:123], v3, s[24:27], s68 offen offset:0 sc1
    buffer_load_dwordx4 v[124:127], v3, s[24:27], s68 offen offset:2048 sc1
    s_add_u32 s68, s68, 4096
    s_cmp_eq_u32 s68, 57344
    s_cselect_b32 s68, 0, s68
    buffer_load_dwordx4 v[128:131], v3, s[24:27], s68 offen offset:0 sc1
    buffer_load_dwordx4 v[132:135], v3, s[24:27], s68 offen offset:2048 sc1
    s_add_u32 s68, s68, 4096
    s_cmp_eq_u32 s68, 57344
    s_cselect_b32 s68, 0, s68
    buffer_load_dwordx4 v[136:139], v3, s[24:27], s68 offen offset:0 sc1
    buffer_load_dwordx4 v[140:143], v3, s[24:27], s68 offen offset:2048 sc1
    s_add_u32 s68, s68, 4096
    s_cmp_eq_u32 s68, 57344
    s_cselect_b32 s68, 0, s68
    buffer_load_dwordx4 v[96:99], v3, s[24:27], s68 offen offset:0 sc1
    ds_read_b64_tr_b16 a[168:169], v26 offset:10240
    ds_read_b64_tr_b16 a[170:171], v26 offset:11264
    ds_read_b64_tr_b16 a[172:173], v27 offset:10240
    ds_read_b64_tr_b16 a[174:175], v27 offset:11264
    ds_read_b64_tr_b16 a[176:177], v26 offset:0
    ds_read_b64_tr_b16 a[178:179], v26 offset:1024
    ds_read_b64_tr_b16 a[180:181], v27 offset:0
    ds_read_b64_tr_b16 a[182:183], v27 offset:1024
    ds_read_b64_tr_b16 a[184:185], v26 offset:2048
    ds_read_b64_tr_b16 a[186:187], v26 offset:3072
    ds_read_b64_tr_b16 a[188:189], v27 offset:2048
    ds_read_b64_tr_b16 a[190:191], v27 offset:3072
    ds_read_b64_tr_b16 a[192:193], v26 offset:4096
    ds_read_b64_tr_b16 a[194:195], v26 offset:5120
    ds_read_b64_tr_b16 a[196:197], v27 offset:4096
    ds_read_b64_tr_b16 a[198:199], v27 offset:5120
    ds_read_b64_tr_b16 a[200:201], v26 offset:6144
    ds_read_b64_tr_b16 a[202:203], v26 offset:7168
    ds_read_b64_tr_b16 a[204:205], v27 offset:6144
    ds_read_b64_tr_b16 a[206:207], v27 offset:7168
    ds_read_b64_tr_b16 a[208:209], v26 offset:8192
    ds_read_b64_tr_b16 a[210:211], v26 offset:9216
    ds_read_b64_tr_b16 a[212:213], v27 offset:8192
    ds_read_b64_tr_b16 a[214:215], v27 offset:9216
    s_waitcnt lgkmcnt(15)
    s_nop 0
    s_add_u32 m0, s75, 10240
    s_add_u32 s80, s80, 65536
    s_cmp_eq_u32 s80, 1835008
    s_cselect_b32 s80, 0, s80
    buffer_load_dwordx4 v24, s[20:23], s80 offen lds
    buffer_load_dwordx4 v25, s[20:23], s80 offen offset:1024 lds
    s_add_u32 m0, s75, 0
    s_add_u32 s80, s80, 65536
    s_cmp_eq_u32 s80, 1835008
    s_cselect_b32 s80, 0, s80
    buffer_load_dwordx4 v24, s[20:23], s80 offen lds
    buffer_load_dwordx4 v25, s[20:23], s80 offen offset:1024 lds
    s_waitcnt lgkmcnt(12)
    s_add_u32 m0, s75, 2048
    s_add_u32 s80, s80, 65536
    s_cmp_eq_u32 s80, 1835008
    s_cselect_b32 s80, 0, s80
    buffer_load_dwordx4 v24, s[20:23], s80 offen lds
    buffer_load_dwordx4 v25, s[20:23], s80 offen offset:1024 lds
    s_waitcnt lgkmcnt(8)
    s_add_u32 m0, s75, 4096
    s_add_u32 s80, s80, 65536
    s_cmp_eq_u32 s80, 1835008
    s_cselect_b32 s80, 0, s80
    buffer_load_dwordx4 v24, s[20:23], s80 offen lds
    buffer_load_dwordx4 v25, s[20:23], s80 offen offset:1024 lds
    s_nop 1
    s_branch P3JOIN_35
VBAD_65:
    s_waitcnt vmcnt(0)
    s_sub_u32 s58, s58, 64
    s_cbranch_scc0 PLAIN_62
    s_mov_b32 s58, 0
    s_nop 15
    s_nop 1
    s_branch VOK_64
FB_66:
    buffer_load_dword v7, v30, s[24:27], s93 offen offset:2044 sc1
    s_waitcnt vmcnt(0)
    v_cmp_eq_u32 vcc, -1, v7
    s_cbranch_vccz FBM_68
POLL_70:
    s_sleep 2
    s_sub_u32 s58, s58, 1
    s_cbranch_scc0 PGO_71
    s_mov_b32 s58, 0
    s_branch FBM_68
PGO_71:
    buffer_load_dword v7, v30, s[24:27], s93 offen offset:2044 sc1
    s_waitcnt vmcnt(0)
    v_cmp_eq_u32 vcc, -1, v7
    s_cbranch_vccnz POLL_70
    s_branch FBM_68
FBM_68:
    s_lshl_b32 s68, s78, 107
    buffer_load_dwordx4 v[128:131], v3, s[24:27], s68 offen offset:1024 sc1
    buffer_load_dwordx4 v[132:135], v3, s[24:27], s68 offen offset:3072 sc1
    s_add_u32 s68, s68, 4096
    s_cmp_eq_u32 s68, 57344
    s_cselect_b32 s68, 0, s68
    buffer_load_dwordx4 v[136:139], v3, s[24:27], s68 offen offset:1024 sc1
    buffer_load_dwordx4 v[140:143], v3, s[24:27], s68 offen offset:3072 sc1
    s_add_u32 s68, s68, 4096
    s_cmp_eq_u32 s68, 57344
    s_cselect_b32 s68, 0, s68
    buffer_load_dwordx4 v[96:99], v3, s[24:27], s68 offen offset:1024 sc1
    buffer_load_dwordx4 v[100:103], v3, s[24:27], s68 offen offset:3072 sc1
    s_add_u32 s68, s68, 4096
    s_cmp_eq_u32 s68, 57344
    s_cselect_b32 s68, 0, s68
    buffer_load_dwordx4 v[104:107], v3, s[24:27], s68 offen offset:1024 sc1
    buffer_load_dwordx4 v[108:111], v3, s[24:27], s68 offen offset:3072 sc1
    s_add_u32 s68, s68, 4096
    s_cmp_eq_u32 s68, 57344
    s_cselect_b32 s68, 0, s68
    buffer_load_dwordx4 v[112:115], v3, s[24:27], s68 offen offset:1024 sc1
    s_waitcnt vmcnt(0)
    s_nop 1
    s_branch FBB_67
VBAD_75:
    s_waitcnt vmcnt(0)
    s_sub_u32 s58, s58, 64
    s_cbranch_scc0 PLAIN_72
    s_mov_b32 s58, 0
    s_nop 15
    s_nop 1
    s_branch VOK_74
FB_78:
    buffer_load_dword v7, v29, s[24:27], s95 offen offset:1020 sc1
    s_waitcnt vmcnt(0)
    v_cmp_eq_u32_e64 vcc, -1, v7
    s_cbranch_vccz FBM_80
POLL_82:
    s_sleep 2
    s_sub_u32 s58, s58, 1
    s_cbranch_scc0 PGO_83
    s_mov_b32 s58, 0
    s_branch FBM_80
PGO_83:
    buffer_load_dword v7, v29, s[24:27], s95 offen offset:1020 sc1
    s_waitcnt vmcnt(0)
    v_cmp_eq_u32 vcc, -1, v7
    s_cbranch_vccnz POLL_82
    s_branch FBM_80
FBM_80:
    s_mov_b32 s68, s66
    buffer_load_dwordx4 v[192:195], v1, s[24:27], s68 offen offset:0 sc1
    buffer_load_dwordx4 v[196:199], v1, s[24:27], s68 offen offset:1024 sc1
    s_add_u32 s68, s68, 4096
    buffer_load_dwordx4 v[200:203], v1, s[24:27], s68 offen offset:0 sc1
    buffer_load_dwordx4 v[204:207], v1, s[24:27], s68 offen offset:1024 sc1
    s_add_u32 s68, s68, 4096
    buffer_load_dwordx4 v[208:211], v1, s[24:27], s68 offen offset:0 sc1
    buffer_load_dwordx4 v[212:215], v1, s[24:27], s68 offen offset:1024 sc1
    s_add_u32 s68, s68, 4096
    buffer_load_dwordx4 v[216:219], v1, s[24:27], s68 offen offset:0 sc1
    buffer_load_dwordx4 v[220:223], v1, s[24:27], s68 offen offset:1024 sc1
    s_waitcnt vmcnt(0)
    s_nop 1
    s_branch FBB_79
XREDO_77:
    s_mov_b32 s68, s66
    buffer_load_dwordx4 v[192:195], v1, s[24:27], s68 offen offset:0 sc1
    buffer_load_dwordx4 v[196:199], v1, s[24:27], s68 offen offset:1024 sc1
    s_add_u32 s68, s68, 4096
    buffer_load_dwordx4 v[200:203], v1, s[24:27], s68 offen offset:0 sc1
    buffer_load_dwordx4 v[204:207], v1, s[24:27], s68 offen offset:1024 sc1
    s_add_u32 s68, s68, 4096
    buffer_load_dwordx4 v[208:211], v1, s[24:27], s68 offen offset:0 sc1
    buffer_load_dwordx4 v[212:215], v1, s[24:27], s68 offen offset:1024 sc1
    s_add_u32 s68, s68, 4096
    buffer_load_dwordx4 v[216:219], v1, s[24:27], s68 offen offset:0 sc1
    buffer_load_dwordx4 v[220:223], v1, s[24:27], s68 offen offset:1024 sc1
    s_waitcnt vmcnt(0)
    s_nop 1
    s_nop 0
    s_branch XGO_76
FB_84:
    buffer_load_dwordx2 v[96:97], v89, s[24:27], s97 offen offset:0 sc1
    buffer_load_dwordx2 v[98:99], v89, s[24:27], s97 offen offset:512 sc1
    buffer_load_dwordx2 v[100:101], v89, s[24:27], s97 offen offset:1024 sc1
    buffer_load_dwordx2 v[102:103], v89, s[24:27], s97 offen offset:1536 sc1
    buffer_load_dwordx2 v[104:105], v89, s[24:27], s97 offen offset:2048 sc1
    buffer_load_dwordx2 v[106:107], v89, s[24:27], s97 offen offset:2560 sc1
    buffer_load_dwordx2 v[108:109], v89, s[24:27], s97 offen offset:3072 sc1
    buffer_load_dwordx2 v[110:111], v89, s[24:27], s97 offen offset:3584 sc1
    s_waitcnt vmcnt(0)
    v_max3_u32 v7, v97, v99, v101
    v_max3_u32 v7, v7, v103, v105
    v_max3_u32 v7, v7, v107, v109
    v_max_u32 v7, v7, v111
    v_cmp_eq_u32_e64 vcc, -1, v7
    s_cbranch_vccz FBM_86
POLL_88:
    s_sleep 2
    s_sub_u32 s58, s58, 1
    s_cbranch_scc0 PGO_89
    s_mov_b32 s58, 0
    s_branch FBM_86
PGO_89:
    buffer_load_dwordx2 v[96:97], v89, s[24:27], s97 offen offset:0 sc1
    buffer_load_dwordx2 v[98:99], v89, s[24:27], s97 offen offset:512 sc1
    buffer_load_dwordx2 v[100:101], v89, s[24:27], s97 offen offset:1024 sc1
    buffer_load_dwordx2 v[102:103], v89, s[24:27], s97 offen offset:1536 sc1
    buffer_load_dwordx2 v[104:105], v89, s[24:27], s97 offen offset:2048 sc1
    buffer_load_dwordx2 v[106:107], v89, s[24:27], s97 offen offset:2560 sc1
    buffer_load_dwordx2 v[108:109], v89, s[24:27], s97 offen offset:3072 sc1
    buffer_load_dwordx2 v[110:111], v89, s[24:27], s97 offen offset:3584 sc1
    s_waitcnt vmcnt(0)
    v_max3_u32 v7, v97, v99, v101
    v_max3_u32 v7, v7, v103, v105
    v_max3_u32 v7, v7, v107, v109
    v_max_u32 v7, v7, v111
    v_cmp_eq_u32 vcc, -1, v7
    s_cbranch_vccnz POLL_88
    s_branch FBM_86
FBM_86:
    s_mov_b32 s68, s66
    buffer_load_dwordx4 v[128:131], v1, s[24:27], s68 offen offset:2048 sc1
    buffer_load_dwordx4 v[132:135], v1, s[24:27], s68 offen offset:3072 sc1
    s_add_u32 s68, s68, 4096
    buffer_load_dwordx4 v[136:139], v1, s[24:27], s68 offen offset:2048 sc1
    buffer_load_dwordx4 v[140:143], v1, s[24:27], s68 offen offset:3072 sc1
    s_add_u32 s68, s68, 4096
    buffer_load_dwordx4 v[144:147], v1, s[24:27], s68 offen offset:2048 sc1
    buffer_load_dwordx4 v[148:151], v1, s[24:27], s68 offen offset:3072 sc1
    s_add_u32 s68, s68, 4096
    buffer_load_dwordx4 v[152:155], v1, s[24:27], s68 offen offset:2048 sc1
    buffer_load_dwordx4 v[156:159], v1, s[24:27], s68 offen offset:3072 sc1
    s_nop 1
    s_branch FBB_85
VBAD_91:
    s_waitcnt vmcnt(0)
    s_sub_u32 s58, s58, 64
    s_cbranch_scc0 XREDO_77
    s_mov_b32 s58, 0
    s_nop 15
    s_nop 1
    s_branch VOK_90
RED_93:
    s_lshr_b32 s81, s79, 98
    s_mul_i32 s81, s81, 40960
    s_and_b32 s64, s79, 3
    s_mul_i32 s64, s64, 640
    s_add_u32 s81, s81, s64
    s_add_u32 s81, s81, 0xc6000
    s_mov_b32 exec_lo, 0xffffffff
    s_mov_b32 exec_hi, 0x7
    s_mov_b32 s65, s81
    buffer_load_dwordx4 v[128:131], v1, s[24:27], s65 offen offset:0 sc1
    buffer_load_dwordx4 v[132:135], v1, s[24:27], s65 offen offset:2560 sc1
    s_add_u32 s65, s65, 5120
    buffer_load_dwordx4 v[136:139], v1, s[24:27], s65 offen offset:0 sc1
    buffer_load_dwordx4 v[140:143], v1, s[24:27], s65 offen offset:2560 sc1
    s_add_u32 s65, s65, 5120
    buffer_load_dwordx4 v[144:147], v1, s[24:27], s65 offen offset:0 sc1
    buffer_load_dwordx4 v[148:151], v1, s[24:27], s65 offen offset:2560 sc1
    s_add_u32 s65, s65, 5120
    buffer_load_dwordx4 v[152:155], v1, s[24:27], s65 offen offset:0 sc1
    buffer_load_dwordx4 v[156:159], v1, s[24:27], s65 offen offset:2560 sc1
    s_add_u32 s65, s65, 5120
    buffer_load_dwordx4 v[160:163], v1, s[24:27], s65 offen offset:0 sc1
    buffer_load_dwordx4 v[164:167], v1, s[24:27], s65 offen offset:2560 sc1
    s_add_u32 s65, s65, 5120
    buffer_load_dwordx4 v[168:171], v1, s[24:27], s65 offen offset:0 sc1
    buffer_load_dwordx4 v[172:175], v1, s[24:27], s65 offen offset:2560 sc1
    s_add_u32 s65, s65, 5120
    buffer_load_dwordx4 v[176:179], v1, s[24:27], s65 offen offset:0 sc1
    buffer_load_dwordx4 v[180:183], v1, s[24:27], s65 offen offset:2560 sc1
    s_add_u32 s65, s65, 5120
    buffer_load_dwordx4 v[184:187], v1, s[24:27], s65 offen offset:0 sc1
    buffer_load_dwordx4 v[188:191], v1, s[24:27], s65 offen offset:2560 sc1
    s_mov_b64 exec, -1
    s_nop 1
    s_branch NOA1E_92
PRT_97:
POLL_98:
    s_sub_u32 s58, s58, 1
    s_cbranch_scc0 PGO_99
    s_mov_b32 s58, 0
    s_branch PDONE_96
PGO_99:
    s_mov_b32 s65, s81
    buffer_load_dwordx4 v[128:131], v1, s[24:27], s65 offen offset:0 sc1
    buffer_load_dwordx4 v[132:135], v1, s[24:27], s65 offen offset:2560 sc1
    s_add_u32 s65, s65, 5120
    buffer_load_dwordx4 v[136:139], v1, s[24:27], s65 offen offset:0 sc1
    buffer_load_dwordx4 v[140:143], v1, s[24:27], s65 offen offset:2560 sc1
    s_add_u32 s65, s65, 5120
    buffer_load_dwordx4 v[144:147], v1, s[24:27], s65 offen offset:0 sc1
    buffer_load_dwordx4 v[148:151], v1, s[24:27], s65 offen offset:2560 sc1
    s_add_u32 s65, s65, 5120
    buffer_load_dwordx4 v[152:155], v1, s[24:27], s65 offen offset:0 sc1
    buffer_load_dwordx4 v[156:159], v1, s[24:27], s65 offen offset:2560 sc1
    s_add_u32 s65, s65, 5120
    buffer_load_dwordx4 v[160:163], v1, s[24:27], s65 offen offset:0 sc1
    buffer_load_dwordx4 v[164:167], v1, s[24:27], s65 offen offset:2560 sc1
    s_add_u32 s65, s65, 5120
    buffer_load_dwordx4 v[168:171], v1, s[24:27], s65 offen offset:0 sc1
    buffer_load_dwordx4 v[172:175], v1, s[24:27], s65 offen offset:2560 sc1
    s_add_u32 s65, s65, 5120
    buffer_load_dwordx4 v[176:179], v1, s[24:27], s65 offen offset:0 sc1
    buffer_load_dwordx4 v[180:183], v1, s[24:27], s65 offen offset:2560 sc1
    s_add_u32 s65, s65, 5120
    buffer_load_dwordx4 v[184:187], v1, s[24:27], s65 offen offset:0 sc1
    buffer_load_dwordx4 v[188:191], v1, s[24:27], s65 offen offset:2560 sc1
    s_waitcnt vmcnt(0)
    s_nop 0
    v_max3_u32 v7, v128, v132, v136
    v_min3_u32 v5, v128, v132, v136
    v_max3_u32 v7, v7, v140, v144
    v_min3_u32 v5, v5, v140, v144
    v_max3_u32 v7, v7, v148, v152
    v_min3_u32 v5, v5, v148, v152
    v_max3_u32 v7, v7, v156, v160
    v_min3_u32 v5, v5, v156, v160
    v_max3_u32 v7, v7, v164, v168
    v_min3_u32 v5, v5, v164, v168
    v_max3_u32 v7, v7, v172, v176
    v_min3_u32 v5, v5, v172, v176
    v_max3_u32 v7, v7, v180, v184
    v_min3_u32 v5, v5, v180, v184
    v_max_u32 v7, v7, v188
    v_min_u32 v5, v5, v188
    v_cmp_eq_u32_e64 vcc, -1, v7
    v_readlane_b32 s62, v7, 34
    v_readlane_b32 s63, v5, 34
    s_xor_b32 s62, s62, s101
    s_xor_b32 s63, s63, s101
    s_or_b32 s62, s62, s63
    s_or_b32 vcc_lo, vcc_lo, s62
    s_or_b64 vcc, vcc, vcc
    s_cbranch_vccnz POLL_98
    s_branch PDONE_96
RED_95:
    s_mul_i32 s64, s79, 384
    s_add_u32 s64, s64, 0xc0000
    v_lshlrev_b32_e64 v6, 3, v0
    s_mov_b32 exec_lo, 0xffffffff
    s_mov_b32 exec_hi, 0x7
    s_waitcnt vmcnt(2)
    v_max3_u32 v7, v128, v132, v136
    v_min3_u32 v5, v128, v132, v136
    v_max3_u32 v7, v7, v140, v144
    v_min3_u32 v5, v5, v140, v144
    v_max3_u32 v7, v7, v148, v152
    v_min3_u32 v5, v5, v148, v152
    v_max3_u32 v7, v7, v156, v160
    v_min3_u32 v5, v5, v156, v160
    v_max3_u32 v7, v7, v164, v168
    v_min3_u32 v5, v5, v164, v168
    v_max3_u32 v7, v7, v172, v176
    v_min3_u32 v5, v5, v172, v176
    v_max3_u32 v7, v7, v180, v184
    v_min3_u32 v5, v5, v180, v184
    v_max_u32 v7, v7, v188
    v_min_u32 v5, v5, v188
    v_cmp_eq_u32_e64 vcc, -1, v7
    v_readlane_b32 s62, v7, 34
    v_readlane_b32 s63, v5, 34
    s_xor_b32 s62, s62, s101
    s_xor_b32 s63, s63, s101
    s_or_b32 s62, s62, s63
    s_or_b32 vcc_lo, vcc_lo, s62
    s_or_b64 vcc, vcc, vcc
    s_cbranch_vccnz PRT_97
PDONE_96:
    v_pk_add_f32 v[128:129], v[128:129], v[160:161]
    v_pk_add_f32 v[130:131], v[130:131], v[162:163]
    v_pk_add_f32 v[132:133], v[132:133], v[164:165]
    v_pk_add_f32 v[134:135], v[134:135], v[166:167]
    v_pk_add_f32 v[136:137], v[136:137], v[168:169]
    v_pk_add_f32 v[138:139], v[138:139], v[170:171]
    v_pk_add_f32 v[140:141], v[140:141], v[172:173]
    v_pk_add_f32 v[142:143], v[142:143], v[174:175]
    v_pk_add_f32 v[144:145], v[144:145], v[176:177]
    v_pk_add_f32 v[146:147], v[146:147], v[178:179]
    v_pk_add_f32 v[148:149], v[148:149], v[180:181]
    v_pk_add_f32 v[150:151], v[150:151], v[182:183]
    v_pk_add_f32 v[152:153], v[152:153], v[184:185]
    v_pk_add_f32 v[154:155], v[154:155], v[186:187]
    v_pk_add_f32 v[156:157], v[156:157], v[188:189]
    v_pk_add_f32 v[158:159], v[158:159], v[190:191]
    v_pk_add_f32 v[128:129], v[128:129], v[144:145]
    v_pk_add_f32 v[130:131], v[130:131], v[146:147]
    v_pk_add_f32 v[132:133], v[132:133], v[148:149]
    v_pk_add_f32 v[134:135], v[134:135], v[150:151]
    v_pk_add_f32 v[136:137], v[136:137], v[152:153]
    v_pk_add_f32 v[138:139], v[138:139], v[154:155]
    v_pk_add_f32 v[140:141], v[140:141], v[156:157]
    v_pk_add_f32 v[142:143], v[142:143], v[158:159]
    v_pk_add_f32 v[128:129], v[128:129], v[136:137]
    v_pk_add_f32 v[130:131], v[130:131], v[138:139]
    v_pk_add_f32 v[132:133], v[132:133], v[140:141]
    v_pk_add_f32 v[134:135], v[134:135], v[142:143]
    v_pk_add_f32 v[128:129], v[128:129], v[132:133]
    v_pk_add_f32 v[130:131], v[130:131], v[134:135]
    v_cvt_pk_bf16_f32 v132, v128, v129
    v_cvt_pk_bf16_f32 v133, v130, v131
    s_nop 0
    s_nop 0
    v_mov_b32_dpp v134, v132 quad_perm:[1,1,3,3] row_mask:0xf bank_mask:0xf
    v_mov_b32_dpp v135, v133 quad_perm:[1,1,3,3] row_mask:0xf bank_mask:0xf
    v_writelane_b32 v132, s101, 34
    s_mov_b32 exec_lo, 0x55555555
    s_mov_b32 exec_hi, 0x5555
    buffer_store_dwordx4 v[132:135], v6, s[24:27], s64 offen sc1
    s_mov_b64 exec, -1
    s_nop 1
    s_nop 1
    s_branch NOA1_94
PRT_103:
POLL_104:
    s_sleep 2
    s_sub_u32 s58, s58, 1
    s_cbranch_scc0 PGO_105
    s_mov_b32 s58, 0
    s_branch PDONE_102
PGO_105:
    buffer_load_dword v7, v6, s[24:27], s86 offen offset:2044 sc1
    s_waitcnt vmcnt(0)
    v_cmp_eq_u32 vcc, -1, v7
    s_cbranch_vccnz POLL_104
    s_branch PDONE_102
PQR_100:
    s_mov_b32 s66, s86
    buffer_load_dwordx4 v[192:195], v1, s[24:27], s66 offen offset:0 sc1
    buffer_load_dwordx4 v[196:199], v1, s[24:27], s66 offen offset:1024 sc1
    buffer_load_dwordx4 v[200:203], v1, s[24:27], s66 offen offset:2048 sc1
    buffer_load_dwordx4 v[204:207], v1, s[24:27], s66 offen offset:3072 sc1
    s_add_u32 s66, s66, 4096
    buffer_load_dwordx4 v[208:211], v1, s[24:27], s66 offen offset:0 sc1
    buffer_load_dwordx4 v[212:215], v1, s[24:27], s66 offen offset:1024 sc1
    buffer_load_dwordx4 v[216:219], v1, s[24:27], s66 offen offset:2048 sc1
    buffer_load_dwordx4 v[220:223], v1, s[24:27], s66 offen offset:3072 sc1
    s_add_u32 s66, s66, 4096
    buffer_load_dwordx4 v[224:227], v1, s[24:27], s66 offen offset:0 sc1
    buffer_load_dwordx4 v[228:231], v1, s[24:27], s66 offen offset:1024 sc1
    buffer_load_dwordx4 v[232:235], v1, s[24:27], s66 offen offset:2048 sc1
    buffer_load_dwordx4 v[236:239], v1, s[24:27], s66 offen offset:3072 sc1
    s_add_u32 s66, s66, 4096
    buffer_load_dwordx4 v[240:243], v1, s[24:27], s66 offen offset:0 sc1
    buffer_load_dwordx4 v[244:247], v1, s[24:27], s66 offen offset:1024 sc1
    buffer_load_dwordx4 v[248:251], v1, s[24:27], s66 offen offset:2048 sc1
    buffer_load_dwordx4 v[252:255], v1, s[24:27], s66 offen offset:3072 sc1
    s_waitcnt vmcnt(0)
    s_nop 1
    s_branch GO_101
P2REDO_106:
    s_mov_b32 s66, s86
    buffer_load_dwordx4 v[192:195], v1, s[24:27], s66 offen offset:0 sc1
    buffer_load_dwordx4 v[196:199], v1, s[24:27], s66 offen offset:1024 sc1
    buffer_load_dwordx4 v[200:203], v1, s[24:27], s66 offen offset:2048 sc1
    buffer_load_dwordx4 v[204:207], v1, s[24:27], s66 offen offset:3072 sc1
    s_add_u32 s66, s66, 4096
    buffer_load_dwordx4 v[208:211], v1, s[24:27], s66 offen offset:0 sc1
    buffer_load_dwordx4 v[212:215], v1, s[24:27], s66 offen offset:1024 sc1
    buffer_load_dwordx4 v[216:219], v1, s[24:27], s66 offen offset:2048 sc1
    buffer_load_dwordx4 v[220:223], v1, s[24:27], s66 offen offset:3072 sc1
    s_add_u32 s66, s66, 4096
    buffer_load_dwordx4 v[224:227], v1, s[24:27], s66 offen offset:0 sc1
    buffer_load_dwordx4 v[228:231], v1, s[24:27], s66 offen offset:1024 sc1
    buffer_load_dwordx4 v[232:235], v1, s[24:27], s66 offen offset:2048 sc1
    buffer_load_dwordx4 v[236:239], v1, s[24:27], s66 offen offset:3072 sc1
    s_add_u32 s66, s66, 4096
    buffer_load_dwordx4 v[240:243], v1, s[24:27], s66 offen offset:0 sc1
    buffer_load_dwordx4 v[244:247], v1, s[24:27], s66 offen offset:1024 sc1
    buffer_load_dwordx4 v[248:251], v1, s[24:27], s66 offen offset:2048 sc1
    buffer_load_dwordx4 v[252:255], v1, s[24:27], s66 offen offset:3072 sc1
    s_nop 1
    s_branch P2REDO2_107
FB_109:
    buffer_load_dword v7, v29, s[24:27], s87 offen offset:272 sc1
    s_waitcnt vmcnt(0)
    v_cmp_ne_u32 vcc, s101, v7
    s_cbranch_vccz FBM_111
POLL_113:
    s_sleep 2
    s_sub_u32 s58, s58, 1
    s_cbranch_scc0 PGO_114
    s_mov_b32 s58, 0
    s_branch FBM_111
PGO_114:
    buffer_load_dword v7, v29, s[24:27], s87 offen offset:272 sc1
    s_waitcnt vmcnt(0)
    v_cmp_ne_u32_e64 vcc, s101, v7
    s_cbranch_vccnz POLL_113
    s_branch FBM_111
FBM_111:
    s_mov_b32 s68, s87
    buffer_load_dwordx4 v[128:131], v28, s[24:27], s68 offen offset:0 sc1
    buffer_load_dwordx4 v[132:135], v28, s[24:27], s68 offen offset:768 sc1
    buffer_load_dwordx4 v[136:139], v28, s[24:27], s68 offen offset:1536 sc1
    buffer_load_dwordx4 v[140:143], v28, s[24:27], s68 offen offset:2304 sc1
    s_add_u32 s68, s68, 3072
    buffer_load_dwordx4 v[144:147], v28, s[24:27], s68 offen offset:0 sc1
    buffer_load_dwordx4 v[148:151], v28, s[24:27], s68 offen offset:768 sc1
    buffer_load_dwordx4 v[152:155], v28, s[24:27], s68 offen offset:1536 sc1
    buffer_load_dwordx4 v[156:159], v28, s[24:27], s68 offen offset:2304 sc1
    s_add_u32 s68, s68, 3072
    buffer_load_dwordx4 v[160:163], v28, s[24:27], s68 offen offset:0 sc1
    buffer_load_dwordx4 v[164:167], v28, s[24:27], s68 offen offset:768 sc1
    s_nop 1
    s_branch FBB_110
P2REDO2_107:
    s_mov_b32 s68, s87
    buffer_load_dwordx4 v[128:131], v28, s[24:27], s68 offen offset:0 sc1
    buffer_load_dwordx4 v[132:135], v28, s[24:27], s68 offen offset:768 sc1
    buffer_load_dwordx4 v[136:139], v28, s[24:27], s68 offen offset:1536 sc1
    buffer_load_dwordx4 v[140:143], v28, s[24:27], s68 offen offset:2304 sc1
    s_add_u32 s68, s68, 3072
    buffer_load_dwordx4 v[144:147], v28, s[24:27], s68 offen offset:0 sc1
    buffer_load_dwordx4 v[148:151], v28, s[24:27], s68 offen offset:768 sc1
    buffer_load_dwordx4 v[152:155], v28, s[24:27], s68 offen offset:1536 sc1
    buffer_load_dwordx4 v[156:159], v28, s[24:27], s68 offen offset:2304 sc1
    s_add_u32 s68, s68, 3072
    buffer_load_dwordx4 v[160:163], v28, s[24:27], s68 offen offset:0 sc1
    buffer_load_dwordx4 v[164:167], v28, s[24:27], s68 offen offset:768 sc1
    s_waitcnt vmcnt(0)
    s_nop 1
    s_branch GO_108
VBAD_116:
    s_waitcnt vmcnt(0)
    s_sub_u32 s58, s58, 64
    s_cbranch_scc0 P2REDO_106
    s_mov_b32 s58, 0
    s_nop 15
    s_nop 1
    s_branch VOK_115
PRT_118:
POLL_119:
    s_sleep 2
    s_sub_u32 s58, s58, 1
    s_cbranch_scc0 PGO_120
    s_mov_b32 s58, 0
    s_branch PDONE_117
PGO_120:
    buffer_load_dwordx2 v[128:129], v6, s[24:27], s89 offen offset:0 sc1
    buffer_load_dwordx2 v[130:131], v6, s[24:27], s89 offen offset:512 sc1
    buffer_load_dwordx2 v[132:133], v6, s[24:27], s89 offen offset:1024 sc1
    buffer_load_dwordx2 v[134:135], v6, s[24:27], s89 offen offset:1536 sc1
    buffer_load_dwordx2 v[136:137], v6, s[24:27], s89 offen offset:2048 sc1
    buffer_load_dwordx2 v[138:139], v6, s[24:27], s89 offen offset:2560 sc1
    buffer_load_dwordx2 v[140:141], v6, s[24:27], s89 offen offset:3072 sc1
    buffer_load_dwordx2 v[142:143], v6, s[24:27], s89 offen offset:3584 sc1
    s_waitcnt vmcnt(0)
    v_max3_u32 v7, v129, v131, v133
    v_max3_u32 v7, v7, v135, v137
    v_max3_u32 v7, v7, v139, v141
    v_max_u32 v7, v7, v143
    v_cmp_eq_u32_e64 vcc, -1, v7
    s_cbranch_vccnz POLL_119
    s_branch PDONE_117
FB_125:
    buffer_load_dword v7, v29, s[24:27], s91 offen offset:3836 sc1
    s_waitcnt vmcnt(0)
    v_cmp_eq_u32 vcc, -1, v7
    s_cbranch_vccz FBM_127
POLL_129:
    s_sleep 2
    s_sub_u32 s58, s58, 1
    s_cbranch_scc0 PGO_130
    s_mov_b32 s58, 0
    s_branch FBM_127
PGO_130:
    buffer_load_dword v7, v29, s[24:27], s91 offen offset:3836 sc1
    s_waitcnt vmcnt(0)
    v_cmp_eq_u32 vcc, -1, v7
    s_cbranch_vccnz POLL_129
    s_branch FBM_127
FBM_127:
    s_lshl_b32 s68, s77, 107
    buffer_load_dwordx4 v[96:99], v2, s[24:27], s68 offen offset:0 sc1
    buffer_load_dwordx4 v[100:103], v2, s[24:27], s68 offen offset:2048 sc1
    s_add_u32 s68, s68, 4096
    s_cmp_eq_u32 s68, 65536
    s_cselect_b32 s68, 0, s68
    buffer_load_dwordx4 v[104:107], v2, s[24:27], s68 offen offset:0 sc1
    buffer_load_dwordx4 v[108:111], v2, s[24:27], s68 offen offset:2048 sc1
    s_add_u32 s68, s68, 4096
    s_cmp_eq_u32 s68, 65536
    s_cselect_b32 s68, 0, s68
    buffer_load_dwordx4 v[112:115], v2, s[24:27], s68 offen offset:0 sc1
    buffer_load_dwordx4 v[116:119], v2, s[24:27], s68 offen offset:2048 sc1
    s_add_u32 s68, s68, 4096
    s_cmp_eq_u32 s68, 65536
    s_cselect_b32 s68, 0, s68
    buffer_load_dwordx4 v[120:123], v2, s[24:27], s68 offen offset:0 sc1
    buffer_load_dwordx4 v[124:127], v2, s[24:27], s68 offen offset:2048 sc1
    s_add_u32 s68, s68, 4096
    s_cmp_eq_u32 s68, 65536
    s_cselect_b32 s68, 0, s68
    buffer_load_dwordx4 v[128:131], v2, s[24:27], s68 offen offset:0 sc1
    s_nop 1
    s_branch FBB_126
SREDO_123:
    s_lshl_b32 s68, s77, 11
    buffer_load_dwordx4 v[96:99], v2, s[24:27], s68 offen offset:0 sc1
    buffer_load_dwordx4 v[100:103], v2, s[24:27], s68 offen offset:2048 sc1
    s_add_u32 s68, s68, 4096
    s_cmp_eq_u32 s68, 65536
    s_cselect_b32 s68, 0, s68
    buffer_load_dwordx4 v[104:107], v2, s[24:27], s68 offen offset:0 sc1
    buffer_load_dwordx4 v[108:111], v2, s[24:27], s68 offen offset:2048 sc1
    s_add_u32 s68, s68, 4096
    s_cmp_eq_u32 s68, 65536
    s_cselect_b32 s68, 0, s68
    buffer_load_dwordx4 v[112:115], v2, s[24:27], s68 offen offset:0 sc1
    buffer_load_dwordx4 v[116:119], v2, s[24:27], s68 offen offset:2048 sc1
    s_add_u32 s68, s68, 4096
    s_cmp_eq_u32 s68, 65536
    s_cselect_b32 s68, 0, s68
    buffer_load_dwordx4 v[120:123], v2, s[24:27], s68 offen offset:0 sc1
    buffer_load_dwordx4 v[124:127], v2, s[24:27], s68 offen offset:2048 sc1
    s_add_u32 s68, s68, 4096
    s_cmp_eq_u32 s68, 65536
    s_cselect_b32 s68, 0, s68
    buffer_load_dwordx4 v[128:131], v2, s[24:27], s68 offen offset:0 sc1
    s_waitcnt vmcnt(0)
    s_nop 1
    s_branch GO_124
VBAD_134:
    s_waitcnt vmcnt(0)
    s_sub_u32 s58, s58, 64
    s_cbranch_scc0 PLAIN_131
    s_mov_b32 s58, 0
    s_nop 15
    s_nop 1
    s_branch VOK_133
VBAD_138:
    s_waitcnt vmcnt(0)
    s_sub_u32 s58, s58, 64
    s_cbranch_scc0 PLAIN_135
    s_mov_b32 s58, 0
    s_nop 15
    s_nop 1
    s_branch VOK_137
FB_139:
    buffer_load_dword v7, v30, s[24:27], s93 offen offset:1020 sc1
    s_waitcnt vmcnt(0)
    v_cmp_eq_u32 vcc, -1, v7
    s_cbranch_vccz FBM_141
POLL_143:
    s_sleep 2
    s_sub_u32 s58, s58, 1
    s_cbranch_scc0 PGO_144
    s_mov_b32 s58, 0
    s_branch FBM_141
PGO_144:
    buffer_load_dword v7, v30, s[24:27], s93 offen offset:1020 sc1
    s_waitcnt vmcnt(0)
    v_cmp_eq_u32 vcc, -1, v7
    s_cbranch_vccnz POLL_143
    s_branch FBM_141
FBM_141:
    s_lshl_b32 s68, s78, 107
    buffer_load_dwordx4 v[112:115], v3, s[24:27], s68 offen offset:0 sc1
    buffer_load_dwordx4 v[116:119], v3, s[24:27], s68 offen offset:2048 sc1
    s_add_u32 s68, s68, 4096
    s_cmp_eq_u32 s68, 57344
    s_cselect_b32 s68, 0, s68
    buffer_load_dwordx4 v[120:123], v3, s[24:27], s68 offen offset:0 sc1
    buffer_load_dwordx4 v[124:127], v3, s[24:27], s68 offen offset:2048 sc1
    s_add_u32 s68, s68, 4096
    s_cmp_eq_u32 s68, 57344
    s_cselect_b32 s68, 0, s68
    buffer_load_dwordx4 v[128:131], v3, s[24:27], s68 offen offset:0 sc1
    buffer_load_dwordx4 v[132:135], v3, s[24:27], s68 offen offset:2048 sc1
    s_add_u32 s68, s68, 4096
    s_cmp_eq_u32 s68, 57344
    s_cselect_b32 s68, 0, s68
    buffer_load_dwordx4 v[136:139], v3, s[24:27], s68 offen offset:0 sc1
    buffer_load_dwordx4 v[140:143], v3, s[24:27], s68 offen offset:2048 sc1
    s_add_u32 s68, s68, 4096
    s_cmp_eq_u32 s68, 57344
    s_cselect_b32 s68, 0, s68
    buffer_load_dwordx4 v[96:99], v3, s[24:27], s68 offen offset:0 sc1
    buffer_load_dword v7, off, s[40:43], 0 offset:4094
    buffer_load_dword v7, off, s[40:43], 0 offset:4094
    buffer_load_dword v7, off, s[40:43], 0 offset:4094
    buffer_load_dword v7, off, s[40:43], 0 offset:4094
    buffer_load_dword v7, off, s[40:43], 0 offset:4094
    buffer_load_dword v7, off, s[40:43], 0 offset:4094
    buffer_load_dword v7, off, s[40:43], 0 offset:4094
    s_nop 1
    s_branch FBB_140
PRT_146:
POLL_147:
    s_sleep 2
    s_sub_u32 s58, s58, 1
    s_cbranch_scc0 PGO_148
    s_mov_b32 s58, 0
    s_branch PDONE_145
PGO_148:
    buffer_load_dword v7, v30, s[24:27], s93 offen offset:1020 sc1
    s_waitcnt vmcnt(0)
    v_cmp_eq_u32_e64 vcc, -1, v7
    s_cbranch_vccnz POLL_147
    s_branch PDONE_145
P3IDLE_121:
    s_add_u32 m0, s75, 0
    s_add_u32 s80, s80, 65536
    s_cmp_eq_u32 s80, 1835008
    s_cselect_b32 s80, 0, s80
    buffer_load_dwordx4 v24, s[20:23], s80 offen lds
    buffer_load_dwordx4 v25, s[20:23], s80 offen offset:1024 lds
    s_add_u32 m0, s75, 2048
    s_add_u32 s80, s80, 65536
    s_cmp_eq_u32 s80, 1835008
    s_cselect_b32 s80, 0, s80
    buffer_load_dwordx4 v24, s[20:23], s80 offen lds
    buffer_load_dwordx4 v25, s[20:23], s80 offen offset:1024 lds
    s_add_u32 m0, s75, 4096
    s_add_u32 s80, s80, 65536
    s_cmp_eq_u32 s80, 1835008
    s_cselect_b32 s80, 0, s80
    buffer_load_dwordx4 v24, s[20:23], s80 offen lds
    buffer_load_dwordx4 v25, s[20:23], s80 offen offset:1024 lds
    buffer_load_dword v7, v30, s[24:27], s93 offen offset:1020 sc1
    s_waitcnt vmcnt(0)
    v_cmp_eq_u32 vcc, -1, v7
    s_cbranch_vccnz PRT_146
PDONE_145:
    s_lshl_b32 s68, s78, 11
    buffer_load_dwordx4 v[112:115], v3, s[24:27], s68 offen offset:0 sc1
    buffer_load_dwordx4 v[116:119], v3, s[24:27], s68 offen offset:2048 sc1
    s_add_u32 s68, s68, 4096
    s_cmp_eq_u32 s68, 57344
    s_cselect_b32 s68, 0, s68
    buffer_load_dwordx4 v[120:123], v3, s[24:27], s68 offen offset:0 sc1
    buffer_load_dwordx4 v[124:127], v3, s[24:27], s68 offen offset:2048 sc1
    s_add_u32 s68, s68, 4096
    s_cmp_eq_u32 s68, 57344
    s_cselect_b32 s68, 0, s68
    buffer_load_dwordx4 v[128:131], v3, s[24:27], s68 offen offset:0 sc1
    buffer_load_dwordx4 v[132:135], v3, s[24:27], s68 offen offset:2048 sc1
    s_add_u32 s68, s68, 4096
    s_cmp_eq_u32 s68, 57344
    s_cselect_b32 s68, 0, s68
    buffer_load_dwordx4 v[136:139], v3, s[24:27], s68 offen offset:0 sc1
    buffer_load_dwordx4 v[140:143], v3, s[24:27], s68 offen offset:2048 sc1
    s_add_u32 s68, s68, 4096
    s_cmp_eq_u32 s68, 57344
    s_cselect_b32 s68, 0, s68
    buffer_load_dwordx4 v[96:99], v3, s[24:27], s68 offen offset:0 sc1
    s_add_u32 m0, s75, 6144
    s_add_u32 s80, s80, 65536
    s_cmp_eq_u32 s80, 1835008
    s_cselect_b32 s80, 0, s80
    buffer_load_dwordx4 v24, s[20:23], s80 offen lds
    buffer_load_dwordx4 v25, s[20:23], s80 offen offset:1024 lds
    s_add_u32 m0, s75, 8192
    s_add_u32 s80, s80, 65536
    s_cmp_eq_u32 s80, 1835008
    s_cselect_b32 s80, 0, s80
    buffer_load_dwordx4 v24, s[20:23], s80 offen lds
    buffer_load_dwordx4 v25, s[20:23], s80 offen offset:1024 lds
    s_add_u32 m0, s75, 10240
    s_add_u32 s80, s80, 65536
    s_cmp_eq_u32 s80, 1835008
    s_cselect_b32 s80, 0, s80
    buffer_load_dwordx4 v24, s[20:23], s80 offen lds
    buffer_load_dwordx4 v25, s[20:23], s80 offen offset:1024 lds
    s_nop 1
    s_branch P3JOIN_122
VBAD_152:
    s_waitcnt vmcnt(0)
    s_sub_u32 s58, s58, 64
    s_cbranch_scc0 PLAIN_149
    s_mov_b32 s58, 0
    s_nop 15
    s_nop 1
    s_branch VOK_151
FB_153:
    buffer_load_dword v7, v30, s[24:27], s93 offen offset:2044 sc1
    s_waitcnt vmcnt(0)
    v_cmp_eq_u32 vcc, -1, v7
    s_cbranch_vccz FBM_155
POLL_157:
    s_sleep 2
    s_sub_u32 s58, s58, 1
    s_cbranch_scc0 PGO_158
    s_mov_b32 s58, 0
    s_branch FBM_155
PGO_158:
    buffer_load_dword v7, v30, s[24:27], s93 offen offset:2044 sc1
    s_waitcnt vmcnt(0)
    v_cmp_eq_u32 vcc, -1, v7
    s_cbranch_vccnz POLL_157
    s_branch FBM_155
FBM_155:
    s_lshl_b32 s68, s78, 107
    buffer_load_dwordx4 v[128:131], v3, s[24:27], s68 offen offset:1024 sc1
    buffer_load_dwordx4 v[132:135], v3, s[24:27], s68 offen offset:3072 sc1
    s_add_u32 s68, s68, 4096
    s_cmp_eq_u32 s68, 57344
    s_cselect_b32 s68, 0, s68
    buffer_load_dwordx4 v[136:139], v3, s[24:27], s68 offen offset:1024 sc1
    buffer_load_dwordx4 v[140:143], v3, s[24:27], s68 offen offset:3072 sc1
    s_add_u32 s68, s68, 4096
    s_cmp_eq_u32 s68, 57344
    s_cselect_b32 s68, 0, s68
    buffer_load_dwordx4 v[96:99], v3, s[24:27], s68 offen offset:1024 sc1
    buffer_load_dwordx4 v[100:103], v3, s[24:27], s68 offen offset:3072 sc1
    s_add_u32 s68, s68, 4096
    s_cmp_eq_u32 s68, 57344
    s_cselect_b32 s68, 0, s68
    buffer_load_dwordx4 v[104:107], v3, s[24:27], s68 offen offset:1024 sc1
    buffer_load_dwordx4 v[108:111], v3, s[24:27], s68 offen offset:3072 sc1
    s_add_u32 s68, s68, 4096
    s_cmp_eq_u32 s68, 57344
    s_cselect_b32 s68, 0, s68
    buffer_load_dwordx4 v[112:115], v3, s[24:27], s68 offen offset:1024 sc1
    s_nop 1
    s_branch FBB_154
VBAD_162:
    s_waitcnt vmcnt(0)
    s_sub_u32 s58, s58, 64
    s_cbranch_scc0 PLAIN_159
    s_mov_b32 s58, 0
    s_nop 15
    s_nop 1
    s_branch VOK_161
L_END:
PLAIN_44:
    s_lshl_b32 s68, s77, 11
    buffer_load_dwordx4 v[96:99], v2, s[24:27], s68 offen offset:0 sc1
    buffer_load_dwordx4 v[100:103], v2, s[24:27], s68 offen offset:2048 sc1
    s_add_u32 s68, s68, 4096
    s_cmp_eq_u32 s68, 65536
    s_cselect_b32 s68, 0, s68
    buffer_load_dwordx4 v[104:107], v2, s[24:27], s68 offen offset:0 sc1
    buffer_load_dwordx4 v[108:111], v2, s[24:27], s68 offen offset:2048 sc1
    s_add_u32 s68, s68, 4096
    s_cmp_eq_u32 s68, 65536
    s_cselect_b32 s68, 0, s68
    buffer_load_dwordx4 v[112:115], v2, s[24:27], s68 offen offset:0 sc1
    buffer_load_dwordx4 v[116:119], v2, s[24:27], s68 offen offset:2048 sc1
    s_add_u32 s68, s68, 4096
    s_cmp_eq_u32 s68, 65536
    s_cselect_b32 s68, 0, s68
    buffer_load_dwordx4 v[120:123], v2, s[24:27], s68 offen offset:0 sc1
    buffer_load_dwordx4 v[124:127], v2, s[24:27], s68 offen offset:2048 sc1
    s_add_u32 s68, s68, 4096
    s_cmp_eq_u32 s68, 65536
    s_cselect_b32 s68, 0, s68
    buffer_load_dwordx4 v[128:131], v2, s[24:27], s68 offen offset:0 sc1
    v_mov_b32 v28, 0
    s_waitcnt vmcnt(8)
    v_mfma_f32_32x32x16_bf16 v[48:63], a[4:7], v[96:99], 0
    buffer_load_dwordx4 v[132:135], v2, s[24:27], s68 offen offset:2048 sc1
    v_mfma_f32_32x32x16_bf16 v[32:47], a[0:3], v[96:99], 0
    s_waitcnt vmcnt(8)
    v_mfma_f32_32x32x16_bf16 v[48:63], a[12:15], v[100:103], v[48:63]
    s_add_u32 s68, s68, 4096
    s_cmp_eq_u32 s68, 65536
    s_cselect_b32 s68, 0, s68
    buffer_load_dwordx4 v[136:139], v2, s[24:27], s68 offen offset:0 sc1
    v_max3_u32 v28, v28, v96, v100
    v_mfma_f32_32x32x16_bf16 v[32:47], a[8:11], v[100:103], v[32:47]
    s_waitcnt vmcnt(8)
    v_mfma_f32_32x32x16_bf16 v[48:63], a[20:23], v[104:107], v[48:63]
    buffer_load_dwordx4 v[140:143], v2, s[24:27], s68 offen offset:2048 sc1
    v_mfma_f32_32x32x16_bf16 v[32:47], a[16:19], v[104:107], v[32:47]
    s_waitcnt vmcnt(8)
    v_mfma_f32_32x32x16_bf16 v[48:63], a[28:31], v[108:111], v[48:63]
    s_add_u32 s68, s68, 4096
    s_cmp_eq_u32 s68, 65536
    s_cselect_b32 s68, 0, s68
    buffer_load_dwordx4 v[96:99], v2, s[24:27], s68 offen offset:0 sc1
    v_max3_u32 v28, v28, v104, v108
    v_mfma_f32_32x32x16_bf16 v[32:47], a[24:27], v[108:111], v[32:47]
    s_waitcnt vmcnt(8)
    v_mfma_f32_32x32x16_bf16 v[48:63], a[36:39], v[112:115], v[48:63]
    buffer_load_dwordx4 v[100:103], v2, s[24:27], s68 offen offset:2048 sc1
    v_mfma_f32_32x32x16_bf16 v[32:47], a[32:35], v[112:115], v[32:47]
    s_waitcnt vmcnt(8)
    v_mfma_f32_32x32x16_bf16 v[48:63], a[44:47], v[116:119], v[48:63]
    s_add_u32 s68, s68, 4096
    s_cmp_eq_u32 s68, 65536
    s_cselect_b32 s68, 0, s68
    buffer_load_dwordx4 v[104:107], v2, s[24:27], s68 offen offset:0 sc1
    v_max3_u32 v28, v28, v112, v116
    v_mfma_f32_32x32x16_bf16 v[32:47], a[40:43], v[116:119], v[32:47]
    s_waitcnt vmcnt(8)
    v_mfma_f32_32x32x16_bf16 v[48:63], a[52:55], v[120:123], v[48:63]
    buffer_load_dwordx4 v[108:111], v2, s[24:27], s68 offen offset:2048 sc1
    v_mfma_f32_32x32x16_bf16 v[32:47], a[48:51], v[120:123], v[32:47]
    s_waitcnt vmcnt(8)
    v_mfma_f32_32x32x16_bf16 v[48:63], a[60:63], v[124:127], v[48:63]
    s_add_u32 s68, s68, 4096
    s_cmp_eq_u32 s68, 65536
    s_cselect_b32 s68, 0, s68
    buffer_load_dwordx4 v[112:115], v2, s[24:27], s68 offen offset:0 sc1
    v_max3_u32 v28, v28, v120, v124
    v_mfma_f32_32x32x16_bf16 v[32:47], a[56:59], v[124:127], v[32:47]
    s_waitcnt vmcnt(8)
    v_mfma_f32_32x32x16_bf16 v[48:63], a[68:71], v[128:131], v[48:63]
    buffer_load_dwordx4 v[116:119], v2, s[24:27], s68 offen offset:2048 sc1
    v_mfma_f32_32x32x16_bf16 v[32:47], a[64:67], v[128:131], v[32:47]
    s_waitcnt vmcnt(8)
    v_mfma_f32_32x32x16_bf16 v[48:63], a[76:79], v[132:135], v[48:63]
    s_add_u32 s68, s68, 4096
    s_cmp_eq_u32 s68, 65536
    s_cselect_b32 s68, 0, s68
    buffer_load_dwordx4 v[120:123], v2, s[24:27], s68 offen offset:0 sc1
    v_max3_u32 v28, v28, v128, v132
    v_mfma_f32_32x32x16_bf16 v[32:47], a[72:75], v[132:135], v[32:47]
    s_waitcnt vmcnt(8)
    v_mfma_f32_32x32x16_bf16 v[48:63], a[84:87], v[136:139], v[48:63]
    buffer_load_dwordx4 v[124:127], v2, s[24:27], s68 offen offset:2048 sc1
    v_mfma_f32_32x32x16_bf16 v[32:47], a[80:83], v[136:139], v[32:47]
    s_waitcnt vmcnt(8)
    v_mfma_f32_32x32x16_bf16 v[48:63], a[92:95], v[140:143], v[48:63]
    s_add_u32 s68, s68, 4096
    s_cmp_eq_u32 s68, 65536
    s_cselect_b32 s68, 0, s68
    buffer_load_dwordx4 v[128:131], v2, s[24:27], s68 offen offset:0 sc1
    v_max3_u32 v28, v28, v136, v140
    v_mfma_f32_32x32x16_bf16 v[32:47], a[88:91], v[140:143], v[32:47]
    s_waitcnt vmcnt(8)
    v_mfma_f32_32x32x16_bf16 v[48:63], a[100:103], v[96:99], v[48:63]
    buffer_load_dwordx4 v[132:135], v2, s[24:27], s68 offen offset:2048 sc1
    v_mfma_f32_32x32x16_bf16 v[32:47], a[96:99], v[96:99], v[32:47]
    s_waitcnt vmcnt(8)
    v_mfma_f32_32x32x16_bf16 v[48:63], a[108:111], v[100:103], v[48:63]
    s_add_u32 s68, s68, 4096
    s_cmp_eq_u32 s68, 65536
    s_cselect_b32 s68, 0, s68
    buffer_load_dwordx4 v[136:139], v2, s[24:27], s68 offen offset:0 sc1
    v_max3_u32 v28, v28, v96, v100
    v_mfma_f32_32x32x16_bf16 v[32:47], a[104:107], v[100:103], v[32:47]
    s_waitcnt vmcnt(8)
    v_mfma_f32_32x32x16_bf16 v[48:63], a[116:119], v[104:107], v[48:63]
    buffer_load_dwordx4 v[140:143], v2, s[24:27], s68 offen offset:2048 sc1
    v_mfma_f32_32x32x16_bf16 v[32:47], a[112:115], v[104:107], v[32:47]
    s_waitcnt vmcnt(8)
    v_mfma_f32_32x32x16_bf16 v[48:63], a[124:127], v[108:111], v[48:63]
    s_add_u32 s68, s68, 4096
    s_cmp_eq_u32 s68, 65536
    s_cselect_b32 s68, 0, s68
    buffer_load_dwordx4 v[96:99], v2, s[24:27], s68 offen offset:0 sc1
    v_max3_u32 v28, v28, v104, v108
    v_mfma_f32_32x32x16_bf16 v[32:47], a[120:123], v[108:111], v[32:47]
    s_waitcnt vmcnt(8)
    v_mfma_f32_32x32x16_bf16 v[48:63], a[220:223], v[112:115], v[48:63]
    buffer_load_dwordx4 v[100:103], v2, s[24:27], s68 offen offset:2048 sc1
    v_mfma_f32_32x32x16_bf16 v[32:47], a[216:219], v[112:115], v[32:47]
    s_waitcnt vmcnt(8)
    v_mfma_f32_32x32x16_bf16 v[48:63], a[228:231], v[116:119], v[48:63]
    s_add_u32 s68, s68, 4096
    s_cmp_eq_u32 s68, 65536
    s_cselect_b32 s68, 0, s68
    buffer_load_dwordx4 v[104:107], v2, s[24:27], s68 offen offset:0 sc1
    v_max3_u32 v28, v28, v112, v116
    v_mfma_f32_32x32x16_bf16 v[32:47], a[224:227], v[116:119], v[32:47]
    s_waitcnt vmcnt(8)
    v_mfma_f32_32x32x16_bf16 v[48:63], a[236:239], v[120:123], v[48:63]
    buffer_load_dwordx4 v[108:111], v2, s[24:27], s68 offen offset:2048 sc1
    v_mfma_f32_32x32x16_bf16 v[32:47], a[232:235], v[120:123], v[32:47]
    s_waitcnt vmcnt(8)
    v_mfma_f32_32x32x16_bf16 v[48:63], a[244:247], v[124:127], v[48:63]
    s_add_u32 s68, s68, 4096
    s_cmp_eq_u32 s68, 65536
    s_cselect_b32 s68, 0, s68
    buffer_load_dwordx4 v[112:115], v2, s[24:27], s68 offen offset:0 sc1
    v_max3_u32 v28, v28, v120, v124
    v_mfma_f32_32x32x16_bf16 v[32:47], a[240:243], v[124:127], v[32:47]
    s_waitcnt vmcnt(8)
    v_mfma_f32_32x32x16_bf16 v[48:63], a[252:255], v[128:131], v[48:63]
    buffer_load_dwordx4 v[116:119], v2, s[24:27], s68 offen offset:2048 sc1
    v_mfma_f32_32x32x16_bf16 v[32:47], a[248:251], v[128:131], v[32:47]
    s_waitcnt vmcnt(8)
    v_mfma_f32_32x32x16_bf16 v[48:63], v[164:167], v[132:135], v[48:63]
    s_add_u32 s68, s68, 4096
    s_cmp_eq_u32 s68, 65536
    s_cselect_b32 s68, 0, s68
    buffer_load_dwordx4 v[120:123], v2, s[24:27], s68 offen offset:0 sc1
    v_max3_u32 v28, v28, v128, v132
    v_mfma_f32_32x32x16_bf16 v[32:47], v[160:163], v[132:135], v[32:47]
    s_waitcnt vmcnt(8)
    v_mfma_f32_32x32x16_bf16 v[48:63], v[172:175], v[136:139], v[48:63]
    buffer_load_dwordx4 v[124:127], v2, s[24:27], s68 offen offset:2048 sc1
    v_mfma_f32_32x32x16_bf16 v[32:47], v[168:171], v[136:139], v[32:47]
    s_waitcnt vmcnt(8)
    v_mfma_f32_32x32x16_bf16 v[48:63], v[180:183], v[140:143], v[48:63]
    v_max3_u32 v28, v28, v136, v140
    v_mfma_f32_32x32x16_bf16 v[32:47], v[176:179], v[140:143], v[32:47]
    s_waitcnt vmcnt(7)
    v_mfma_f32_32x32x16_bf16 v[48:63], v[188:191], v[96:99], v[48:63]
    v_mfma_f32_32x32x16_bf16 v[32:47], v[184:187], v[96:99], v[32:47]
    s_waitcnt vmcnt(6)
    v_mfma_f32_32x32x16_bf16 v[48:63], v[196:199], v[100:103], v[48:63]
    v_max3_u32 v28, v28, v96, v100
    v_mfma_f32_32x32x16_bf16 v[32:47], v[192:195], v[100:103], v[32:47]
    s_waitcnt vmcnt(5)
    v_mfma_f32_32x32x16_bf16 v[48:63], v[204:207], v[104:107], v[48:63]
    v_mfma_f32_32x32x16_bf16 v[32:47], v[200:203], v[104:107], v[32:47]
    s_waitcnt vmcnt(4)
    v_mfma_f32_32x32x16_bf16 v[48:63], v[212:215], v[108:111], v[48:63]
    v_max3_u32 v28, v28, v104, v108
    v_mfma_f32_32x32x16_bf16 v[32:47], v[208:211], v[108:111], v[32:47]
    s_waitcnt vmcnt(3)
    v_mfma_f32_32x32x16_bf16 v[48:63], v[220:223], v[112:115], v[48:63]
    v_mfma_f32_32x32x16_bf16 v[32:47], v[216:219], v[112:115], v[32:47]
    s_waitcnt vmcnt(2)
    v_mfma_f32_32x32x16_bf16 v[48:63], v[228:231], v[116:119], v[48:63]
    v_max3_u32 v28, v28, v112, v116
    v_mfma_f32_32x32x16_bf16 v[32:47], v[224:227], v[116:119], v[32:47]
    s_waitcnt vmcnt(1)
    v_mfma_f32_32x32x16_bf16 v[48:63], v[236:239], v[120:123], v[48:63]
    v_mfma_f32_32x32x16_bf16 v[32:47], v[232:235], v[120:123], v[32:47]
    s_waitcnt vmcnt(0)
    v_mfma_f32_32x32x16_bf16 v[48:63], v[244:247], v[124:127], v[48:63]
    v_max3_u32 v28, v28, v120, v124
    v_mfma_f32_32x32x16_bf16 v[32:47], v[240:243], v[124:127], v[32:47]
    v_cmp_eq_u32 vcc, -1, v28
    s_cbranch_vccnz VBAD_164
VOK_163:
    s_lshl_b32 s68, s77, 107
    buffer_load_dwordx4 v[128:131], v2, s[24:27], s68 offen offset:1024 sc1
    buffer_load_dwordx4 v[132:135], v2, s[24:27], s68 offen offset:3072 sc1
    s_add_u32 s68, s68, 4096
    s_cmp_eq_u32 s68, 65536
    s_cselect_b32 s68, 0, s68
    buffer_load_dwordx4 v[136:139], v2, s[24:27], s68 offen offset:1024 sc1
    buffer_load_dwordx4 v[140:143], v2, s[24:27], s68 offen offset:3072 sc1
    s_add_u32 s68, s68, 4096
    s_cmp_eq_u32 s68, 65536
    s_cselect_b32 s68, 0, s68
    buffer_load_dwordx4 v[96:99], v2, s[24:27], s68 offen offset:1024 sc1
    buffer_load_dwordx4 v[100:103], v2, s[24:27], s68 offen offset:3072 sc1
    s_add_u32 s68, s68, 4096
    s_cmp_eq_u32 s68, 65536
    s_cselect_b32 s68, 0, s68
    buffer_load_dwordx4 v[104:107], v2, s[24:27], s68 offen offset:1024 sc1
    buffer_load_dwordx4 v[108:111], v2, s[24:27], s68 offen offset:3072 sc1
    s_add_u32 s68, s68, 4096
    s_cmp_eq_u32 s68, 65536
    s_cselect_b32 s68, 0, s68
    buffer_load_dwordx4 v[112:115], v2, s[24:27], s68 offen offset:1024 sc1
    s_waitcnt vmcnt(0)
    s_nop 15
    s_branch BACK_45
PLAIN_48:
    s_lshl_b32 s68, s77, 11
    buffer_load_dwordx4 v[128:131], v2, s[24:27], s68 offen offset:1024 sc1
    buffer_load_dwordx4 v[132:135], v2, s[24:27], s68 offen offset:3072 sc1
    s_add_u32 s68, s68, 4096
    s_cmp_eq_u32 s68, 65536
    s_cselect_b32 s68, 0, s68
    buffer_load_dwordx4 v[136:139], v2, s[24:27], s68 offen offset:1024 sc1
    buffer_load_dwordx4 v[140:143], v2, s[24:27], s68 offen offset:3072 sc1
    s_add_u32 s68, s68, 4096
    s_cmp_eq_u32 s68, 65536
    s_cselect_b32 s68, 0, s68
    buffer_load_dwordx4 v[96:99], v2, s[24:27], s68 offen offset:1024 sc1
    buffer_load_dwordx4 v[100:103], v2, s[24:27], s68 offen offset:3072 sc1
    s_add_u32 s68, s68, 4096
    s_cmp_eq_u32 s68, 65536
    s_cselect_b32 s68, 0, s68
    buffer_load_dwordx4 v[104:107], v2, s[24:27], s68 offen offset:1024 sc1
    buffer_load_dwordx4 v[108:111], v2, s[24:27], s68 offen offset:3072 sc1
    s_add_u32 s68, s68, 4096
    s_cmp_eq_u32 s68, 65536
    s_cselect_b32 s68, 0, s68
    buffer_load_dwordx4 v[112:115], v2, s[24:27], s68 offen offset:1024 sc1
    v_mov_b32 v28, 0
    s_waitcnt vmcnt(8)
    v_mfma_f32_32x32x16_bf16 v[80:95], a[4:7], v[128:131], 0
    buffer_load_dwordx4 v[116:119], v2, s[24:27], s68 offen offset:3072 sc1
    v_mfma_f32_32x32x16_bf16 v[64:79], a[0:3], v[128:131], 0
    s_waitcnt vmcnt(8)
    v_mfma_f32_32x32x16_bf16 v[80:95], a[12:15], v[132:135], v[80:95]
    s_add_u32 s68, s68, 4096
    s_cmp_eq_u32 s68, 65536
    s_cselect_b32 s68, 0, s68
    buffer_load_dwordx4 v[120:123], v2, s[24:27], s68 offen offset:1024 sc1
    v_max3_u32 v28, v28, v128, v132
    v_mfma_f32_32x32x16_bf16 v[64:79], a[8:11], v[132:135], v[64:79]
    s_waitcnt vmcnt(8)
    v_mfma_f32_32x32x16_bf16 v[80:95], a[20:23], v[136:139], v[80:95]
    buffer_load_dwordx4 v[124:127], v2, s[24:27], s68 offen offset:3072 sc1
    v_mfma_f32_32x32x16_bf16 v[64:79], a[16:19], v[136:139], v[64:79]
    s_waitcnt vmcnt(8)
    v_mfma_f32_32x32x16_bf16 v[80:95], a[28:31], v[140:143], v[80:95]
    s_add_u32 s68, s68, 4096
    s_cmp_eq_u32 s68, 65536
    s_cselect_b32 s68, 0, s68
    buffer_load_dwordx4 v[128:131], v2, s[24:27], s68 offen offset:1024 sc1
    v_max3_u32 v28, v28, v136, v140
    v_mfma_f32_32x32x16_bf16 v[64:79], a[24:27], v[140:143], v[64:79]
    s_waitcnt vmcnt(8)
    v_mfma_f32_32x32x16_bf16 v[80:95], a[36:39], v[96:99], v[80:95]
    buffer_load_dwordx4 v[132:135], v2, s[24:27], s68 offen offset:3072 sc1
    v_mfma_f32_32x32x16_bf16 v[64:79], a[32:35], v[96:99], v[64:79]
    s_waitcnt vmcnt(8)
    v_mfma_f32_32x32x16_bf16 v[80:95], a[44:47], v[100:103], v[80:95]
    s_add_u32 s68, s68, 4096
    s_cmp_eq_u32 s68, 65536
    s_cselect_b32 s68, 0, s68
    buffer_load_dwordx4 v[136:139], v2, s[24:27], s68 offen offset:1024 sc1
    v_max3_u32 v28, v28, v96, v100
    v_mfma_f32_32x32x16_bf16 v[64:79], a[40:43], v[100:103], v[64:79]
    s_waitcnt vmcnt(8)
    v_mfma_f32_32x32x16_bf16 v[80:95], a[52:55], v[104:107], v[80:95]
    buffer_load_dwordx4 v[140:143], v2, s[24:27], s68 offen offset:3072 sc1
    v_mfma_f32_32x32x16_bf16 v[64:79], a[48:51], v[104:107], v[64:79]
    s_waitcnt vmcnt(8)
    v_mfma_f32_32x32x16_bf16 v[80:95], a[60:63], v[108:111], v[80:95]
    s_add_u32 s68, s68, 4096
    s_cmp_eq_u32 s68, 65536
    s_cselect_b32 s68, 0, s68
    buffer_load_dwordx4 v[96:99], v2, s[24:27], s68 offen offset:1024 sc1
    v_max3_u32 v28, v28, v104, v108
    v_mfma_f32_32x32x16_bf16 v[64:79], a[56:59], v[108:111], v[64:79]
    s_waitcnt vmcnt(8)
    v_mfma_f32_32x32x16_bf16 v[80:95], a[68:71], v[112:115], v[80:95]
    buffer_load_dwordx4 v[100:103], v2, s[24:27], s68 offen offset:3072 sc1
    v_mfma_f32_32x32x16_bf16 v[64:79], a[64:67], v[112:115], v[64:79]
    s_waitcnt vmcnt(8)
    v_mfma_f32_32x32x16_bf16 v[80:95], a[76:79], v[116:119], v[80:95]
    s_add_u32 s68, s68, 4096
    s_cmp_eq_u32 s68, 65536
    s_cselect_b32 s68, 0, s68
    buffer_load_dwordx4 v[104:107], v2, s[24:27], s68 offen offset:1024 sc1
    v_max3_u32 v28, v28, v112, v116
    v_mfma_f32_32x32x16_bf16 v[64:79], a[72:75], v[116:119], v[64:79]
    s_waitcnt vmcnt(8)
    v_mfma_f32_32x32x16_bf16 v[80:95], a[84:87], v[120:123], v[80:95]
    buffer_load_dwordx4 v[108:111], v2, s[24:27], s68 offen offset:3072 sc1
    v_mfma_f32_32x32x16_bf16 v[64:79], a[80:83], v[120:123], v[64:79]
    s_waitcnt vmcnt(8)
    v_mfma_f32_32x32x16_bf16 v[80:95], a[92:95], v[124:127], v[80:95]
    s_add_u32 s68, s68, 4096
    s_cmp_eq_u32 s68, 65536
    s_cselect_b32 s68, 0, s68
    buffer_load_dwordx4 v[112:115], v2, s[24:27], s68 offen offset:1024 sc1
    v_max3_u32 v28, v28, v120, v124
    v_mfma_f32_32x32x16_bf16 v[64:79], a[88:91], v[124:127], v[64:79]
    s_waitcnt vmcnt(8)
    v_mfma_f32_32x32x16_bf16 v[80:95], a[100:103], v[128:131], v[80:95]
    buffer_load_dwordx4 v[116:119], v2, s[24:27], s68 offen offset:3072 sc1
    v_mfma_f32_32x32x16_bf16 v[64:79], a[96:99], v[128:131], v[64:79]
    s_waitcnt vmcnt(8)
    v_mfma_f32_32x32x16_bf16 v[80:95], a[108:111], v[132:135], v[80:95]
    s_add_u32 s68, s68, 4096
    s_cmp_eq_u32 s68, 65536
    s_cselect_b32 s68, 0, s68
    buffer_load_dwordx4 v[120:123], v2, s[24:27], s68 offen offset:1024 sc1
    v_max3_u32 v28, v28, v128, v132
    v_mfma_f32_32x32x16_bf16 v[64:79], a[104:107], v[132:135], v[64:79]
    s_waitcnt vmcnt(8)
    v_mfma_f32_32x32x16_bf16 v[80:95], a[116:119], v[136:139], v[80:95]
    buffer_load_dwordx4 v[124:127], v2, s[24:27], s68 offen offset:3072 sc1
    v_mfma_f32_32x32x16_bf16 v[64:79], a[112:115], v[136:139], v[64:79]
    s_waitcnt vmcnt(8)
    v_mfma_f32_32x32x16_bf16 v[80:95], a[124:127], v[140:143], v[80:95]
    s_add_u32 s68, s68, 4096
    s_cmp_eq_u32 s68, 65536
    s_cselect_b32 s68, 0, s68
    buffer_load_dwordx4 v[128:131], v2, s[24:27], s68 offen offset:1024 sc1
    v_max3_u32 v28, v28, v136, v140
    v_mfma_f32_32x32x16_bf16 v[64:79], a[120:123], v[140:143], v[64:79]
    s_waitcnt vmcnt(8)
    v_mfma_f32_32x32x16_bf16 v[80:95], a[220:223], v[96:99], v[80:95]
    buffer_load_dwordx4 v[132:135], v2, s[24:27], s68 offen offset:3072 sc1
    v_mfma_f32_32x32x16_bf16 v[64:79], a[216:219], v[96:99], v[64:79]
    s_waitcnt vmcnt(8)
    v_mfma_f32_32x32x16_bf16 v[80:95], a[228:231], v[100:103], v[80:95]
    s_add_u32 s68, s68, 4096
    s_cmp_eq_u32 s68, 65536
    s_cselect_b32 s68, 0, s68
    buffer_load_dwordx4 v[136:139], v2, s[24:27], s68 offen offset:1024 sc1
    v_max3_u32 v28, v28, v96, v100
    v_mfma_f32_32x32x16_bf16 v[64:79], a[224:227], v[100:103], v[64:79]
    s_waitcnt vmcnt(8)
    v_mfma_f32_32x32x16_bf16 v[80:95], a[236:239], v[104:107], v[80:95]
    buffer_load_dwordx4 v[140:143], v2, s[24:27], s68 offen offset:3072 sc1
    v_mfma_f32_32x32x16_bf16 v[64:79], a[232:235], v[104:107], v[64:79]
    s_waitcnt vmcnt(8)
    v_mfma_f32_32x32x16_bf16 v[80:95], a[244:247], v[108:111], v[80:95]
    s_add_u32 s68, s68, 4096
    s_cmp_eq_u32 s68, 65536
    s_cselect_b32 s68, 0, s68
    buffer_load_dwordx4 v[96:99], v2, s[24:27], s68 offen offset:1024 sc1
    v_max3_u32 v28, v28, v104, v108
    v_mfma_f32_32x32x16_bf16 v[64:79], a[240:243], v[108:111], v[64:79]
    s_waitcnt vmcnt(8)
    v_mfma_f32_32x32x16_bf16 v[80:95], a[252:255], v[112:115], v[80:95]
    buffer_load_dwordx4 v[100:103], v2, s[24:27], s68 offen offset:3072 sc1
    v_mfma_f32_32x32x16_bf16 v[64:79], a[248:251], v[112:115], v[64:79]
    s_waitcnt vmcnt(8)
    v_mfma_f32_32x32x16_bf16 v[80:95], v[164:167], v[116:119], v[80:95]
    s_add_u32 s68, s68, 4096
    s_cmp_eq_u32 s68, 65536
    s_cselect_b32 s68, 0, s68
    buffer_load_dwordx4 v[104:107], v2, s[24:27], s68 offen offset:1024 sc1
    v_max3_u32 v28, v28, v112, v116
    v_mfma_f32_32x32x16_bf16 v[64:79], v[160:163], v[116:119], v[64:79]
    s_waitcnt vmcnt(8)
    v_mfma_f32_32x32x16_bf16 v[80:95], v[172:175], v[120:123], v[80:95]
    buffer_load_dwordx4 v[108:111], v2, s[24:27], s68 offen offset:3072 sc1
    v_mfma_f32_32x32x16_bf16 v[64:79], v[168:171], v[120:123], v[64:79]
    s_waitcnt vmcnt(8)
    v_mfma_f32_32x32x16_bf16 v[80:95], v[180:183], v[124:127], v[80:95]
    v_max3_u32 v28, v28, v120, v124
    v_mfma_f32_32x32x16_bf16 v[64:79], v[176:179], v[124:127], v[64:79]
    s_waitcnt vmcnt(7)
    v_mfma_f32_32x32x16_bf16 v[80:95], v[188:191], v[128:131], v[80:95]
    v_mfma_f32_32x32x16_bf16 v[64:79], v[184:187], v[128:131], v[64:79]
    s_waitcnt vmcnt(6)
    v_mfma_f32_32x32x16_bf16 v[80:95], v[196:199], v[132:135], v[80:95]
    v_max3_u32 v28, v28, v128, v132
    v_mfma_f32_32x32x16_bf16 v[64:79], v[192:195], v[132:135], v[64:79]
    s_waitcnt vmcnt(5)
    v_mfma_f32_32x32x16_bf16 v[80:95], v[204:207], v[136:139], v[80:95]
    v_mfma_f32_32x32x16_bf16 v[64:79], v[200:203], v[136:139], v[64:79]
    s_waitcnt vmcnt(4)
    v_mfma_f32_32x32x16_bf16 v[80:95], v[212:215], v[140:143], v[80:95]
    v_max3_u32 v28, v28, v136, v140
    v_mfma_f32_32x32x16_bf16 v[64:79], v[208:211], v[140:143], v[64:79]
    s_waitcnt vmcnt(3)
    v_mfma_f32_32x32x16_bf16 v[80:95], v[220:223], v[96:99], v[80:95]
    v_mfma_f32_32x32x16_bf16 v[64:79], v[216:219], v[96:99], v[64:79]
    s_waitcnt vmcnt(2)
    v_mfma_f32_32x32x16_bf16 v[80:95], v[228:231], v[100:103], v[80:95]
    v_max3_u32 v28, v28, v96, v100
    v_mfma_f32_32x32x16_bf16 v[64:79], v[224:227], v[100:103], v[64:79]
    s_waitcnt vmcnt(1)
    v_mfma_f32_32x32x16_bf16 v[80:95], v[236:239], v[104:107], v[80:95]
    v_mfma_f32_32x32x16_bf16 v[64:79], v[232:235], v[104:107], v[64:79]
    s_waitcnt vmcnt(0)
    v_mfma_f32_32x32x16_bf16 v[80:95], v[244:247], v[108:111], v[80:95]
    v_max3_u32 v28, v28, v104, v108
    v_mfma_f32_32x32x16_bf16 v[64:79], v[240:243], v[108:111], v[64:79]
    v_cmp_eq_u32 vcc, -1, v28
    s_cbranch_vccnz VBAD_166
VOK_165:
    buffer_load_dword v7, v30, s[24:27], s93 offen offset:1020 sc1
    s_lshl_b32 s68, s78, 107
    buffer_load_dwordx4 v[112:115], v3, s[24:27], s68 offen offset:0 sc1
    buffer_load_dwordx4 v[116:119], v3, s[24:27], s68 offen offset:2048 sc1
    s_add_u32 s68, s68, 4096
    s_cmp_eq_u32 s68, 57344
    s_cselect_b32 s68, 0, s68
    buffer_load_dwordx4 v[120:123], v3, s[24:27], s68 offen offset:0 sc1
    buffer_load_dwordx4 v[124:127], v3, s[24:27], s68 offen offset:2048 sc1
    s_add_u32 s68, s68, 4096
    s_cmp_eq_u32 s68, 57344
    s_cselect_b32 s68, 0, s68
    buffer_load_dwordx4 v[128:131], v3, s[24:27], s68 offen offset:0 sc1
    buffer_load_dwordx4 v[132:135], v3, s[24:27], s68 offen offset:2048 sc1
    s_add_u32 s68, s68, 4096
    s_cmp_eq_u32 s68, 57344
    s_cselect_b32 s68, 0, s68
    buffer_load_dwordx4 v[136:139], v3, s[24:27], s68 offen offset:0 sc1
    buffer_load_dwordx4 v[140:143], v3, s[24:27], s68 offen offset:2048 sc1
    s_add_u32 s68, s68, 4096
    s_cmp_eq_u32 s68, 57344
    s_cselect_b32 s68, 0, s68
    buffer_load_dwordx4 v[96:99], v3, s[24:27], s68 offen offset:0 sc1
    s_waitcnt vmcnt(0)
    s_nop 15
    s_branch BACK_49
PLAIN_62:
    s_lshl_b32 s68, s78, 11
    buffer_load_dwordx4 v[112:115], v3, s[24:27], s68 offen offset:0 sc1
    buffer_load_dwordx4 v[116:119], v3, s[24:27], s68 offen offset:2048 sc1
    s_add_u32 s68, s68, 4096
    s_cmp_eq_u32 s68, 57344
    s_cselect_b32 s68, 0, s68
    buffer_load_dwordx4 v[120:123], v3, s[24:27], s68 offen offset:0 sc1
    buffer_load_dwordx4 v[124:127], v3, s[24:27], s68 offen offset:2048 sc1
    s_add_u32 s68, s68, 4096
    s_cmp_eq_u32 s68, 57344
    s_cselect_b32 s68, 0, s68
    buffer_load_dwordx4 v[128:131], v3, s[24:27], s68 offen offset:0 sc1
    buffer_load_dwordx4 v[132:135], v3, s[24:27], s68 offen offset:2048 sc1
    s_add_u32 s68, s68, 4096
    s_cmp_eq_u32 s68, 57344
    s_cselect_b32 s68, 0, s68
    buffer_load_dwordx4 v[136:139], v3, s[24:27], s68 offen offset:0 sc1
    buffer_load_dwordx4 v[140:143], v3, s[24:27], s68 offen offset:2048 sc1
    s_add_u32 s68, s68, 4096
    s_cmp_eq_u32 s68, 57344
    s_cselect_b32 s68, 0, s68
    buffer_load_dwordx4 v[96:99], v3, s[24:27], s68 offen offset:0 sc1
    v_mov_b32 v28, 0
    s_waitcnt vmcnt(8)
    v_mfma_f32_32x32x16_bf16 v[48:63], v[112:115], a[132:135], 0
    buffer_load_dwordx4 v[100:103], v3, s[24:27], s68 offen offset:2048 sc1
    v_mfma_f32_32x32x16_bf16 v[32:47], v[112:115], a[128:131], 0
    s_waitcnt vmcnt(8)
    v_mfma_f32_32x32x16_bf16 v[48:63], v[116:119], a[140:143], v[48:63]
    s_add_u32 s68, s68, 4096
    s_cmp_eq_u32 s68, 57344
    s_cselect_b32 s68, 0, s68
    buffer_load_dwordx4 v[104:107], v3, s[24:27], s68 offen offset:0 sc1
    v_max3_u32 v28, v28, v112, v116
    v_mfma_f32_32x32x16_bf16 v[32:47], v[116:119], a[136:139], v[32:47]
    s_waitcnt vmcnt(8)
    v_mfma_f32_32x32x16_bf16 v[48:63], v[120:123], a[148:151], v[48:63]
    buffer_load_dwordx4 v[108:111], v3, s[24:27], s68 offen offset:2048 sc1
    v_mfma_f32_32x32x16_bf16 v[32:47], v[120:123], a[144:147], v[32:47]
    s_waitcnt vmcnt(8)
    v_mfma_f32_32x32x16_bf16 v[48:63], v[124:127], a[156:159], v[48:63]
    s_add_u32 s68, s68, 4096
    s_cmp_eq_u32 s68, 57344
    s_cselect_b32 s68, 0, s68
    buffer_load_dwordx4 v[112:115], v3, s[24:27], s68 offen offset:0 sc1
    v_max3_u32 v28, v28, v120, v124
    v_mfma_f32_32x32x16_bf16 v[32:47], v[124:127], a[152:155], v[32:47]
    s_waitcnt vmcnt(8)
    v_mfma_f32_32x32x16_bf16 v[48:63], v[128:131], a[164:167], v[48:63]
    buffer_load_dwordx4 v[116:119], v3, s[24:27], s68 offen offset:2048 sc1
    v_mfma_f32_32x32x16_bf16 v[32:47], v[128:131], a[160:163], v[32:47]
    s_waitcnt vmcnt(8)
    v_mfma_f32_32x32x16_bf16 v[48:63], v[132:135], a[172:175], v[48:63]
    s_add_u32 s68, s68, 4096
    s_cmp_eq_u32 s68, 57344
    s_cselect_b32 s68, 0, s68
    buffer_load_dwordx4 v[120:123], v3, s[24:27], s68 offen offset:0 sc1
    v_max3_u32 v28, v28, v128, v132
    v_mfma_f32_32x32x16_bf16 v[32:47], v[132:135], a[168:171], v[32:47]
    s_waitcnt vmcnt(8)
    v_mfma_f32_32x32x16_bf16 v[48:63], v[136:139], a[180:183], v[48:63]
    buffer_load_dwordx4 v[124:127], v3, s[24:27], s68 offen offset:2048 sc1
    v_mfma_f32_32x32x16_bf16 v[32:47], v[136:139], a[176:179], v[32:47]
    s_waitcnt vmcnt(8)
    v_mfma_f32_32x32x16_bf16 v[48:63], v[140:143], a[188:191], v[48:63]
    s_add_u32 s68, s68, 4096
    s_cmp_eq_u32 s68, 57344
    s_cselect_b32 s68, 0, s68
    buffer_load_dwordx4 v[128:131], v3, s[24:27], s68 offen offset:0 sc1
    v_max3_u32 v28, v28, v136, v140
    v_mfma_f32_32x32x16_bf16 v[32:47], v[140:143], a[184:187], v[32:47]
    s_waitcnt vmcnt(8)
    v_mfma_f32_32x32x16_bf16 v[48:63], v[96:99], a[196:199], v[48:63]
    buffer_load_dwordx4 v[132:135], v3, s[24:27], s68 offen offset:2048 sc1
    v_mfma_f32_32x32x16_bf16 v[32:47], v[96:99], a[192:195], v[32:47]
    s_waitcnt vmcnt(8)
    v_mfma_f32_32x32x16_bf16 v[48:63], v[100:103], a[204:207], v[48:63]
    s_add_u32 s68, s68, 4096
    s_cmp_eq_u32 s68, 57344
    s_cselect_b32 s68, 0, s68
    buffer_load_dwordx4 v[136:139], v3, s[24:27], s68 offen offset:0 sc1
    v_max3_u32 v28, v28, v96, v100
    v_mfma_f32_32x32x16_bf16 v[32:47], v[100:103], a[200:203], v[32:47]
    s_waitcnt vmcnt(8)
    v_mfma_f32_32x32x16_bf16 v[48:63], v[104:107], a[212:215], v[48:63]
    buffer_load_dwordx4 v[140:143], v3, s[24:27], s68 offen offset:2048 sc1
    v_mfma_f32_32x32x16_bf16 v[32:47], v[104:107], a[208:211], v[32:47]
    s_waitcnt vmcnt(8)
    v_mfma_f32_32x32x16_bf16 v[48:63], v[108:111], a[220:223], v[48:63]
    s_add_u32 s68, s68, 4096
    s_cmp_eq_u32 s68, 57344
    s_cselect_b32 s68, 0, s68
    buffer_load_dwordx4 v[96:99], v3, s[24:27], s68 offen offset:0 sc1
    v_max3_u32 v28, v28, v104, v108
    v_mfma_f32_32x32x16_bf16 v[32:47], v[108:111], a[216:219], v[32:47]
    s_waitcnt vmcnt(8)
    v_mfma_f32_32x32x16_bf16 v[48:63], v[112:115], a[228:231], v[48:63]
    buffer_load_dwordx4 v[100:103], v3, s[24:27], s68 offen offset:2048 sc1
    v_mfma_f32_32x32x16_bf16 v[32:47], v[112:115], a[224:227], v[32:47]
    s_waitcnt vmcnt(8)
    v_mfma_f32_32x32x16_bf16 v[48:63], v[116:119], a[236:239], v[48:63]
    s_add_u32 s68, s68, 4096
    s_cmp_eq_u32 s68, 57344
    s_cselect_b32 s68, 0, s68
    buffer_load_dwordx4 v[104:107], v3, s[24:27], s68 offen offset:0 sc1
    v_max3_u32 v28, v28, v112, v116
    v_mfma_f32_32x32x16_bf16 v[32:47], v[116:119], a[232:235], v[32:47]
    s_waitcnt vmcnt(8)
    v_mfma_f32_32x32x16_bf16 v[48:63], v[120:123], a[244:247], v[48:63]
    buffer_load_dwordx4 v[108:111], v3, s[24:27], s68 offen offset:2048 sc1
    v_mfma_f32_32x32x16_bf16 v[32:47], v[120:123], a[240:243], v[32:47]
    s_waitcnt vmcnt(8)
    v_mfma_f32_32x32x16_bf16 v[48:63], v[124:127], a[252:255], v[48:63]
    s_add_u32 s68, s68, 4096
    s_cmp_eq_u32 s68, 57344
    s_cselect_b32 s68, 0, s68
    buffer_load_dwordx4 v[112:115], v3, s[24:27], s68 offen offset:0 sc1
    v_max3_u32 v28, v28, v120, v124
    v_mfma_f32_32x32x16_bf16 v[32:47], v[124:127], a[248:251], v[32:47]
    s_waitcnt vmcnt(8)
    v_mfma_f32_32x32x16_bf16 v[48:63], v[128:131], v[164:167], v[48:63]
    buffer_load_dwordx4 v[116:119], v3, s[24:27], s68 offen offset:2048 sc1
    v_mfma_f32_32x32x16_bf16 v[32:47], v[128:131], v[160:163], v[32:47]
    s_waitcnt vmcnt(8)
    v_mfma_f32_32x32x16_bf16 v[48:63], v[132:135], v[172:175], v[48:63]
    s_add_u32 s68, s68, 4096
    s_cmp_eq_u32 s68, 57344
    s_cselect_b32 s68, 0, s68
    buffer_load_dwordx4 v[120:123], v3, s[24:27], s68 offen offset:0 sc1
    v_max3_u32 v28, v28, v128, v132
    v_mfma_f32_32x32x16_bf16 v[32:47], v[132:135], v[168:171], v[32:47]
    s_waitcnt vmcnt(8)
    v_mfma_f32_32x32x16_bf16 v[48:63], v[136:139], v[180:183], v[48:63]
    buffer_load_dwordx4 v[124:127], v3, s[24:27], s68 offen offset:2048 sc1
    v_mfma_f32_32x32x16_bf16 v[32:47], v[136:139], v[176:179], v[32:47]
    s_waitcnt vmcnt(8)
    v_mfma_f32_32x32x16_bf16 v[48:63], v[140:143], v[188:191], v[48:63]
    v_max3_u32 v28, v28, v136, v140
    v_mfma_f32_32x32x16_bf16 v[32:47], v[140:143], v[184:187], v[32:47]
    s_waitcnt vmcnt(7)
    v_mfma_f32_32x32x16_bf16 v[48:63], v[96:99], v[196:199], v[48:63]
    v_mfma_f32_32x32x16_bf16 v[32:47], v[96:99], v[192:195], v[32:47]
    s_waitcnt vmcnt(6)
    v_mfma_f32_32x32x16_bf16 v[48:63], v[100:103], v[204:207], v[48:63]
    v_max3_u32 v28, v28, v96, v100
    v_mfma_f32_32x32x16_bf16 v[32:47], v[100:103], v[200:203], v[32:47]
    s_waitcnt vmcnt(5)
    v_mfma_f32_32x32x16_bf16 v[48:63], v[104:107], v[212:215], v[48:63]
    v_mfma_f32_32x32x16_bf16 v[32:47], v[104:107], v[208:211], v[32:47]
    s_waitcnt vmcnt(4)
    v_mfma_f32_32x32x16_bf16 v[48:63], v[108:111], v[220:223], v[48:63]
    v_max3_u32 v28, v28, v104, v108
    v_mfma_f32_32x32x16_bf16 v[32:47], v[108:111], v[216:219], v[32:47]
    s_waitcnt vmcnt(3)
    v_mfma_f32_32x32x16_bf16 v[48:63], v[112:115], v[228:231], v[48:63]
    v_mfma_f32_32x32x16_bf16 v[32:47], v[112:115], v[224:227], v[32:47]
    s_waitcnt vmcnt(2)
    v_mfma_f32_32x32x16_bf16 v[48:63], v[116:119], v[236:239], v[48:63]
    v_max3_u32 v28, v28, v112, v116
    v_mfma_f32_32x32x16_bf16 v[32:47], v[116:119], v[232:235], v[32:47]
    s_waitcnt vmcnt(1)
    v_mfma_f32_32x32x16_bf16 v[48:63], v[120:123], v[244:247], v[48:63]
    v_mfma_f32_32x32x16_bf16 v[32:47], v[120:123], v[240:243], v[32:47]
    s_waitcnt vmcnt(0)
    v_mfma_f32_32x32x16_bf16 v[48:63], v[124:127], v[252:255], v[48:63]
    v_max3_u32 v28, v28, v120, v124
    v_mfma_f32_32x32x16_bf16 v[32:47], v[124:127], v[248:251], v[32:47]
    v_cmp_eq_u32 vcc, -1, v28
    s_cbranch_vccnz VBAD_168
VOK_167:
    buffer_load_dword v7, v30, s[24:27], s93 offen offset:2044 sc1
    s_lshl_b32 s68, s78, 107
    buffer_load_dwordx4 v[128:131], v3, s[24:27], s68 offen offset:1024 sc1
    buffer_load_dwordx4 v[132:135], v3, s[24:27], s68 offen offset:3072 sc1
    s_add_u32 s68, s68, 4096
    s_cmp_eq_u32 s68, 57344
    s_cselect_b32 s68, 0, s68
    buffer_load_dwordx4 v[136:139], v3, s[24:27], s68 offen offset:1024 sc1
    buffer_load_dwordx4 v[140:143], v3, s[24:27], s68 offen offset:3072 sc1
    s_add_u32 s68, s68, 4096
    s_cmp_eq_u32 s68, 57344
    s_cselect_b32 s68, 0, s68
    buffer_load_dwordx4 v[96:99], v3, s[24:27], s68 offen offset:1024 sc1
    buffer_load_dwordx4 v[100:103], v3, s[24:27], s68 offen offset:3072 sc1
    s_add_u32 s68, s68, 4096
    s_cmp_eq_u32 s68, 57344
    s_cselect_b32 s68, 0, s68
    buffer_load_dwordx4 v[104:107], v3, s[24:27], s68 offen offset:1024 sc1
    buffer_load_dwordx4 v[108:111], v3, s[24:27], s68 offen offset:3072 sc1
    s_add_u32 s68, s68, 4096
    s_cmp_eq_u32 s68, 57344
    s_cselect_b32 s68, 0, s68
    buffer_load_dwordx4 v[112:115], v3, s[24:27], s68 offen offset:1024 sc1
    s_waitcnt vmcnt(0)
    s_nop 15
    s_branch BACK_63
PLAIN_72:
    s_lshl_b32 s68, s78, 11
    buffer_load_dwordx4 v[128:131], v3, s[24:27], s68 offen offset:1024 sc1
    buffer_load_dwordx4 v[132:135], v3, s[24:27], s68 offen offset:3072 sc1
    s_add_u32 s68, s68, 4096
    s_cmp_eq_u32 s68, 57344
    s_cselect_b32 s68, 0, s68
    buffer_load_dwordx4 v[136:139], v3, s[24:27], s68 offen offset:1024 sc1
    buffer_load_dwordx4 v[140:143], v3, s[24:27], s68 offen offset:3072 sc1
    s_add_u32 s68, s68, 4096
    s_cmp_eq_u32 s68, 57344
    s_cselect_b32 s68, 0, s68
    buffer_load_dwordx4 v[96:99], v3, s[24:27], s68 offen offset:1024 sc1
    buffer_load_dwordx4 v[100:103], v3, s[24:27], s68 offen offset:3072 sc1
    s_add_u32 s68, s68, 4096
    s_cmp_eq_u32 s68, 57344
    s_cselect_b32 s68, 0, s68
    buffer_load_dwordx4 v[104:107], v3, s[24:27], s68 offen offset:1024 sc1
    buffer_load_dwordx4 v[108:111], v3, s[24:27], s68 offen offset:3072 sc1
    s_add_u32 s68, s68, 4096
    s_cmp_eq_u32 s68, 57344
    s_cselect_b32 s68, 0, s68
    buffer_load_dwordx4 v[112:115], v3, s[24:27], s68 offen offset:1024 sc1
    v_mov_b32 v28, 0
    s_waitcnt vmcnt(8)
    v_mfma_f32_32x32x16_bf16 v[80:95], v[128:131], a[132:135], 0
    buffer_load_dwordx4 v[116:119], v3, s[24:27], s68 offen offset:3072 sc1
    v_mfma_f32_32x32x16_bf16 v[64:79], v[128:131], a[128:131], 0
    s_waitcnt vmcnt(8)
    v_mfma_f32_32x32x16_bf16 v[80:95], v[132:135], a[140:143], v[80:95]
    s_add_u32 s68, s68, 4096
    s_cmp_eq_u32 s68, 57344
    s_cselect_b32 s68, 0, s68
    buffer_load_dwordx4 v[120:123], v3, s[24:27], s68 offen offset:1024 sc1
    v_max3_u32 v28, v28, v128, v132
    v_mfma_f32_32x32x16_bf16 v[64:79], v[132:135], a[136:139], v[64:79]
    s_waitcnt vmcnt(8)
    v_mfma_f32_32x32x16_bf16 v[80:95], v[136:139], a[148:151], v[80:95]
    buffer_load_dwordx4 v[124:127], v3, s[24:27], s68 offen offset:3072 sc1
    v_mfma_f32_32x32x16_bf16 v[64:79], v[136:139], a[144:147], v[64:79]
    s_waitcnt vmcnt(8)
    v_mfma_f32_32x32x16_bf16 v[80:95], v[140:143], a[156:159], v[80:95]
    s_add_u32 s68, s68, 4096
    s_cmp_eq_u32 s68, 57344
    s_cselect_b32 s68, 0, s68
    buffer_load_dwordx4 v[128:131], v3, s[24:27], s68 offen offset:1024 sc1
    v_max3_u32 v28, v28, v136, v140
    v_mfma_f32_32x32x16_bf16 v[64:79], v[140:143], a[152:155], v[64:79]
    s_waitcnt vmcnt(8)
    v_mfma_f32_32x32x16_bf16 v[80:95], v[96:99], a[164:167], v[80:95]
    buffer_load_dwordx4 v[132:135], v3, s[24:27], s68 offen offset:3072 sc1
    v_mfma_f32_32x32x16_bf16 v[64:79], v[96:99], a[160:163], v[64:79]
    s_waitcnt vmcnt(8)
    v_mfma_f32_32x32x16_bf16 v[80:95], v[100:103], a[172:175], v[80:95]
    s_add_u32 s68, s68, 4096
    s_cmp_eq_u32 s68, 57344
    s_cselect_b32 s68, 0, s68
    buffer_load_dwordx4 v[136:139], v3, s[24:27], s68 offen offset:1024 sc1
    v_max3_u32 v28, v28, v96, v100
    v_mfma_f32_32x32x16_bf16 v[64:79], v[100:103], a[168:171], v[64:79]
    s_waitcnt vmcnt(8)
    v_mfma_f32_32x32x16_bf16 v[80:95], v[104:107], a[180:183], v[80:95]
    buffer_load_dwordx4 v[140:143], v3, s[24:27], s68 offen offset:3072 sc1
    v_mfma_f32_32x32x16_bf16 v[64:79], v[104:107], a[176:179], v[64:79]
    s_waitcnt vmcnt(8)
    v_mfma_f32_32x32x16_bf16 v[80:95], v[108:111], a[188:191], v[80:95]
    s_add_u32 s68, s68, 4096
    s_cmp_eq_u32 s68, 57344
    s_cselect_b32 s68, 0, s68
    buffer_load_dwordx4 v[96:99], v3, s[24:27], s68 offen offset:1024 sc1
    v_max3_u32 v28, v28, v104, v108
    v_mfma_f32_32x32x16_bf16 v[64:79], v[108:111], a[184:187], v[64:79]
    s_waitcnt vmcnt(8)
    v_mfma_f32_32x32x16_bf16 v[80:95], v[112:115], a[196:199], v[80:95]
    buffer_load_dwordx4 v[100:103], v3, s[24:27], s68 offen offset:3072 sc1
    v_mfma_f32_32x32x16_bf16 v[64:79], v[112:115], a[192:195], v[64:79]
    s_waitcnt vmcnt(8)
    v_mfma_f32_32x32x16_bf16 v[80:95], v[116:119], a[204:207], v[80:95]
    s_add_u32 s68, s68, 4096
    s_cmp_eq_u32 s68, 57344
    s_cselect_b32 s68, 0, s68
    buffer_load_dwordx4 v[104:107], v3, s[24:27], s68 offen offset:1024 sc1
    v_max3_u32 v28, v28, v112, v116
    v_mfma_f32_32x32x16_bf16 v[64:79], v[116:119], a[200:203], v[64:79]
    s_waitcnt vmcnt(8)
    v_mfma_f32_32x32x16_bf16 v[80:95], v[120:123], a[212:215], v[80:95]
    buffer_load_dwordx4 v[108:111], v3, s[24:27], s68 offen offset:3072 sc1
    v_mfma_f32_32x32x16_bf16 v[64:79], v[120:123], a[208:211], v[64:79]
    s_waitcnt vmcnt(8)
    v_mfma_f32_32x32x16_bf16 v[80:95], v[124:127], a[220:223], v[80:95]
    s_add_u32 s68, s68, 4096
    s_cmp_eq_u32 s68, 57344
    s_cselect_b32 s68, 0, s68
    buffer_load_dwordx4 v[112:115], v3, s[24:27], s68 offen offset:1024 sc1
    v_max3_u32 v28, v28, v120, v124
    v_mfma_f32_32x32x16_bf16 v[64:79], v[124:127], a[216:219], v[64:79]
    s_waitcnt vmcnt(8)
    v_mfma_f32_32x32x16_bf16 v[80:95], v[128:131], a[228:231], v[80:95]
    buffer_load_dwordx4 v[116:119], v3, s[24:27], s68 offen offset:3072 sc1
    v_mfma_f32_32x32x16_bf16 v[64:79], v[128:131], a[224:227], v[64:79]
    s_waitcnt vmcnt(8)
    v_mfma_f32_32x32x16_bf16 v[80:95], v[132:135], a[236:239], v[80:95]
    s_add_u32 s68, s68, 4096
    s_cmp_eq_u32 s68, 57344
    s_cselect_b32 s68, 0, s68
    buffer_load_dwordx4 v[120:123], v3, s[24:27], s68 offen offset:1024 sc1
    v_max3_u32 v28, v28, v128, v132
    v_mfma_f32_32x32x16_bf16 v[64:79], v[132:135], a[232:235], v[64:79]
    s_waitcnt vmcnt(8)
    v_mfma_f32_32x32x16_bf16 v[80:95], v[136:139], a[244:247], v[80:95]
    buffer_load_dwordx4 v[124:127], v3, s[24:27], s68 offen offset:3072 sc1
    v_mfma_f32_32x32x16_bf16 v[64:79], v[136:139], a[240:243], v[64:79]
    s_waitcnt vmcnt(8)
    v_mfma_f32_32x32x16_bf16 v[80:95], v[140:143], a[252:255], v[80:95]
    s_add_u32 s68, s68, 4096
    s_cmp_eq_u32 s68, 57344
    s_cselect_b32 s68, 0, s68
    buffer_load_dwordx4 v[128:131], v3, s[24:27], s68 offen offset:1024 sc1
    v_max3_u32 v28, v28, v136, v140
    v_mfma_f32_32x32x16_bf16 v[64:79], v[140:143], a[248:251], v[64:79]
    s_waitcnt vmcnt(8)
    v_mfma_f32_32x32x16_bf16 v[80:95], v[96:99], v[164:167], v[80:95]
    buffer_load_dwordx4 v[132:135], v3, s[24:27], s68 offen offset:3072 sc1
    v_mfma_f32_32x32x16_bf16 v[64:79], v[96:99], v[160:163], v[64:79]
    s_waitcnt vmcnt(8)
    v_mfma_f32_32x32x16_bf16 v[80:95], v[100:103], v[172:175], v[80:95]
    s_add_u32 s68, s68, 4096
    s_cmp_eq_u32 s68, 57344
    s_cselect_b32 s68, 0, s68
    buffer_load_dwordx4 v[136:139], v3, s[24:27], s68 offen offset:1024 sc1
    v_max3_u32 v28, v28, v96, v100
    v_mfma_f32_32x32x16_bf16 v[64:79], v[100:103], v[168:171], v[64:79]
    s_waitcnt vmcnt(8)
    v_mfma_f32_32x32x16_bf16 v[80:95], v[104:107], v[180:183], v[80:95]
    buffer_load_dwordx4 v[140:143], v3, s[24:27], s68 offen offset:3072 sc1
    v_mfma_f32_32x32x16_bf16 v[64:79], v[104:107], v[176:179], v[64:79]
    s_waitcnt vmcnt(8)
    v_mfma_f32_32x32x16_bf16 v[80:95], v[108:111], v[188:191], v[80:95]
    v_max3_u32 v28, v28, v104, v108
    v_mfma_f32_32x32x16_bf16 v[64:79], v[108:111], v[184:187], v[64:79]
    s_waitcnt vmcnt(7)
    v_mfma_f32_32x32x16_bf16 v[80:95], v[112:115], v[196:199], v[80:95]
    v_mfma_f32_32x32x16_bf16 v[64:79], v[112:115], v[192:195], v[64:79]
    s_waitcnt vmcnt(6)
    v_mfma_f32_32x32x16_bf16 v[80:95], v[116:119], v[204:207], v[80:95]
    v_max3_u32 v28, v28, v112, v116
    v_mfma_f32_32x32x16_bf16 v[64:79], v[116:119], v[200:203], v[64:79]
    s_waitcnt vmcnt(5)
    v_mfma_f32_32x32x16_bf16 v[80:95], v[120:123], v[212:215], v[80:95]
    v_mfma_f32_32x32x16_bf16 v[64:79], v[120:123], v[208:211], v[64:79]
    s_waitcnt vmcnt(4)
    v_mfma_f32_32x32x16_bf16 v[80:95], v[124:127], v[220:223], v[80:95]
    v_max3_u32 v28, v28, v120, v124
    v_mfma_f32_32x32x16_bf16 v[64:79], v[124:127], v[216:219], v[64:79]
    s_waitcnt vmcnt(3)
    v_mfma_f32_32x32x16_bf16 v[80:95], v[128:131], v[228:231], v[80:95]
    v_mfma_f32_32x32x16_bf16 v[64:79], v[128:131], v[224:227], v[64:79]
    s_waitcnt vmcnt(2)
    v_mfma_f32_32x32x16_bf16 v[80:95], v[132:135], v[236:239], v[80:95]
    v_max3_u32 v28, v28, v128, v132
    v_mfma_f32_32x32x16_bf16 v[64:79], v[132:135], v[232:235], v[64:79]
    s_waitcnt vmcnt(1)
    v_mfma_f32_32x32x16_bf16 v[80:95], v[136:139], v[244:247], v[80:95]
    v_mfma_f32_32x32x16_bf16 v[64:79], v[136:139], v[240:243], v[64:79]
    s_waitcnt vmcnt(0)
    v_mfma_f32_32x32x16_bf16 v[80:95], v[140:143], v[252:255], v[80:95]
    v_max3_u32 v28, v28, v136, v140
    v_mfma_f32_32x32x16_bf16 v[64:79], v[140:143], v[248:251], v[64:79]
    v_cmp_eq_u32 vcc, -1, v28
    s_cbranch_vccnz VBAD_170
VOK_169:
    s_nop 15
    s_branch BACK_73
PLAIN_131:
    s_lshl_b32 s68, s77, 107
    buffer_load_dwordx4 v[96:99], v2, s[24:27], s68 offen offset:0 sc1
    buffer_load_dwordx4 v[100:103], v2, s[24:27], s68 offen offset:2048 sc1
    s_add_u32 s68, s68, 4096
    s_cmp_eq_u32 s68, 65536
    s_cselect_b32 s68, 0, s68
    buffer_load_dwordx4 v[104:107], v2, s[24:27], s68 offen offset:0 sc1
    buffer_load_dwordx4 v[108:111], v2, s[24:27], s68 offen offset:2048 sc1
    s_add_u32 s68, s68, 4096
    s_cmp_eq_u32 s68, 65536
    s_cselect_b32 s68, 0, s68
    buffer_load_dwordx4 v[112:115], v2, s[24:27], s68 offen offset:0 sc1
    buffer_load_dwordx4 v[116:119], v2, s[24:27], s68 offen offset:2048 sc1
    s_add_u32 s68, s68, 4096
    s_cmp_eq_u32 s68, 65536
    s_cselect_b32 s68, 0, s68
    buffer_load_dwordx4 v[120:123], v2, s[24:27], s68 offen offset:0 sc1
    buffer_load_dwordx4 v[124:127], v2, s[24:27], s68 offen offset:2048 sc1
    s_add_u32 s68, s68, 4096
    s_cmp_eq_u32 s68, 65536
    s_cselect_b32 s68, 0, s68
    buffer_load_dwordx4 v[128:131], v2, s[24:27], s68 offen offset:0 sc1
    v_mov_b32 v28, 0
    s_waitcnt vmcnt(8)
    v_mfma_f32_32x32x16_bf16 v[48:63], a[4:7], v[96:99], 0
    buffer_load_dwordx4 v[132:135], v2, s[24:27], s68 offen offset:2048 sc1
    v_mfma_f32_32x32x16_bf16 v[32:47], a[0:3], v[96:99], 0
    s_waitcnt vmcnt(8)
    v_mfma_f32_32x32x16_bf16 v[48:63], a[12:15], v[100:103], v[48:63]
    s_add_u32 s68, s68, 4096
    s_cmp_eq_u32 s68, 65536
    s_cselect_b32 s68, 0, s68
    buffer_load_dwordx4 v[136:139], v2, s[24:27], s68 offen offset:0 sc1
    v_max3_u32 v28, v28, v96, v100
    v_mfma_f32_32x32x16_bf16 v[32:47], a[8:11], v[100:103], v[32:47]
    s_waitcnt vmcnt(8)
    v_mfma_f32_32x32x16_bf16 v[48:63], a[20:23], v[104:107], v[48:63]
    buffer_load_dwordx4 v[140:143], v2, s[24:27], s68 offen offset:2048 sc1
    v_mfma_f32_32x32x16_bf16 v[32:47], a[16:19], v[104:107], v[32:47]
    s_waitcnt vmcnt(8)
    v_mfma_f32_32x32x16_bf16 v[48:63], a[28:31], v[108:111], v[48:63]
    s_add_u32 s68, s68, 4096
    s_cmp_eq_u32 s68, 65536
    s_cselect_b32 s68, 0, s68
    buffer_load_dwordx4 v[96:99], v2, s[24:27], s68 offen offset:0 sc1
    v_max3_u32 v28, v28, v104, v108
    v_mfma_f32_32x32x16_bf16 v[32:47], a[24:27], v[108:111], v[32:47]
    s_waitcnt vmcnt(8)
    v_mfma_f32_32x32x16_bf16 v[48:63], a[36:39], v[112:115], v[48:63]
    buffer_load_dwordx4 v[100:103], v2, s[24:27], s68 offen offset:2048 sc1
    v_mfma_f32_32x32x16_bf16 v[32:47], a[32:35], v[112:115], v[32:47]
    s_waitcnt vmcnt(8)
    v_mfma_f32_32x32x16_bf16 v[48:63], a[44:47], v[116:119], v[48:63]
    s_add_u32 s68, s68, 4096
    s_cmp_eq_u32 s68, 65536
    s_cselect_b32 s68, 0, s68
    buffer_load_dwordx4 v[104:107], v2, s[24:27], s68 offen offset:0 sc1
    v_max3_u32 v28, v28, v112, v116
    v_mfma_f32_32x32x16_bf16 v[32:47], a[40:43], v[116:119], v[32:47]
    s_waitcnt vmcnt(8)
    v_mfma_f32_32x32x16_bf16 v[48:63], a[52:55], v[120:123], v[48:63]
    buffer_load_dwordx4 v[108:111], v2, s[24:27], s68 offen offset:2048 sc1
    v_mfma_f32_32x32x16_bf16 v[32:47], a[48:51], v[120:123], v[32:47]
    s_waitcnt vmcnt(8)
    v_mfma_f32_32x32x16_bf16 v[48:63], a[60:63], v[124:127], v[48:63]
    s_add_u32 s68, s68, 4096
    s_cmp_eq_u32 s68, 65536
    s_cselect_b32 s68, 0, s68
    buffer_load_dwordx4 v[112:115], v2, s[24:27], s68 offen offset:0 sc1
    v_max3_u32 v28, v28, v120, v124
    v_mfma_f32_32x32x16_bf16 v[32:47], a[56:59], v[124:127], v[32:47]
    s_waitcnt vmcnt(8)
    v_mfma_f32_32x32x16_bf16 v[48:63], a[68:71], v[128:131], v[48:63]
    buffer_load_dwordx4 v[116:119], v2, s[24:27], s68 offen offset:2048 sc1
    v_mfma_f32_32x32x16_bf16 v[32:47], a[64:67], v[128:131], v[32:47]
    s_waitcnt vmcnt(8)
    v_mfma_f32_32x32x16_bf16 v[48:63], a[76:79], v[132:135], v[48:63]
    s_add_u32 s68, s68, 4096
    s_cmp_eq_u32 s68, 65536
    s_cselect_b32 s68, 0, s68
    buffer_load_dwordx4 v[120:123], v2, s[24:27], s68 offen offset:0 sc1
    v_max3_u32 v28, v28, v128, v132
    v_mfma_f32_32x32x16_bf16 v[32:47], a[72:75], v[132:135], v[32:47]
    s_waitcnt vmcnt(8)
    v_mfma_f32_32x32x16_bf16 v[48:63], a[84:87], v[136:139], v[48:63]
    buffer_load_dwordx4 v[124:127], v2, s[24:27], s68 offen offset:2048 sc1
    v_mfma_f32_32x32x16_bf16 v[32:47], a[80:83], v[136:139], v[32:47]
    s_waitcnt vmcnt(8)
    v_mfma_f32_32x32x16_bf16 v[48:63], a[92:95], v[140:143], v[48:63]
    s_add_u32 s68, s68, 4096
    s_cmp_eq_u32 s68, 65536
    s_cselect_b32 s68, 0, s68
    buffer_load_dwordx4 v[128:131], v2, s[24:27], s68 offen offset:0 sc1
    v_max3_u32 v28, v28, v136, v140
    v_mfma_f32_32x32x16_bf16 v[32:47], a[88:91], v[140:143], v[32:47]
    s_waitcnt vmcnt(8)
    v_mfma_f32_32x32x16_bf16 v[48:63], a[100:103], v[96:99], v[48:63]
    buffer_load_dwordx4 v[132:135], v2, s[24:27], s68 offen offset:2048 sc1
    v_mfma_f32_32x32x16_bf16 v[32:47], a[96:99], v[96:99], v[32:47]
    s_waitcnt vmcnt(8)
    v_mfma_f32_32x32x16_bf16 v[48:63], a[108:111], v[100:103], v[48:63]
    s_add_u32 s68, s68, 4096
    s_cmp_eq_u32 s68, 65536
    s_cselect_b32 s68, 0, s68
    buffer_load_dwordx4 v[136:139], v2, s[24:27], s68 offen offset:0 sc1
    v_max3_u32 v28, v28, v96, v100
    v_mfma_f32_32x32x16_bf16 v[32:47], a[104:107], v[100:103], v[32:47]
    s_waitcnt vmcnt(8)
    v_mfma_f32_32x32x16_bf16 v[48:63], a[116:119], v[104:107], v[48:63]
    buffer_load_dwordx4 v[140:143], v2, s[24:27], s68 offen offset:2048 sc1
    v_mfma_f32_32x32x16_bf16 v[32:47], a[112:115], v[104:107], v[32:47]
    s_waitcnt vmcnt(8)
    v_mfma_f32_32x32x16_bf16 v[48:63], a[124:127], v[108:111], v[48:63]
    s_add_u32 s68, s68, 4096
    s_cmp_eq_u32 s68, 65536
    s_cselect_b32 s68, 0, s68
    buffer_load_dwordx4 v[96:99], v2, s[24:27], s68 offen offset:0 sc1
    v_max3_u32 v28, v28, v104, v108
    v_mfma_f32_32x32x16_bf16 v[32:47], a[120:123], v[108:111], v[32:47]
    s_waitcnt vmcnt(8)
    v_mfma_f32_32x32x16_bf16 v[48:63], a[220:223], v[112:115], v[48:63]
    buffer_load_dwordx4 v[100:103], v2, s[24:27], s68 offen offset:2048 sc1
    v_mfma_f32_32x32x16_bf16 v[32:47], a[216:219], v[112:115], v[32:47]
    s_waitcnt vmcnt(8)
    v_mfma_f32_32x32x16_bf16 v[48:63], a[228:231], v[116:119], v[48:63]
    s_add_u32 s68, s68, 4096
    s_cmp_eq_u32 s68, 65536
    s_cselect_b32 s68, 0, s68
    buffer_load_dwordx4 v[104:107], v2, s[24:27], s68 offen offset:0 sc1
    v_max3_u32 v28, v28, v112, v116
    v_mfma_f32_32x32x16_bf16 v[32:47], a[224:227], v[116:119], v[32:47]
    s_waitcnt vmcnt(8)
    v_mfma_f32_32x32x16_bf16 v[48:63], a[236:239], v[120:123], v[48:63]
    buffer_load_dwordx4 v[108:111], v2, s[24:27], s68 offen offset:2048 sc1
    v_mfma_f32_32x32x16_bf16 v[32:47], a[232:235], v[120:123], v[32:47]
    s_waitcnt vmcnt(8)
    v_mfma_f32_32x32x16_bf16 v[48:63], a[244:247], v[124:127], v[48:63]
    s_add_u32 s68, s68, 4096
    s_cmp_eq_u32 s68, 65536
    s_cselect_b32 s68, 0, s68
    buffer_load_dwordx4 v[112:115], v2, s[24:27], s68 offen offset:0 sc1
    v_max3_u32 v28, v28, v120, v124
    v_mfma_f32_32x32x16_bf16 v[32:47], a[240:243], v[124:127], v[32:47]
    s_waitcnt vmcnt(8)
    v_mfma_f32_32x32x16_bf16 v[48:63], a[252:255], v[128:131], v[48:63]
    buffer_load_dwordx4 v[116:119], v2, s[24:27], s68 offen offset:2048 sc1
    v_mfma_f32_32x32x16_bf16 v[32:47], a[248:251], v[128:131], v[32:47]
    s_waitcnt vmcnt(8)
    v_mfma_f32_32x32x16_bf16 v[48:63], v[164:167], v[132:135], v[48:63]
    s_add_u32 s68, s68, 4096
    s_cmp_eq_u32 s68, 65536
    s_cselect_b32 s68, 0, s68
    buffer_load_dwordx4 v[120:123], v2, s[24:27], s68 offen offset:0 sc1
    v_max3_u32 v28, v28, v128, v132
    v_mfma_f32_32x32x16_bf16 v[32:47], v[160:163], v[132:135], v[32:47]
    s_waitcnt vmcnt(8)
    v_mfma_f32_32x32x16_bf16 v[48:63], v[172:175], v[136:139], v[48:63]
    buffer_load_dwordx4 v[124:127], v2, s[24:27], s68 offen offset:2048 sc1
    v_mfma_f32_32x32x16_bf16 v[32:47], v[168:171], v[136:139], v[32:47]
    s_waitcnt vmcnt(8)
    v_mfma_f32_32x32x16_bf16 v[48:63], v[180:183], v[140:143], v[48:63]
    v_max3_u32 v28, v28, v136, v140
    v_mfma_f32_32x32x16_bf16 v[32:47], v[176:179], v[140:143], v[32:47]
    s_waitcnt vmcnt(7)
    v_mfma_f32_32x32x16_bf16 v[48:63], v[188:191], v[96:99], v[48:63]
    v_mfma_f32_32x32x16_bf16 v[32:47], v[184:187], v[96:99], v[32:47]
    s_waitcnt vmcnt(6)
    v_mfma_f32_32x32x16_bf16 v[48:63], v[196:199], v[100:103], v[48:63]
    v_max3_u32 v28, v28, v96, v100
    v_mfma_f32_32x32x16_bf16 v[32:47], v[192:195], v[100:103], v[32:47]
    s_waitcnt vmcnt(5)
    v_mfma_f32_32x32x16_bf16 v[48:63], v[204:207], v[104:107], v[48:63]
    v_mfma_f32_32x32x16_bf16 v[32:47], v[200:203], v[104:107], v[32:47]
    s_waitcnt vmcnt(4)
    v_mfma_f32_32x32x16_bf16 v[48:63], v[212:215], v[108:111], v[48:63]
    v_max3_u32 v28, v28, v104, v108
    v_mfma_f32_32x32x16_bf16 v[32:47], v[208:211], v[108:111], v[32:47]
    s_waitcnt vmcnt(3)
    v_mfma_f32_32x32x16_bf16 v[48:63], v[220:223], v[112:115], v[48:63]
    v_mfma_f32_32x32x16_bf16 v[32:47], v[216:219], v[112:115], v[32:47]
    s_waitcnt vmcnt(2)
    v_mfma_f32_32x32x16_bf16 v[48:63], v[228:231], v[116:119], v[48:63]
    v_max3_u32 v28, v28, v112, v116
    v_mfma_f32_32x32x16_bf16 v[32:47], v[224:227], v[116:119], v[32:47]
    s_waitcnt vmcnt(1)
    v_mfma_f32_32x32x16_bf16 v[48:63], v[236:239], v[120:123], v[48:63]
    v_mfma_f32_32x32x16_bf16 v[32:47], v[232:235], v[120:123], v[32:47]
    s_waitcnt vmcnt(0)
    v_mfma_f32_32x32x16_bf16 v[48:63], v[244:247], v[124:127], v[48:63]
    v_max3_u32 v28, v28, v120, v124
    v_mfma_f32_32x32x16_bf16 v[32:47], v[240:243], v[124:127], v[32:47]
    v_cmp_eq_u32 vcc, -1, v28
    s_cbranch_vccnz VBAD_172
VOK_171:
    s_lshl_b32 s68, s77, 107
    buffer_load_dwordx4 v[128:131], v2, s[24:27], s68 offen offset:1024 sc1
    buffer_load_dwordx4 v[132:135], v2, s[24:27], s68 offen offset:3072 sc1
    s_add_u32 s68, s68, 4096
    s_cmp_eq_u32 s68, 65536
    s_cselect_b32 s68, 0, s68
    buffer_load_dwordx4 v[136:139], v2, s[24:27], s68 offen offset:1024 sc1
    buffer_load_dwordx4 v[140:143], v2, s[24:27], s68 offen offset:3072 sc1
    s_add_u32 s68, s68, 4096
    s_cmp_eq_u32 s68, 65536
    s_cselect_b32 s68, 0, s68
    buffer_load_dwordx4 v[96:99], v2, s[24:27], s68 offen offset:1024 sc1
    buffer_load_dwordx4 v[100:103], v2, s[24:27], s68 offen offset:3072 sc1
    s_add_u32 s68, s68, 4096
    s_cmp_eq_u32 s68, 65536
    s_cselect_b32 s68, 0, s68
    buffer_load_dwordx4 v[104:107], v2, s[24:27], s68 offen offset:1024 sc1
    buffer_load_dwordx4 v[108:111], v2, s[24:27], s68 offen offset:3072 sc1
    s_add_u32 s68, s68, 4096
    s_cmp_eq_u32 s68, 65536
    s_cselect_b32 s68, 0, s68
    buffer_load_dwordx4 v[112:115], v2, s[24:27], s68 offen offset:1024 sc1
    s_waitcnt vmcnt(0)
    s_nop 15
    s_branch BACK_132
PLAIN_135:
    s_lshl_b32 s68, s77, 11
    buffer_load_dwordx4 v[128:131], v2, s[24:27], s68 offen offset:1024 sc1
    buffer_load_dwordx4 v[132:135], v2, s[24:27], s68 offen offset:3072 sc1
    s_add_u32 s68, s68, 4096
    s_cmp_eq_u32 s68, 65536
    s_cselect_b32 s68, 0, s68
    buffer_load_dwordx4 v[136:139], v2, s[24:27], s68 offen offset:1024 sc1
    buffer_load_dwordx4 v[140:143], v2, s[24:27], s68 offen offset:3072 sc1
    s_add_u32 s68, s68, 4096
    s_cmp_eq_u32 s68, 65536
    s_cselect_b32 s68, 0, s68
    buffer_load_dwordx4 v[96:99], v2, s[24:27], s68 offen offset:1024 sc1
    buffer_load_dwordx4 v[100:103], v2, s[24:27], s68 offen offset:3072 sc1
    s_add_u32 s68, s68, 4096
    s_cmp_eq_u32 s68, 65536
    s_cselect_b32 s68, 0, s68
    buffer_load_dwordx4 v[104:107], v2, s[24:27], s68 offen offset:1024 sc1
    buffer_load_dwordx4 v[108:111], v2, s[24:27], s68 offen offset:3072 sc1
    s_add_u32 s68, s68, 4096
    s_cmp_eq_u32 s68, 65536
    s_cselect_b32 s68, 0, s68
    buffer_load_dwordx4 v[112:115], v2, s[24:27], s68 offen offset:1024 sc1
    v_mov_b32 v28, 0
    s_waitcnt vmcnt(8)
    v_mfma_f32_32x32x16_bf16 v[80:95], a[4:7], v[128:131], 0
    buffer_load_dwordx4 v[116:119], v2, s[24:27], s68 offen offset:3072 sc1
    v_mfma_f32_32x32x16_bf16 v[64:79], a[0:3], v[128:131], 0
    s_waitcnt vmcnt(8)
    v_mfma_f32_32x32x16_bf16 v[80:95], a[12:15], v[132:135], v[80:95]
    s_add_u32 s68, s68, 4096
    s_cmp_eq_u32 s68, 65536
    s_cselect_b32 s68, 0, s68
    buffer_load_dwordx4 v[120:123], v2, s[24:27], s68 offen offset:1024 sc1
    v_max3_u32 v28, v28, v128, v132
    v_mfma_f32_32x32x16_bf16 v[64:79], a[8:11], v[132:135], v[64:79]
    s_waitcnt vmcnt(8)
    v_mfma_f32_32x32x16_bf16 v[80:95], a[20:23], v[136:139], v[80:95]
    buffer_load_dwordx4 v[124:127], v2, s[24:27], s68 offen offset:3072 sc1
    v_mfma_f32_32x32x16_bf16 v[64:79], a[16:19], v[136:139], v[64:79]
    s_waitcnt vmcnt(8)
    v_mfma_f32_32x32x16_bf16 v[80:95], a[28:31], v[140:143], v[80:95]
    s_add_u32 s68, s68, 4096
    s_cmp_eq_u32 s68, 65536
    s_cselect_b32 s68, 0, s68
    buffer_load_dwordx4 v[128:131], v2, s[24:27], s68 offen offset:1024 sc1
    v_max3_u32 v28, v28, v136, v140
    v_mfma_f32_32x32x16_bf16 v[64:79], a[24:27], v[140:143], v[64:79]
    s_waitcnt vmcnt(8)
    v_mfma_f32_32x32x16_bf16 v[80:95], a[36:39], v[96:99], v[80:95]
    buffer_load_dwordx4 v[132:135], v2, s[24:27], s68 offen offset:3072 sc1
    v_mfma_f32_32x32x16_bf16 v[64:79], a[32:35], v[96:99], v[64:79]
    s_waitcnt vmcnt(8)
    v_mfma_f32_32x32x16_bf16 v[80:95], a[44:47], v[100:103], v[80:95]
    s_add_u32 s68, s68, 4096
    s_cmp_eq_u32 s68, 65536
    s_cselect_b32 s68, 0, s68
    buffer_load_dwordx4 v[136:139], v2, s[24:27], s68 offen offset:1024 sc1
    v_max3_u32 v28, v28, v96, v100
    v_mfma_f32_32x32x16_bf16 v[64:79], a[40:43], v[100:103], v[64:79]
    s_waitcnt vmcnt(8)
    v_mfma_f32_32x32x16_bf16 v[80:95], a[52:55], v[104:107], v[80:95]
    buffer_load_dwordx4 v[140:143], v2, s[24:27], s68 offen offset:3072 sc1
    v_mfma_f32_32x32x16_bf16 v[64:79], a[48:51], v[104:107], v[64:79]
    s_waitcnt vmcnt(8)
    v_mfma_f32_32x32x16_bf16 v[80:95], a[60:63], v[108:111], v[80:95]
    s_add_u32 s68, s68, 4096
    s_cmp_eq_u32 s68, 65536
    s_cselect_b32 s68, 0, s68
    buffer_load_dwordx4 v[96:99], v2, s[24:27], s68 offen offset:1024 sc1
    v_max3_u32 v28, v28, v104, v108
    v_mfma_f32_32x32x16_bf16 v[64:79], a[56:59], v[108:111], v[64:79]
    s_waitcnt vmcnt(8)
    v_mfma_f32_32x32x16_bf16 v[80:95], a[68:71], v[112:115], v[80:95]
    buffer_load_dwordx4 v[100:103], v2, s[24:27], s68 offen offset:3072 sc1
    v_mfma_f32_32x32x16_bf16 v[64:79], a[64:67], v[112:115], v[64:79]
    s_waitcnt vmcnt(8)
    v_mfma_f32_32x32x16_bf16 v[80:95], a[76:79], v[116:119], v[80:95]
    s_add_u32 s68, s68, 4096
    s_cmp_eq_u32 s68, 65536
    s_cselect_b32 s68, 0, s68
    buffer_load_dwordx4 v[104:107], v2, s[24:27], s68 offen offset:1024 sc1
    v_max3_u32 v28, v28, v112, v116
    v_mfma_f32_32x32x16_bf16 v[64:79], a[72:75], v[116:119], v[64:79]
    s_waitcnt vmcnt(8)
    v_mfma_f32_32x32x16_bf16 v[80:95], a[84:87], v[120:123], v[80:95]
    buffer_load_dwordx4 v[108:111], v2, s[24:27], s68 offen offset:3072 sc1
    v_mfma_f32_32x32x16_bf16 v[64:79], a[80:83], v[120:123], v[64:79]
    s_waitcnt vmcnt(8)
    v_mfma_f32_32x32x16_bf16 v[80:95], a[92:95], v[124:127], v[80:95]
    s_add_u32 s68, s68, 4096
    s_cmp_eq_u32 s68, 65536
    s_cselect_b32 s68, 0, s68
    buffer_load_dwordx4 v[112:115], v2, s[24:27], s68 offen offset:1024 sc1
    v_max3_u32 v28, v28, v120, v124
    v_mfma_f32_32x32x16_bf16 v[64:79], a[88:91], v[124:127], v[64:79]
    s_waitcnt vmcnt(8)
    v_mfma_f32_32x32x16_bf16 v[80:95], a[100:103], v[128:131], v[80:95]
    buffer_load_dwordx4 v[116:119], v2, s[24:27], s68 offen offset:3072 sc1
    v_mfma_f32_32x32x16_bf16 v[64:79], a[96:99], v[128:131], v[64:79]
    s_waitcnt vmcnt(8)
    v_mfma_f32_32x32x16_bf16 v[80:95], a[108:111], v[132:135], v[80:95]
    s_add_u32 s68, s68, 4096
    s_cmp_eq_u32 s68, 65536
    s_cselect_b32 s68, 0, s68
    buffer_load_dwordx4 v[120:123], v2, s[24:27], s68 offen offset:1024 sc1
    v_max3_u32 v28, v28, v128, v132
    v_mfma_f32_32x32x16_bf16 v[64:79], a[104:107], v[132:135], v[64:79]
    s_waitcnt vmcnt(8)
    v_mfma_f32_32x32x16_bf16 v[80:95], a[116:119], v[136:139], v[80:95]
    buffer_load_dwordx4 v[124:127], v2, s[24:27], s68 offen offset:3072 sc1
    v_mfma_f32_32x32x16_bf16 v[64:79], a[112:115], v[136:139], v[64:79]
    s_waitcnt vmcnt(8)
    v_mfma_f32_32x32x16_bf16 v[80:95], a[124:127], v[140:143], v[80:95]
    s_add_u32 s68, s68, 4096
    s_cmp_eq_u32 s68, 65536
    s_cselect_b32 s68, 0, s68
    buffer_load_dwordx4 v[128:131], v2, s[24:27], s68 offen offset:1024 sc1
    v_max3_u32 v28, v28, v136, v140
    v_mfma_f32_32x32x16_bf16 v[64:79], a[120:123], v[140:143], v[64:79]
    s_waitcnt vmcnt(8)
    v_mfma_f32_32x32x16_bf16 v[80:95], a[220:223], v[96:99], v[80:95]
    buffer_load_dwordx4 v[132:135], v2, s[24:27], s68 offen offset:3072 sc1
    v_mfma_f32_32x32x16_bf16 v[64:79], a[216:219], v[96:99], v[64:79]
    s_waitcnt vmcnt(8)
    v_mfma_f32_32x32x16_bf16 v[80:95], a[228:231], v[100:103], v[80:95]
    s_add_u32 s68, s68, 4096
    s_cmp_eq_u32 s68, 65536
    s_cselect_b32 s68, 0, s68
    buffer_load_dwordx4 v[136:139], v2, s[24:27], s68 offen offset:1024 sc1
    v_max3_u32 v28, v28, v96, v100
    v_mfma_f32_32x32x16_bf16 v[64:79], a[224:227], v[100:103], v[64:79]
    s_waitcnt vmcnt(8)
    v_mfma_f32_32x32x16_bf16 v[80:95], a[236:239], v[104:107], v[80:95]
    buffer_load_dwordx4 v[140:143], v2, s[24:27], s68 offen offset:3072 sc1
    v_mfma_f32_32x32x16_bf16 v[64:79], a[232:235], v[104:107], v[64:79]
    s_waitcnt vmcnt(8)
    v_mfma_f32_32x32x16_bf16 v[80:95], a[244:247], v[108:111], v[80:95]
    s_add_u32 s68, s68, 4096
    s_cmp_eq_u32 s68, 65536
    s_cselect_b32 s68, 0, s68
    buffer_load_dwordx4 v[96:99], v2, s[24:27], s68 offen offset:1024 sc1
    v_max3_u32 v28, v28, v104, v108
    v_mfma_f32_32x32x16_bf16 v[64:79], a[240:243], v[108:111], v[64:79]
    s_waitcnt vmcnt(8)
    v_mfma_f32_32x32x16_bf16 v[80:95], a[252:255], v[112:115], v[80:95]
    buffer_load_dwordx4 v[100:103], v2, s[24:27], s68 offen offset:3072 sc1
    v_mfma_f32_32x32x16_bf16 v[64:79], a[248:251], v[112:115], v[64:79]
    s_waitcnt vmcnt(8)
    v_mfma_f32_32x32x16_bf16 v[80:95], v[164:167], v[116:119], v[80:95]
    s_add_u32 s68, s68, 4096
    s_cmp_eq_u32 s68, 65536
    s_cselect_b32 s68, 0, s68
    buffer_load_dwordx4 v[104:107], v2, s[24:27], s68 offen offset:1024 sc1
    v_max3_u32 v28, v28, v112, v116
    v_mfma_f32_32x32x16_bf16 v[64:79], v[160:163], v[116:119], v[64:79]
    s_waitcnt vmcnt(8)
    v_mfma_f32_32x32x16_bf16 v[80:95], v[172:175], v[120:123], v[80:95]
    buffer_load_dwordx4 v[108:111], v2, s[24:27], s68 offen offset:3072 sc1
    v_mfma_f32_32x32x16_bf16 v[64:79], v[168:171], v[120:123], v[64:79]
    s_waitcnt vmcnt(8)
    v_mfma_f32_32x32x16_bf16 v[80:95], v[180:183], v[124:127], v[80:95]
    v_max3_u32 v28, v28, v120, v124
    v_mfma_f32_32x32x16_bf16 v[64:79], v[176:179], v[124:127], v[64:79]
    s_waitcnt vmcnt(7)
    v_mfma_f32_32x32x16_bf16 v[80:95], v[188:191], v[128:131], v[80:95]
    v_mfma_f32_32x32x16_bf16 v[64:79], v[184:187], v[128:131], v[64:79]
    s_waitcnt vmcnt(6)
    v_mfma_f32_32x32x16_bf16 v[80:95], v[196:199], v[132:135], v[80:95]
    v_max3_u32 v28, v28, v128, v132
    v_mfma_f32_32x32x16_bf16 v[64:79], v[192:195], v[132:135], v[64:79]
    s_waitcnt vmcnt(5)
    v_mfma_f32_32x32x16_bf16 v[80:95], v[204:207], v[136:139], v[80:95]
    v_mfma_f32_32x32x16_bf16 v[64:79], v[200:203], v[136:139], v[64:79]
    s_waitcnt vmcnt(4)
    v_mfma_f32_32x32x16_bf16 v[80:95], v[212:215], v[140:143], v[80:95]
    v_max3_u32 v28, v28, v136, v140
    v_mfma_f32_32x32x16_bf16 v[64:79], v[208:211], v[140:143], v[64:79]
    s_waitcnt vmcnt(3)
    v_mfma_f32_32x32x16_bf16 v[80:95], v[220:223], v[96:99], v[80:95]
    v_mfma_f32_32x32x16_bf16 v[64:79], v[216:219], v[96:99], v[64:79]
    s_waitcnt vmcnt(2)
    v_mfma_f32_32x32x16_bf16 v[80:95], v[228:231], v[100:103], v[80:95]
    v_max3_u32 v28, v28, v96, v100
    v_mfma_f32_32x32x16_bf16 v[64:79], v[224:227], v[100:103], v[64:79]
    s_waitcnt vmcnt(1)
    v_mfma_f32_32x32x16_bf16 v[80:95], v[236:239], v[104:107], v[80:95]
    v_mfma_f32_32x32x16_bf16 v[64:79], v[232:235], v[104:107], v[64:79]
    s_waitcnt vmcnt(0)
    v_mfma_f32_32x32x16_bf16 v[80:95], v[244:247], v[108:111], v[80:95]
    v_max3_u32 v28, v28, v104, v108
    v_mfma_f32_32x32x16_bf16 v[64:79], v[240:243], v[108:111], v[64:79]
    v_cmp_eq_u32_e64 vcc, -1, v28
    s_cbranch_vccnz VBAD_174
VOK_173:
    buffer_load_dword v7, v30, s[24:27], s93 offen offset:1020 sc1
    s_lshl_b32 s68, s78, 107
    buffer_load_dwordx4 v[112:115], v3, s[24:27], s68 offen offset:0 sc1
    buffer_load_dwordx4 v[116:119], v3, s[24:27], s68 offen offset:2048 sc1
    s_add_u32 s68, s68, 4096
    s_cmp_eq_u32 s68, 57344
    s_cselect_b32 s68, 0, s68
    buffer_load_dwordx4 v[120:123], v3, s[24:27], s68 offen offset:0 sc1
    buffer_load_dwordx4 v[124:127], v3, s[24:27], s68 offen offset:2048 sc1
    s_add_u32 s68, s68, 4096
    s_cmp_eq_u32 s68, 57344
    s_cselect_b32 s68, 0, s68
    buffer_load_dwordx4 v[128:131], v3, s[24:27], s68 offen offset:0 sc1
    buffer_load_dwordx4 v[132:135], v3, s[24:27], s68 offen offset:2048 sc1
    s_add_u32 s68, s68, 4096
    s_cmp_eq_u32 s68, 57344
    s_cselect_b32 s68, 0, s68
    buffer_load_dwordx4 v[136:139], v3, s[24:27], s68 offen offset:0 sc1
    buffer_load_dwordx4 v[140:143], v3, s[24:27], s68 offen offset:2048 sc1
    s_add_u32 s68, s68, 4096
    s_cmp_eq_u32 s68, 57344
    s_cselect_b32 s68, 0, s68
    buffer_load_dwordx4 v[96:99], v3, s[24:27], s68 offen offset:0 sc1
    s_waitcnt vmcnt(0)
    s_nop 15
    s_branch BACK_136
PLAIN_149:
    s_lshl_b32 s68, s78, 107
    buffer_load_dwordx4 v[112:115], v3, s[24:27], s68 offen offset:0 sc1
    buffer_load_dwordx4 v[116:119], v3, s[24:27], s68 offen offset:2048 sc1
    s_add_u32 s68, s68, 4096
    s_cmp_eq_u32 s68, 57344
    s_cselect_b32 s68, 0, s68
    buffer_load_dwordx4 v[120:123], v3, s[24:27], s68 offen offset:0 sc1
    buffer_load_dwordx4 v[124:127], v3, s[24:27], s68 offen offset:2048 sc1
    s_add_u32 s68, s68, 4096
    s_cmp_eq_u32 s68, 57344
    s_cselect_b32 s68, 0, s68
    buffer_load_dwordx4 v[128:131], v3, s[24:27], s68 offen offset:0 sc1
    buffer_load_dwordx4 v[132:135], v3, s[24:27], s68 offen offset:2048 sc1
    s_add_u32 s68, s68, 4096
    s_cmp_eq_u32 s68, 57344
    s_cselect_b32 s68, 0, s68
    buffer_load_dwordx4 v[136:139], v3, s[24:27], s68 offen offset:0 sc1
    buffer_load_dwordx4 v[140:143], v3, s[24:27], s68 offen offset:2048 sc1
    s_add_u32 s68, s68, 4096
    s_cmp_eq_u32 s68, 57344
    s_cselect_b32 s68, 0, s68
    buffer_load_dwordx4 v[96:99], v3, s[24:27], s68 offen offset:0 sc1
    v_mov_b32 v28, 0
    s_waitcnt vmcnt(8)
    v_mfma_f32_32x32x16_bf16 v[48:63], v[112:115], a[132:135], 0
    buffer_load_dwordx4 v[100:103], v3, s[24:27], s68 offen offset:2048 sc1
    v_mfma_f32_32x32x16_bf16 v[32:47], v[112:115], a[128:131], 0
    s_waitcnt vmcnt(8)
    v_mfma_f32_32x32x16_bf16 v[48:63], v[116:119], a[140:143], v[48:63]
    s_add_u32 s68, s68, 4096
    s_cmp_eq_u32 s68, 57344
    s_cselect_b32 s68, 0, s68
    buffer_load_dwordx4 v[104:107], v3, s[24:27], s68 offen offset:0 sc1
    v_max3_u32 v28, v28, v112, v116
    v_mfma_f32_32x32x16_bf16 v[32:47], v[116:119], a[136:139], v[32:47]
    s_waitcnt vmcnt(8)
    v_mfma_f32_32x32x16_bf16 v[48:63], v[120:123], a[148:151], v[48:63]
    buffer_load_dwordx4 v[108:111], v3, s[24:27], s68 offen offset:2048 sc1
    v_mfma_f32_32x32x16_bf16 v[32:47], v[120:123], a[144:147], v[32:47]
    s_waitcnt vmcnt(8)
    v_mfma_f32_32x32x16_bf16 v[48:63], v[124:127], a[156:159], v[48:63]
    s_add_u32 s68, s68, 4096
    s_cmp_eq_u32 s68, 57344
    s_cselect_b32 s68, 0, s68
    buffer_load_dwordx4 v[112:115], v3, s[24:27], s68 offen offset:0 sc1
    v_max3_u32 v28, v28, v120, v124
    v_mfma_f32_32x32x16_bf16 v[32:47], v[124:127], a[152:155], v[32:47]
    s_waitcnt vmcnt(8)
    v_mfma_f32_32x32x16_bf16 v[48:63], v[128:131], a[164:167], v[48:63]
    buffer_load_dwordx4 v[116:119], v3, s[24:27], s68 offen offset:2048 sc1
    v_mfma_f32_32x32x16_bf16 v[32:47], v[128:131], a[160:163], v[32:47]
    s_waitcnt vmcnt(8)
    v_mfma_f32_32x32x16_bf16 v[48:63], v[132:135], a[172:175], v[48:63]
    s_add_u32 s68, s68, 4096
    s_cmp_eq_u32 s68, 57344
    s_cselect_b32 s68, 0, s68
    buffer_load_dwordx4 v[120:123], v3, s[24:27], s68 offen offset:0 sc1
    v_max3_u32 v28, v28, v128, v132
    v_mfma_f32_32x32x16_bf16 v[32:47], v[132:135], a[168:171], v[32:47]
    s_waitcnt vmcnt(8)
    v_mfma_f32_32x32x16_bf16 v[48:63], v[136:139], a[180:183], v[48:63]
    buffer_load_dwordx4 v[124:127], v3, s[24:27], s68 offen offset:2048 sc1
    v_mfma_f32_32x32x16_bf16 v[32:47], v[136:139], a[176:179], v[32:47]
    s_waitcnt vmcnt(8)
    v_mfma_f32_32x32x16_bf16 v[48:63], v[140:143], a[188:191], v[48:63]
    s_add_u32 s68, s68, 4096
    s_cmp_eq_u32 s68, 57344
    s_cselect_b32 s68, 0, s68
    buffer_load_dwordx4 v[128:131], v3, s[24:27], s68 offen offset:0 sc1
    v_max3_u32 v28, v28, v136, v140
    v_mfma_f32_32x32x16_bf16 v[32:47], v[140:143], a[184:187], v[32:47]
    s_waitcnt vmcnt(8)
    v_mfma_f32_32x32x16_bf16 v[48:63], v[96:99], a[196:199], v[48:63]
    buffer_load_dwordx4 v[132:135], v3, s[24:27], s68 offen offset:2048 sc1
    v_mfma_f32_32x32x16_bf16 v[32:47], v[96:99], a[192:195], v[32:47]
    s_waitcnt vmcnt(8)
    v_mfma_f32_32x32x16_bf16 v[48:63], v[100:103], a[204:207], v[48:63]
    s_add_u32 s68, s68, 4096
    s_cmp_eq_u32 s68, 57344
    s_cselect_b32 s68, 0, s68
    buffer_load_dwordx4 v[136:139], v3, s[24:27], s68 offen offset:0 sc1
    v_max3_u32 v28, v28, v96, v100
    v_mfma_f32_32x32x16_bf16 v[32:47], v[100:103], a[200:203], v[32:47]
    s_waitcnt vmcnt(8)
    v_mfma_f32_32x32x16_bf16 v[48:63], v[104:107], a[212:215], v[48:63]
    buffer_load_dwordx4 v[140:143], v3, s[24:27], s68 offen offset:2048 sc1
    v_mfma_f32_32x32x16_bf16 v[32:47], v[104:107], a[208:211], v[32:47]
    s_waitcnt vmcnt(8)
    v_mfma_f32_32x32x16_bf16 v[48:63], v[108:111], a[220:223], v[48:63]
    s_add_u32 s68, s68, 4096
    s_cmp_eq_u32 s68, 57344
    s_cselect_b32 s68, 0, s68
    buffer_load_dwordx4 v[96:99], v3, s[24:27], s68 offen offset:0 sc1
    v_max3_u32 v28, v28, v104, v108
    v_mfma_f32_32x32x16_bf16 v[32:47], v[108:111], a[216:219], v[32:47]
    s_waitcnt vmcnt(8)
    v_mfma_f32_32x32x16_bf16 v[48:63], v[112:115], a[228:231], v[48:63]
    buffer_load_dwordx4 v[100:103], v3, s[24:27], s68 offen offset:2048 sc1
    v_mfma_f32_32x32x16_bf16 v[32:47], v[112:115], a[224:227], v[32:47]
    s_waitcnt vmcnt(8)
    v_mfma_f32_32x32x16_bf16 v[48:63], v[116:119], a[236:239], v[48:63]
    s_add_u32 s68, s68, 4096
    s_cmp_eq_u32 s68, 57344
    s_cselect_b32 s68, 0, s68
    buffer_load_dwordx4 v[104:107], v3, s[24:27], s68 offen offset:0 sc1
    v_max3_u32 v28, v28, v112, v116
    v_mfma_f32_32x32x16_bf16 v[32:47], v[116:119], a[232:235], v[32:47]
    s_waitcnt vmcnt(8)
    v_mfma_f32_32x32x16_bf16 v[48:63], v[120:123], a[244:247], v[48:63]
    buffer_load_dwordx4 v[108:111], v3, s[24:27], s68 offen offset:2048 sc1
    v_mfma_f32_32x32x16_bf16 v[32:47], v[120:123], a[240:243], v[32:47]
    s_waitcnt vmcnt(8)
    v_mfma_f32_32x32x16_bf16 v[48:63], v[124:127], a[252:255], v[48:63]
    s_add_u32 s68, s68, 4096
    s_cmp_eq_u32 s68, 57344
    s_cselect_b32 s68, 0, s68
    buffer_load_dwordx4 v[112:115], v3, s[24:27], s68 offen offset:0 sc1
    v_max3_u32 v28, v28, v120, v124
    v_mfma_f32_32x32x16_bf16 v[32:47], v[124:127], a[248:251], v[32:47]
    s_waitcnt vmcnt(8)
    v_mfma_f32_32x32x16_bf16 v[48:63], v[128:131], v[164:167], v[48:63]
    buffer_load_dwordx4 v[116:119], v3, s[24:27], s68 offen offset:2048 sc1
    v_mfma_f32_32x32x16_bf16 v[32:47], v[128:131], v[160:163], v[32:47]
    s_waitcnt vmcnt(8)
    v_mfma_f32_32x32x16_bf16 v[48:63], v[132:135], v[172:175], v[48:63]
    s_add_u32 s68, s68, 4096
    s_cmp_eq_u32 s68, 57344
    s_cselect_b32 s68, 0, s68
    buffer_load_dwordx4 v[120:123], v3, s[24:27], s68 offen offset:0 sc1
    v_max3_u32 v28, v28, v128, v132
    v_mfma_f32_32x32x16_bf16 v[32:47], v[132:135], v[168:171], v[32:47]
    s_waitcnt vmcnt(8)
    v_mfma_f32_32x32x16_bf16 v[48:63], v[136:139], v[180:183], v[48:63]
    buffer_load_dwordx4 v[124:127], v3, s[24:27], s68 offen offset:2048 sc1
    v_mfma_f32_32x32x16_bf16 v[32:47], v[136:139], v[176:179], v[32:47]
    s_waitcnt vmcnt(8)
    v_mfma_f32_32x32x16_bf16 v[48:63], v[140:143], v[188:191], v[48:63]
    v_max3_u32 v28, v28, v136, v140
    v_mfma_f32_32x32x16_bf16 v[32:47], v[140:143], v[184:187], v[32:47]
    s_waitcnt vmcnt(7)
    v_mfma_f32_32x32x16_bf16 v[48:63], v[96:99], v[196:199], v[48:63]
    v_mfma_f32_32x32x16_bf16 v[32:47], v[96:99], v[192:195], v[32:47]
    s_waitcnt vmcnt(6)
    v_mfma_f32_32x32x16_bf16 v[48:63], v[100:103], v[204:207], v[48:63]
    v_max3_u32 v28, v28, v96, v100
    v_mfma_f32_32x32x16_bf16 v[32:47], v[100:103], v[200:203], v[32:47]
    s_waitcnt vmcnt(5)
    v_mfma_f32_32x32x16_bf16 v[48:63], v[104:107], v[212:215], v[48:63]
    v_mfma_f32_32x32x16_bf16 v[32:47], v[104:107], v[208:211], v[32:47]
    s_waitcnt vmcnt(4)
    v_mfma_f32_32x32x16_bf16 v[48:63], v[108:111], v[220:223], v[48:63]
    v_max3_u32 v28, v28, v104, v108
    v_mfma_f32_32x32x16_bf16 v[32:47], v[108:111], v[216:219], v[32:47]
    s_waitcnt vmcnt(3)
    v_mfma_f32_32x32x16_bf16 v[48:63], v[112:115], v[228:231], v[48:63]
    v_mfma_f32_32x32x16_bf16 v[32:47], v[112:115], v[224:227], v[32:47]
    s_waitcnt vmcnt(2)
    v_mfma_f32_32x32x16_bf16 v[48:63], v[116:119], v[236:239], v[48:63]
    v_max3_u32 v28, v28, v112, v116
    v_mfma_f32_32x32x16_bf16 v[32:47], v[116:119], v[232:235], v[32:47]
    s_waitcnt vmcnt(1)
    v_mfma_f32_32x32x16_bf16 v[48:63], v[120:123], v[244:247], v[48:63]
    v_mfma_f32_32x32x16_bf16 v[32:47], v[120:123], v[240:243], v[32:47]
    s_waitcnt vmcnt(0)
    v_mfma_f32_32x32x16_bf16 v[48:63], v[124:127], v[252:255], v[48:63]
    v_max3_u32 v28, v28, v120, v124
    v_mfma_f32_32x32x16_bf16 v[32:47], v[124:127], v[248:251], v[32:47]
    v_cmp_eq_u32 vcc, -1, v28
    s_cbranch_vccnz VBAD_176
VOK_175:
    buffer_load_dword v7, v30, s[24:27], s93 offen offset:2044 sc1
    s_lshl_b32 s68, s78, 107
    buffer_load_dwordx4 v[128:131], v3, s[24:27], s68 offen offset:1024 sc1
    buffer_load_dwordx4 v[132:135], v3, s[24:27], s68 offen offset:3072 sc1
    s_add_u32 s68, s68, 4096
    s_cmp_eq_u32 s68, 57344
    s_cselect_b32 s68, 0, s68
    buffer_load_dwordx4 v[136:139], v3, s[24:27], s68 offen offset:1024 sc1
    buffer_load_dwordx4 v[140:143], v3, s[24:27], s68 offen offset:3072 sc1
    s_add_u32 s68, s68, 4096
    s_cmp_eq_u32 s68, 57344
    s_cselect_b32 s68, 0, s68
    buffer_load_dwordx4 v[96:99], v3, s[24:27], s68 offen offset:1024 sc1
    buffer_load_dwordx4 v[100:103], v3, s[24:27], s68 offen offset:3072 sc1
    s_add_u32 s68, s68, 4096
    s_cmp_eq_u32 s68, 57344
    s_cselect_b32 s68, 0, s68
    buffer_load_dwordx4 v[104:107], v3, s[24:27], s68 offen offset:1024 sc1
    buffer_load_dwordx4 v[108:111], v3, s[24:27], s68 offen offset:3072 sc1
    s_add_u32 s68, s68, 4096
    s_cmp_eq_u32 s68, 57344
    s_cselect_b32 s68, 0, s68
    buffer_load_dwordx4 v[112:115], v3, s[24:27], s68 offen offset:1024 sc1
    s_waitcnt vmcnt(0)
    s_nop 15
    s_branch BACK_150
PLAIN_159:
    s_lshl_b32 s68, s78, 11
    buffer_load_dwordx4 v[128:131], v3, s[24:27], s68 offen offset:1024 sc1
    buffer_load_dwordx4 v[132:135], v3, s[24:27], s68 offen offset:3072 sc1
    s_add_u32 s68, s68, 4096
    s_cmp_eq_u32 s68, 57344
    s_cselect_b32 s68, 0, s68
    buffer_load_dwordx4 v[136:139], v3, s[24:27], s68 offen offset:1024 sc1
    buffer_load_dwordx4 v[140:143], v3, s[24:27], s68 offen offset:3072 sc1
    s_add_u32 s68, s68, 4096
    s_cmp_eq_u32 s68, 57344
    s_cselect_b32 s68, 0, s68
    buffer_load_dwordx4 v[96:99], v3, s[24:27], s68 offen offset:1024 sc1
    buffer_load_dwordx4 v[100:103], v3, s[24:27], s68 offen offset:3072 sc1
    s_add_u32 s68, s68, 4096
    s_cmp_eq_u32 s68, 57344
    s_cselect_b32 s68, 0, s68
    buffer_load_dwordx4 v[104:107], v3, s[24:27], s68 offen offset:1024 sc1
    buffer_load_dwordx4 v[108:111], v3, s[24:27], s68 offen offset:3072 sc1
    s_add_u32 s68, s68, 4096
    s_cmp_eq_u32 s68, 57344
    s_cselect_b32 s68, 0, s68
    buffer_load_dwordx4 v[112:115], v3, s[24:27], s68 offen offset:1024 sc1
    v_mov_b32 v28, 0
    s_waitcnt vmcnt(8)
    v_mfma_f32_32x32x16_bf16 v[80:95], v[128:131], a[132:135], 0
    buffer_load_dwordx4 v[116:119], v3, s[24:27], s68 offen offset:3072 sc1
    v_mfma_f32_32x32x16_bf16 v[64:79], v[128:131], a[128:131], 0
    s_waitcnt vmcnt(8)
    v_mfma_f32_32x32x16_bf16 v[80:95], v[132:135], a[140:143], v[80:95]
    s_add_u32 s68, s68, 4096
    s_cmp_eq_u32 s68, 57344
    s_cselect_b32 s68, 0, s68
    buffer_load_dwordx4 v[120:123], v3, s[24:27], s68 offen offset:1024 sc1
    v_max3_u32 v28, v28, v128, v132
    v_mfma_f32_32x32x16_bf16 v[64:79], v[132:135], a[136:139], v[64:79]
    s_waitcnt vmcnt(8)
    v_mfma_f32_32x32x16_bf16 v[80:95], v[136:139], a[148:151], v[80:95]
    buffer_load_dwordx4 v[124:127], v3, s[24:27], s68 offen offset:3072 sc1
    v_mfma_f32_32x32x16_bf16 v[64:79], v[136:139], a[144:147], v[64:79]
    s_waitcnt vmcnt(8)
    v_mfma_f32_32x32x16_bf16 v[80:95], v[140:143], a[156:159], v[80:95]
    s_add_u32 s68, s68, 4096
    s_cmp_eq_u32 s68, 57344
    s_cselect_b32 s68, 0, s68
    buffer_load_dwordx4 v[128:131], v3, s[24:27], s68 offen offset:1024 sc1
    v_max3_u32 v28, v28, v136, v140
    v_mfma_f32_32x32x16_bf16 v[64:79], v[140:143], a[152:155], v[64:79]
    s_waitcnt vmcnt(8)
    v_mfma_f32_32x32x16_bf16 v[80:95], v[96:99], a[164:167], v[80:95]
    buffer_load_dwordx4 v[132:135], v3, s[24:27], s68 offen offset:3072 sc1
    v_mfma_f32_32x32x16_bf16 v[64:79], v[96:99], a[160:163], v[64:79]
    s_waitcnt vmcnt(8)
    v_mfma_f32_32x32x16_bf16 v[80:95], v[100:103], a[172:175], v[80:95]
    s_add_u32 s68, s68, 4096
    s_cmp_eq_u32 s68, 57344
    s_cselect_b32 s68, 0, s68
    buffer_load_dwordx4 v[136:139], v3, s[24:27], s68 offen offset:1024 sc1
    v_max3_u32 v28, v28, v96, v100
    v_mfma_f32_32x32x16_bf16 v[64:79], v[100:103], a[168:171], v[64:79]
    s_waitcnt vmcnt(8)
    v_mfma_f32_32x32x16_bf16 v[80:95], v[104:107], a[180:183], v[80:95]
    buffer_load_dwordx4 v[140:143], v3, s[24:27], s68 offen offset:3072 sc1
    v_mfma_f32_32x32x16_bf16 v[64:79], v[104:107], a[176:179], v[64:79]
    s_waitcnt vmcnt(8)
    v_mfma_f32_32x32x16_bf16 v[80:95], v[108:111], a[188:191], v[80:95]
    s_add_u32 s68, s68, 4096
    s_cmp_eq_u32 s68, 57344
    s_cselect_b32 s68, 0, s68
    buffer_load_dwordx4 v[96:99], v3, s[24:27], s68 offen offset:1024 sc1
    v_max3_u32 v28, v28, v104, v108
    v_mfma_f32_32x32x16_bf16 v[64:79], v[108:111], a[184:187], v[64:79]
    s_waitcnt vmcnt(8)
    v_mfma_f32_32x32x16_bf16 v[80:95], v[112:115], a[196:199], v[80:95]
    buffer_load_dwordx4 v[100:103], v3, s[24:27], s68 offen offset:3072 sc1
    v_mfma_f32_32x32x16_bf16 v[64:79], v[112:115], a[192:195], v[64:79]
    s_waitcnt vmcnt(8)
    v_mfma_f32_32x32x16_bf16 v[80:95], v[116:119], a[204:207], v[80:95]
    s_add_u32 s68, s68, 4096
    s_cmp_eq_u32 s68, 57344
    s_cselect_b32 s68, 0, s68
    buffer_load_dwordx4 v[104:107], v3, s[24:27], s68 offen offset:1024 sc1
    v_max3_u32 v28, v28, v112, v116
    v_mfma_f32_32x32x16_bf16 v[64:79], v[116:119], a[200:203], v[64:79]
    s_waitcnt vmcnt(8)
    v_mfma_f32_32x32x16_bf16 v[80:95], v[120:123], a[212:215], v[80:95]
    buffer_load_dwordx4 v[108:111], v3, s[24:27], s68 offen offset:3072 sc1
    v_mfma_f32_32x32x16_bf16 v[64:79], v[120:123], a[208:211], v[64:79]
    s_waitcnt vmcnt(8)
    v_mfma_f32_32x32x16_bf16 v[80:95], v[124:127], a[220:223], v[80:95]
    s_add_u32 s68, s68, 4096
    s_cmp_eq_u32 s68, 57344
    s_cselect_b32 s68, 0, s68
    buffer_load_dwordx4 v[112:115], v3, s[24:27], s68 offen offset:1024 sc1
    v_max3_u32 v28, v28, v120, v124
    v_mfma_f32_32x32x16_bf16 v[64:79], v[124:127], a[216:219], v[64:79]
    s_waitcnt vmcnt(8)
    v_mfma_f32_32x32x16_bf16 v[80:95], v[128:131], a[228:231], v[80:95]
    buffer_load_dwordx4 v[116:119], v3, s[24:27], s68 offen offset:3072 sc1
    v_mfma_f32_32x32x16_bf16 v[64:79], v[128:131], a[224:227], v[64:79]
    s_waitcnt vmcnt(8)
    v_mfma_f32_32x32x16_bf16 v[80:95], v[132:135], a[236:239], v[80:95]
    s_add_u32 s68, s68, 4096
    s_cmp_eq_u32 s68, 57344
    s_cselect_b32 s68, 0, s68
    buffer_load_dwordx4 v[120:123], v3, s[24:27], s68 offen offset:1024 sc1
    v_max3_u32 v28, v28, v128, v132
    v_mfma_f32_32x32x16_bf16 v[64:79], v[132:135], a[232:235], v[64:79]
    s_waitcnt vmcnt(8)
    v_mfma_f32_32x32x16_bf16 v[80:95], v[136:139], a[244:247], v[80:95]
    buffer_load_dwordx4 v[124:127], v3, s[24:27], s68 offen offset:3072 sc1
    v_mfma_f32_32x32x16_bf16 v[64:79], v[136:139], a[240:243], v[64:79]
    s_waitcnt vmcnt(8)
    v_mfma_f32_32x32x16_bf16 v[80:95], v[140:143], a[252:255], v[80:95]
    s_add_u32 s68, s68, 4096
    s_cmp_eq_u32 s68, 57344
    s_cselect_b32 s68, 0, s68
    buffer_load_dwordx4 v[128:131], v3, s[24:27], s68 offen offset:1024 sc1
    v_max3_u32 v28, v28, v136, v140
    v_mfma_f32_32x32x16_bf16 v[64:79], v[140:143], a[248:251], v[64:79]
    s_waitcnt vmcnt(8)
    v_mfma_f32_32x32x16_bf16 v[80:95], v[96:99], v[164:167], v[80:95]
    buffer_load_dwordx4 v[132:135], v3, s[24:27], s68 offen offset:3072 sc1
    v_mfma_f32_32x32x16_bf16 v[64:79], v[96:99], v[160:163], v[64:79]
    s_waitcnt vmcnt(8)
    v_mfma_f32_32x32x16_bf16 v[80:95], v[100:103], v[172:175], v[80:95]
    s_add_u32 s68, s68, 4096
    s_cmp_eq_u32 s68, 57344
    s_cselect_b32 s68, 0, s68
    buffer_load_dwordx4 v[136:139], v3, s[24:27], s68 offen offset:1024 sc1
    v_max3_u32 v28, v28, v96, v100
    v_mfma_f32_32x32x16_bf16 v[64:79], v[100:103], v[168:171], v[64:79]
    s_waitcnt vmcnt(8)
    v_mfma_f32_32x32x16_bf16 v[80:95], v[104:107], v[180:183], v[80:95]
    buffer_load_dwordx4 v[140:143], v3, s[24:27], s68 offen offset:3072 sc1
    v_mfma_f32_32x32x16_bf16 v[64:79], v[104:107], v[176:179], v[64:79]
    s_waitcnt vmcnt(8)
    v_mfma_f32_32x32x16_bf16 v[80:95], v[108:111], v[188:191], v[80:95]
    v_max3_u32 v28, v28, v104, v108
    v_mfma_f32_32x32x16_bf16 v[64:79], v[108:111], v[184:187], v[64:79]
    s_waitcnt vmcnt(7)
    v_mfma_f32_32x32x16_bf16 v[80:95], v[112:115], v[196:199], v[80:95]
    v_mfma_f32_32x32x16_bf16 v[64:79], v[112:115], v[192:195], v[64:79]
    s_waitcnt vmcnt(6)
    v_mfma_f32_32x32x16_bf16 v[80:95], v[116:119], v[204:207], v[80:95]
    v_max3_u32 v28, v28, v112, v116
    v_mfma_f32_32x32x16_bf16 v[64:79], v[116:119], v[200:203], v[64:79]
    s_waitcnt vmcnt(5)
    v_mfma_f32_32x32x16_bf16 v[80:95], v[120:123], v[212:215], v[80:95]
    v_mfma_f32_32x32x16_bf16 v[64:79], v[120:123], v[208:211], v[64:79]
    s_waitcnt vmcnt(4)
    v_mfma_f32_32x32x16_bf16 v[80:95], v[124:127], v[220:223], v[80:95]
    v_max3_u32 v28, v28, v120, v124
    v_mfma_f32_32x32x16_bf16 v[64:79], v[124:127], v[216:219], v[64:79]
    s_waitcnt vmcnt(3)
    v_mfma_f32_32x32x16_bf16 v[80:95], v[128:131], v[228:231], v[80:95]
    v_mfma_f32_32x32x16_bf16 v[64:79], v[128:131], v[224:227], v[64:79]
    s_waitcnt vmcnt(2)
    v_mfma_f32_32x32x16_bf16 v[80:95], v[132:135], v[236:239], v[80:95]
    v_max3_u32 v28, v28, v128, v132
    v_mfma_f32_32x32x16_bf16 v[64:79], v[132:135], v[232:235], v[64:79]
    s_waitcnt vmcnt(1)
    v_mfma_f32_32x32x16_bf16 v[80:95], v[136:139], v[244:247], v[80:95]
    v_mfma_f32_32x32x16_bf16 v[64:79], v[136:139], v[240:243], v[64:79]
    s_waitcnt vmcnt(0)
    v_mfma_f32_32x32x16_bf16 v[80:95], v[140:143], v[252:255], v[80:95]
    v_max3_u32 v28, v28, v136, v140
    v_mfma_f32_32x32x16_bf16 v[64:79], v[140:143], v[248:251], v[64:79]
    v_cmp_eq_u32 vcc, -1, v28
    s_cbranch_vccnz VBAD_178
VOK_177:
    s_nop 15
    s_branch BACK_160
VBAD_164:
    s_waitcnt vmcnt(0)
    s_sub_u32 s58, s58, 64
    s_cbranch_scc0 PLAIN_44
    s_mov_b32 s58, 0
    s_nop 15
    s_nop 1
    s_branch VOK_163
VBAD_166:
    s_waitcnt vmcnt(0)
    s_sub_u32 s58, s58, 64
    s_cbranch_scc0 PLAIN_48
    s_mov_b32 s58, 0
    s_nop 15
    s_nop 1
    s_branch VOK_165
VBAD_168:
    s_waitcnt vmcnt(0)
    s_sub_u32 s58, s58, 64
    s_cbranch_scc0 PLAIN_62
    s_mov_b32 s58, 0
    s_nop 15
    s_nop 1
    s_branch VOK_167
VBAD_170:
    s_waitcnt vmcnt(0)
    s_sub_u32 s58, s58, 64
    s_cbranch_scc0 PLAIN_72
    s_mov_b32 s58, 0
    s_nop 15
    s_nop 1
    s_branch VOK_169
VBAD_172:
    s_waitcnt vmcnt(0)
    s_sub_u32 s58, s58, 64
    s_cbranch_scc0 PLAIN_131
    s_mov_b32 s58, 0
    s_nop 15
    s_nop 1
    s_branch VOK_171
VBAD_174:
    s_waitcnt vmcnt(0)
    s_sub_u32 s58, s58, 64
    s_cbranch_scc0 PLAIN_135
    s_mov_b32 s58, 0
    s_nop 15
    s_nop 1
    s_branch VOK_173
VBAD_176:
    s_waitcnt vmcnt(0)
    s_sub_u32 s58, s58, 64
    s_cbranch_scc0 PLAIN_149
    s_mov_b32 s58, 0
    s_nop 15
    s_nop 1
    s_branch VOK_175
VBAD_178:
    s_waitcnt vmcnt(0)
    s_sub_u32 s58, s58, 64
    s_cbranch_scc0 PLAIN_159
    s_mov_b32 s58, 0
    s_nop 15
    s_nop 1
    s_branch VOK_177
L_EXIT:
    s_endpgm
.section .rodata,"a"
.p2align 6
.amdhsa_kernel interleave_layers__linear_attn_block__mixer_token_mlp__prompt_kernel
  .amdhsa_next_free_vgpr 512
  .amdhsa_next_free_sgpr 102
  .amdhsa_accum_offset 256
  .amdhsa_group_segment_fixed_size 0
  .amdhsa_kernarg_size 88
  .amdhsa_user_sgpr_count 2
  .amdhsa_user_sgpr_kernarg_segment_ptr 1
  .amdhsa_system_sgpr_workgroup_id_x 1
  .amdhsa_float_denorm_mode_32 3
.end_amdhsa_kernel
```
